```python
import torch

def _softmax(x, axis=-1):
    return torch.softmax(x, dim=axis)
def _gelu(x):
    return torch.nn.functional.gelu(x, approximate="tanh")
def _silu(x):
    return torch.nn.functional.silu(x)
def _sigmoid(x):
    return torch.sigmoid(x)
def _layernorm(x, axis=-1, eps=1e-5):
    m = x.mean(dim=axis, keepdim=True)
    v = x.var(dim=axis, keepdim=True, unbiased=False)
    return (x - m) / torch.sqrt(v + eps)
def _scatter_add(tgt, idx, src, axis=0):
    return tgt.clone().index_add_(axis, idx, src)
def _segment_sum(src, seg, n):
    out = torch.zeros((n,) + src.shape[1:], dtype=src.dtype)
    return out.index_add_(0, seg, src)
def _pad(x, pw):
    flat = tuple(v for pair in reversed(pw) for v in pair)
    return torch.nn.functional.pad(x, flat)

kernel_name = 'gated_mix__ssm_conv_s4d__ssm_conv_s5__prompt'

def setup_inputs():

    _w = (lambda a: (lambda t: t.to(torch.bfloat16) if t.is_floating_point() else t)(torch.as_tensor(a)))
    def _A_setup():
        Bsz, L, D, N = 1, 2048, 640, 128
        return {
            "u": _w((lambda *s: torch.randn(*s, dtype=torch.bfloat16) * 0.05)(Bsz, L, D)),
            "log_A_real": _w((lambda *s: torch.randn(*s, dtype=torch.bfloat16) * 3.2)(D, N) * 0.5),
            "A_imag": _w((lambda *s: torch.randn(*s, dtype=torch.bfloat16) * 0.05)(D, N) * 3.14),
            "C_real": _w((lambda *s: torch.randn(*s, dtype=torch.bfloat16) * 0.1)(D, N) / N ** 0.5),
            "C_imag": _w((lambda *s: torch.randn(*s, dtype=torch.bfloat16) * 0.1)(D, N) / N ** 0.5),
            "log_dt": _w((lambda *s: torch.randn(*s, dtype=torch.bfloat16) * 0.05)(D) * 0.5 - 4.0),
            "D_skip": _w((lambda *s: torch.randn(*s, dtype=torch.bfloat16) * 0.05)(D)),
        }
    _A_in = _A_setup()

    def _B_setup():
        B, S, D = 1, 2048, 640
        P = D
        Lambda_re = -0.5 * (lambda _x: torch.exp(torch.as_tensor(_x)))((lambda *s: torch.randn(*s, dtype=torch.bfloat16) * 0.2)(P))
        Lambda_im = (lambda *s: torch.randn(*s, dtype=torch.bfloat16) * 0.4)(P) * 1.0
        B_re = (lambda *s: torch.randn(*s, dtype=torch.bfloat16) * 0.2)(P, D) * (D ** -0.5)
        B_im = (lambda *s: torch.randn(*s, dtype=torch.bfloat16) * 0.2)(P, D) * (D ** -0.5)
        C_re = (lambda *s: torch.randn(*s, dtype=torch.bfloat16) * 0.2)(D, P) * (P ** -0.5)
        C_im = (lambda *s: torch.randn(*s, dtype=torch.bfloat16) * 0.2)(D, P) * (P ** -0.5)
        log_dt = (lambda *s: torch.randn(*s, dtype=torch.bfloat16) * 0.2)(P) * 0.3 - 2.0
        Dskip = (lambda *s: torch.randn(*s, dtype=torch.bfloat16) * 0.05)(D)
        return {
            "x": _w((lambda *s: torch.randn(*s, dtype=torch.bfloat16) * 0.05)(B, S, D)),
            "Lambda_re": _w(Lambda_re),
            "Lambda_im": _w(Lambda_im),
            "B_re": _w(B_re),
            "B_im": _w(B_im),
            "C_re": _w(C_re),
            "C_im": _w(C_im),
            "log_dt": _w(log_dt),
            "Dskip": _w(Dskip),
        }
    _B_in = _B_setup()

    return {
        "A_u": _A_in["u"],
        "A_log_A_real": _A_in["log_A_real"],
        "A_A_imag": _A_in["A_imag"],
        "A_C_real": _A_in["C_real"],
        "A_C_imag": _A_in["C_imag"],
        "A_log_dt": _A_in["log_dt"],
        "A_D_skip": _A_in["D_skip"],
        "B_x": _B_in["x"],
        "B_Lambda_re": _B_in["Lambda_re"],
        "B_Lambda_im": _B_in["Lambda_im"],
        "B_B_re": _B_in["B_re"],
        "B_B_im": _B_in["B_im"],
        "B_C_re": _B_in["C_re"],
        "B_C_im": _B_in["C_im"],
        "B_log_dt": _B_in["log_dt"],
        "B_Dskip": _B_in["Dskip"],
        "gate_w": _w((lambda *s: torch.randn(*s, dtype=torch.bfloat16) * 0.05)(640) * 16.0),
    }

def reference(A_u, A_log_A_real, A_A_imag, A_C_real, A_C_imag, A_log_dt, A_D_skip, B_x, B_Lambda_re, B_Lambda_im, B_B_re, B_B_im, B_C_re, B_C_im, B_log_dt, B_Dskip, gate_w):
    def _A_ref(u, log_A_real, A_imag, C_real, C_imag, log_dt, D_skip):
        L = u.shape[1]
        dt = torch.exp(log_dt)
        A = -torch.exp(log_A_real) + 1j * A_imag
        C = (C_real + 1j * C_imag) * dt[:, None]
        pos = (lambda x, dt: x.to(dt))(torch.arange(L), log_dt.dtype)
        P = torch.exp((A * dt[:, None])[:, :, None] * pos[None, None, :])
        K = 2.0 * torch.einsum("dn,dnl->dl", C, P).real
        L2 = 2 * L
        u_t = (lambda x, *d: x.permute(*d))(u, 0, 2, 1)
        Kf = (lambda x, *a, **k: torch.fft.rfft(x.float(), *a, **k))(K, L2)
        Uf = (lambda x, *a, **k: torch.fft.rfft(x.float(), *a, **k))(u_t, L2)
        y = (lambda x, *a, **k: torch.fft.irfft(x, *a, **k).to(torch.bfloat16))(Uf * Kf[None, :, :], L2)[:, :, :L]
        y = (lambda x, *d: x.permute(*d))(y, 0, 2, 1)
        return y + u * D_skip[None, None, :]

    def _B_ref(x, Lambda_re, Lambda_im, B_re, B_im, C_re, C_im, log_dt, Dskip):
        Bsz, L, H = x.shape
        Lam = Lambda_re + 1j * Lambda_im
        Bmat = B_re + 1j * B_im
        Cmat = C_re + 1j * C_im
        dt = torch.exp(log_dt)
        Lam_bar = torch.exp(dt * Lam)
        B_bar = ((Lam_bar - 1.0) / Lam)[:, None] * Bmat
        Bu = torch.einsum("bld,pd->blp", x + 0j, B_bar)
        h = torch.zeros_like(Bu[:, 0, :])
        hs = []
        for t in range(L):
            h = Lam_bar[None, :] * h + Bu[:, t, :]
            hs.append(h)
        hseq = torch.stack(hs, 1)
        y = 2.0 * torch.einsum("blp,dp->bld", hseq, Cmat).real + x * Dskip[None, None, :]
        return y

    x = A_u
    g = _sigmoid((x * gate_w).sum(-1, keepdims=True))
    a = _A_ref(x, A_log_A_real, A_A_imag, A_C_real, A_C_imag, A_log_dt, A_D_skip)
    b = _B_ref(x, B_Lambda_re, B_Lambda_im, B_B_re, B_B_im, B_C_re, B_C_im, B_log_dt, B_Dskip)
    return g * a + (1 - g) * b
```

```asm
; @launch grid=(256,1,1) block=(512,1,1) lds=163840
.amdgcn_target "amdgcn-amd-amdhsa--gfx950"
.text
.globl gated_mix__ssm_conv_s4d__ssm_conv_s5__prompt_kernel
.p2align 8
.type gated_mix__ssm_conv_s4d__ssm_conv_s5__prompt_kernel,@function
gated_mix__ssm_conv_s4d__ssm_conv_s5__prompt_kernel:
    s_load_dwordx16 s[36:51], s[0:1], 0
    s_load_dwordx16 s[52:67], s[0:1], 64
    s_load_dwordx8 s[68:75], s[0:1], 128
    s_cmp_ge_u32 s2, 256
    s_cbranch_scc1 L_END
    v_lshrrev_b32 v1, 6, v0
    s_nop 0
    v_readfirstlane_b32 s3, v1
    v_and_b32 v1, 63, v0
    s_and_b32 s30, s2, 7
    s_lshr_b32 s31, s2, 3
    s_cmp_lg_u32 s3, 7
    s_cbranch_scc1 L_NOCW
    s_getpc_b64 s[12:13]
L_PCREF2:
    s_sub_u32 s12, s12, L_PCREF2-gated_mix__ssm_conv_s4d__ssm_conv_s5__prompt_kernel
    s_subb_u32 s13, s13, 0
    s_and_b32 s13, s13, 0xffff
    s_mov_b32 s14, L_CODE_END-gated_mix__ssm_conv_s4d__ssm_conv_s5__prompt_kernel
    s_mov_b32 s15, 0x00020000
    v_lshlrev_b32 v2, 4, v1
    s_lshl_b32 s32, s31, 11
    buffer_load_dwordx4 v[248:251], v2, s[12:15], s32 offen
    buffer_load_dwordx4 v[248:251], v2, s[12:15], s32 offen offset:1024
L_NOCW:
    s_cmp_lt_u32 s31, 20
    s_cbranch_scc1 L_GEMM
    s_cmp_lt_u32 s31, 30
    s_cbranch_scc1 L_CONV
    s_branch L_GATE
L_GEMM:
    s_mul_i32 s34, s31, 52
    s_lshr_b32 s34, s34, 8
    s_mul_i32 s35, s34, 5
    s_sub_u32 s35, s31, s35
    s_lshr_b32 s93, s30, 1
    s_and_b32 s94, s30, 1
    s_lshl_b32 s30, s93, 2
    s_add_u32 s30, s30, s34
    s_mul_i32 s31, s94, 5
    s_add_u32 s31, s31, s35
    s_lshl_b32 s35, s35, 1
    s_add_u32 s35, s35, s94
    s_add_u32 s35, s35, s93
    s_mul_i32 s34, s34, 5
    s_lshr_b32 s34, s34, 1
    s_add_u32 s93, s35, s34
    s_cmp_ge_u32 s93, 10
    s_cselect_b32 s34, 10, 0
    s_sub_u32 s93, s93, s34
    s_cmp_lt_u32 s3, 4
    s_cbranch_scc1 L_COMPUTE
    s_sub_u32 s83, s3, 4
    v_lshrrev_b32 v211, 3, v1
    v_mul_u32_u24 v211, 1280, v211
    v_and_b32 v212, 7, v1
    v_lshrrev_b32 v213, 4, v1
    v_xor_b32 v212, v212, v213
    v_lshl_add_u32 v2, v212, 4, v211
    v_xor_b32 v3, 64, v2
    v_add_u32 v3, 10240, v3
    v_add_u32 v4, 20480, v2
    v_add_u32 v5, 20480, v3
    s_lshl_b32 s34, s30, 7
    s_lshl_b32 s35, s83, 5
    s_add_u32 s34, s34, s35
    s_mul_i32 s76, s34, 1280
    s_lshl_b32 s34, s31, 6
    s_and_b32 s35, s83, 1
    s_lshl_b32 s35, s35, 5
    s_add_u32 s34, s34, s35
    s_mul_i32 s77, s34, 1280
    s_lshl_b32 s81, s83, 12
    s_mov_b32 s78, s93
    s_waitcnt lgkmcnt(0)
    s_mov_b32 s4, s36
    s_and_b32 s5, s37, 0xffff
    s_mov_b32 s6, 2621440
    s_mov_b32 s7, 0x00020000
    s_mov_b32 s8, s74
    s_and_b32 s9, s75, 0xffff
    s_mov_b32 s10, 12582912
    s_mov_b32 s11, 0x00020000
    s_mov_b32 s24, s72
    s_and_b32 s25, s73, 0xffff
    s_mov_b32 s26, 256
    s_mov_b32 s27, 0x00020000
    s_cmp_ge_u32 s83, 2
    s_cselect_b32 s12, s58, s56
    s_cselect_b32 s13, s59, s57
    s_and_b32 s13, s13, 0xffff
    s_mov_b32 s14, 819200
    s_mov_b32 s15, 0x00020000
    s_lshl_b32 s79, s78, 7
    s_add_u32 s80, s79, s77
    s_add_u32 s79, s79, s76
    s_add_u32 m0, s81, 0
    s_nop 0
    buffer_load_dwordx4 v2, s[4:7], s79 offen lds
    s_add_u32 m0, s81, 65536
    s_nop 0
    buffer_load_dwordx4 v2, s[12:15], s80 offen lds
    s_add_u32 m0, s81, 1024
    s_nop 0
    buffer_load_dwordx4 v3, s[4:7], s79 offen lds
    s_add_u32 m0, s81, 66560
    s_nop 0
    buffer_load_dwordx4 v3, s[12:15], s80 offen lds
    s_add_u32 m0, s81, 2048
    s_nop 0
    buffer_load_dwordx4 v4, s[4:7], s79 offen lds
    s_add_u32 m0, s81, 67584
    s_nop 0
    buffer_load_dwordx4 v4, s[12:15], s80 offen lds
    s_add_u32 m0, s81, 3072
    s_nop 0
    buffer_load_dwordx4 v5, s[4:7], s79 offen lds
    s_add_u32 m0, s81, 68608
    s_nop 0
    buffer_load_dwordx4 v5, s[12:15], s80 offen lds
    s_add_u32 s78, s78, 1
    s_cmp_eq_u32 s78, 10
    s_cselect_b32 s78, 0, s78
    s_lshl_b32 s79, s78, 7
    s_add_u32 s80, s79, s77
    s_add_u32 s79, s79, s76
    s_add_u32 m0, s81, 16384
    s_nop 0
    buffer_load_dwordx4 v2, s[4:7], s79 offen lds
    s_add_u32 m0, s81, 81920
    s_nop 0
    buffer_load_dwordx4 v2, s[12:15], s80 offen lds
    s_add_u32 m0, s81, 17408
    s_nop 0
    buffer_load_dwordx4 v3, s[4:7], s79 offen lds
    s_add_u32 m0, s81, 82944
    s_nop 0
    buffer_load_dwordx4 v3, s[12:15], s80 offen lds
    s_add_u32 m0, s81, 18432
    s_nop 0
    buffer_load_dwordx4 v4, s[4:7], s79 offen lds
    s_add_u32 m0, s81, 83968
    s_nop 0
    buffer_load_dwordx4 v4, s[12:15], s80 offen lds
    s_add_u32 m0, s81, 19456
    s_nop 0
    buffer_load_dwordx4 v5, s[4:7], s79 offen lds
    s_add_u32 m0, s81, 84992
    s_nop 0
    buffer_load_dwordx4 v5, s[12:15], s80 offen lds
    s_add_u32 s78, s78, 1
    s_cmp_eq_u32 s78, 10
    s_cselect_b32 s78, 0, s78
    v_mov_b32 v224, 0
    v_lshlrev_b32 v225, 4, v1
    s_waitcnt vmcnt(8)
    s_barrier
    s_lshl_b32 s79, s78, 7
    s_add_u32 s80, s79, s77
    s_add_u32 s79, s79, s76
    s_add_u32 m0, s81, 32768
    s_nop 0
    buffer_load_dwordx4 v2, s[4:7], s79 offen lds
    s_add_u32 m0, s81, 98304
    s_nop 0
    buffer_load_dwordx4 v2, s[12:15], s80 offen lds
    s_add_u32 m0, s81, 33792
    s_nop 0
    buffer_load_dwordx4 v3, s[4:7], s79 offen lds
    s_add_u32 m0, s81, 99328
    s_nop 0
    buffer_load_dwordx4 v3, s[12:15], s80 offen lds
    s_add_u32 m0, s81, 34816
    s_nop 0
    buffer_load_dwordx4 v4, s[4:7], s79 offen lds
    s_add_u32 m0, s81, 100352
    s_nop 0
    buffer_load_dwordx4 v4, s[12:15], s80 offen lds
    s_add_u32 m0, s81, 35840
    s_nop 0
    buffer_load_dwordx4 v5, s[4:7], s79 offen lds
    s_add_u32 m0, s81, 101376
    s_nop 0
    buffer_load_dwordx4 v5, s[12:15], s80 offen lds
    s_add_u32 s78, s78, 1
    s_cmp_eq_u32 s78, 10
    s_cselect_b32 s78, 0, s78
    s_waitcnt vmcnt(8)
    s_barrier
    s_lshl_b32 s79, s78, 7
    s_add_u32 s80, s79, s77
    s_add_u32 s79, s79, s76
    s_add_u32 m0, s81, 49152
    s_nop 0
    buffer_load_dwordx4 v2, s[4:7], s79 offen lds
    s_add_u32 m0, s81, 114688
    s_nop 0
    buffer_load_dwordx4 v2, s[12:15], s80 offen lds
    s_add_u32 m0, s81, 50176
    s_nop 0
    buffer_load_dwordx4 v3, s[4:7], s79 offen lds
    s_add_u32 m0, s81, 115712
    s_nop 0
    buffer_load_dwordx4 v3, s[12:15], s80 offen lds
    s_add_u32 m0, s81, 51200
    s_nop 0
    buffer_load_dwordx4 v4, s[4:7], s79 offen lds
    s_add_u32 m0, s81, 116736
    s_nop 0
    buffer_load_dwordx4 v4, s[12:15], s80 offen lds
    s_add_u32 m0, s81, 52224
    s_nop 0
    buffer_load_dwordx4 v5, s[4:7], s79 offen lds
    s_add_u32 m0, s81, 117760
    s_nop 0
    buffer_load_dwordx4 v5, s[12:15], s80 offen lds
    s_add_u32 s78, s78, 1
    s_cmp_eq_u32 s78, 10
    s_cselect_b32 s78, 0, s78
    s_waitcnt vmcnt(8)
    s_barrier
    s_lshl_b32 s79, s78, 7
    s_add_u32 s80, s79, s77
    s_add_u32 s79, s79, s76
    s_add_u32 m0, s81, 0
    s_nop 0
    buffer_load_dwordx4 v2, s[4:7], s79 offen lds
    s_add_u32 m0, s81, 65536
    s_nop 0
    buffer_load_dwordx4 v2, s[12:15], s80 offen lds
    s_add_u32 m0, s81, 1024
    s_nop 0
    buffer_load_dwordx4 v3, s[4:7], s79 offen lds
    s_add_u32 m0, s81, 66560
    s_nop 0
    buffer_load_dwordx4 v3, s[12:15], s80 offen lds
    s_add_u32 m0, s81, 2048
    s_nop 0
    buffer_load_dwordx4 v4, s[4:7], s79 offen lds
    s_add_u32 m0, s81, 67584
    s_nop 0
    buffer_load_dwordx4 v4, s[12:15], s80 offen lds
    s_add_u32 m0, s81, 3072
    s_nop 0
    buffer_load_dwordx4 v5, s[4:7], s79 offen lds
    s_add_u32 m0, s81, 68608
    s_nop 0
    buffer_load_dwordx4 v5, s[12:15], s80 offen lds
    s_add_u32 s78, s78, 1
    s_cmp_eq_u32 s78, 10
    s_cselect_b32 s78, 0, s78
    s_waitcnt vmcnt(8)
    s_barrier
    s_lshl_b32 s79, s78, 7
    s_add_u32 s80, s79, s77
    s_add_u32 s79, s79, s76
    s_add_u32 m0, s81, 16384
    s_nop 0
    buffer_load_dwordx4 v2, s[4:7], s79 offen lds
    s_add_u32 m0, s81, 81920
    s_nop 0
    buffer_load_dwordx4 v2, s[12:15], s80 offen lds
    s_add_u32 m0, s81, 17408
    s_nop 0
    buffer_load_dwordx4 v3, s[4:7], s79 offen lds
    s_add_u32 m0, s81, 82944
    s_nop 0
    buffer_load_dwordx4 v3, s[12:15], s80 offen lds
    s_add_u32 m0, s81, 18432
    s_nop 0
    buffer_load_dwordx4 v4, s[4:7], s79 offen lds
    s_add_u32 m0, s81, 83968
    s_nop 0
    buffer_load_dwordx4 v4, s[12:15], s80 offen lds
    s_add_u32 m0, s81, 19456
    s_nop 0
    buffer_load_dwordx4 v5, s[4:7], s79 offen lds
    s_add_u32 m0, s81, 84992
    s_nop 0
    buffer_load_dwordx4 v5, s[12:15], s80 offen lds
    s_add_u32 s78, s78, 1
    s_cmp_eq_u32 s78, 10
    s_cselect_b32 s78, 0, s78
    s_waitcnt vmcnt(8)
    s_barrier
    s_lshl_b32 s79, s78, 7
    s_add_u32 s80, s79, s77
    s_add_u32 s79, s79, s76
    s_add_u32 m0, s81, 32768
    s_nop 0
    buffer_load_dwordx4 v2, s[4:7], s79 offen lds
    s_add_u32 m0, s81, 98304
    s_nop 0
    buffer_load_dwordx4 v2, s[12:15], s80 offen lds
    s_add_u32 m0, s81, 33792
    s_nop 0
    buffer_load_dwordx4 v3, s[4:7], s79 offen lds
    s_add_u32 m0, s81, 99328
    s_nop 0
    buffer_load_dwordx4 v3, s[12:15], s80 offen lds
    s_add_u32 m0, s81, 34816
    s_nop 0
    buffer_load_dwordx4 v4, s[4:7], s79 offen lds
    s_add_u32 m0, s81, 100352
    s_nop 0
    buffer_load_dwordx4 v4, s[12:15], s80 offen lds
    s_add_u32 m0, s81, 35840
    s_nop 0
    buffer_load_dwordx4 v5, s[4:7], s79 offen lds
    s_add_u32 m0, s81, 101376
    s_nop 0
    buffer_load_dwordx4 v5, s[12:15], s80 offen lds
    s_add_u32 s78, s78, 1
    s_cmp_eq_u32 s78, 10
    s_cselect_b32 s78, 0, s78
    s_waitcnt vmcnt(8)
    s_barrier
    s_lshl_b32 s79, s78, 7
    s_add_u32 s80, s79, s77
    s_add_u32 s79, s79, s76
    s_add_u32 m0, s81, 49152
    s_nop 0
    buffer_load_dwordx4 v2, s[4:7], s79 offen lds
    s_add_u32 m0, s81, 114688
    s_nop 0
    buffer_load_dwordx4 v2, s[12:15], s80 offen lds
    s_add_u32 m0, s81, 50176
    s_nop 0
    buffer_load_dwordx4 v3, s[4:7], s79 offen lds
    s_add_u32 m0, s81, 115712
    s_nop 0
    buffer_load_dwordx4 v3, s[12:15], s80 offen lds
    s_add_u32 m0, s81, 51200
    s_nop 0
    buffer_load_dwordx4 v4, s[4:7], s79 offen lds
    s_add_u32 m0, s81, 116736
    s_nop 0
    buffer_load_dwordx4 v4, s[12:15], s80 offen lds
    s_add_u32 m0, s81, 52224
    s_nop 0
    buffer_load_dwordx4 v5, s[4:7], s79 offen lds
    s_add_u32 m0, s81, 117760
    s_nop 0
    buffer_load_dwordx4 v5, s[12:15], s80 offen lds
    s_add_u32 s78, s78, 1
    s_cmp_eq_u32 s78, 10
    s_cselect_b32 s78, 0, s78
    s_waitcnt vmcnt(8)
    s_barrier
    s_lshl_b32 s79, s78, 7
    s_add_u32 s80, s79, s77
    s_add_u32 s79, s79, s76
    s_add_u32 m0, s81, 0
    s_nop 0
    buffer_load_dwordx4 v2, s[4:7], s79 offen lds
    s_add_u32 m0, s81, 65536
    s_nop 0
    buffer_load_dwordx4 v2, s[12:15], s80 offen lds
    s_add_u32 m0, s81, 1024
    s_nop 0
    buffer_load_dwordx4 v3, s[4:7], s79 offen lds
    s_add_u32 m0, s81, 66560
    s_nop 0
    buffer_load_dwordx4 v3, s[12:15], s80 offen lds
    s_add_u32 m0, s81, 2048
    s_nop 0
    buffer_load_dwordx4 v4, s[4:7], s79 offen lds
    s_add_u32 m0, s81, 67584
    s_nop 0
    buffer_load_dwordx4 v4, s[12:15], s80 offen lds
    s_add_u32 m0, s81, 3072
    s_nop 0
    buffer_load_dwordx4 v5, s[4:7], s79 offen lds
    s_add_u32 m0, s81, 68608
    s_nop 0
    buffer_load_dwordx4 v5, s[12:15], s80 offen lds
    s_add_u32 s78, s78, 1
    s_cmp_eq_u32 s78, 10
    s_cselect_b32 s78, 0, s78
    s_waitcnt vmcnt(8)
    s_barrier
    s_lshl_b32 s79, s78, 7
    s_add_u32 s80, s79, s77
    s_add_u32 s79, s79, s76
    s_add_u32 m0, s81, 16384
    s_nop 0
    buffer_load_dwordx4 v2, s[4:7], s79 offen lds
    s_add_u32 m0, s81, 81920
    s_nop 0
    buffer_load_dwordx4 v2, s[12:15], s80 offen lds
    s_add_u32 m0, s81, 17408
    s_nop 0
    buffer_load_dwordx4 v3, s[4:7], s79 offen lds
    s_add_u32 m0, s81, 82944
    s_nop 0
    buffer_load_dwordx4 v3, s[12:15], s80 offen lds
    s_add_u32 m0, s81, 18432
    s_nop 0
    buffer_load_dwordx4 v4, s[4:7], s79 offen lds
    s_add_u32 m0, s81, 83968
    s_nop 0
    buffer_load_dwordx4 v4, s[12:15], s80 offen lds
    s_add_u32 m0, s81, 19456
    s_nop 0
    buffer_load_dwordx4 v5, s[4:7], s79 offen lds
    s_add_u32 m0, s81, 84992
    s_nop 0
    buffer_load_dwordx4 v5, s[12:15], s80 offen lds
    s_add_u32 s78, s78, 1
    s_cmp_eq_u32 s78, 10
    s_cselect_b32 s78, 0, s78
    s_waitcnt vmcnt(8)
    s_barrier
    s_waitcnt vmcnt(0)
    s_barrier
    s_barrier
    s_mov_b32 s16, s60
    s_and_b32 s17, s61, 0xffff
    s_mov_b32 s18, 819200
    s_mov_b32 s19, 0x00020000
    s_mov_b32 s20, s62
    s_and_b32 s21, s63, 0xffff
    s_mov_b32 s22, 819200
    s_mov_b32 s23, 0x00020000
    buffer_load_dwordx2 v[204:205], v224, s[24:27], 0 offen sc1
    v_mov_b32 v210, 148480
    s_mov_b32 s82, 2000000
SPIN_1:
    ds_read_b32 v212, v210
    s_waitcnt lgkmcnt(0)
    v_readfirstlane_b32 s87, v212
    s_nop 0
    s_cmp_ge_u32 s87, 4
    s_cbranch_scc1 SPOK_2
    s_sleep 1
    s_sub_u32 s82, s82, 1
    s_cbranch_scc0 SPIN_1
SPOK_2:
    v_lshrrev_b32 v206, 3, v1
    v_mul_u32_u24 v206, 1280, v206
    v_and_b32 v207, 7, v1
    v_lshl_add_u32 v206, v207, 4, v206
    s_lshl_b32 s35, s31, 7
    s_add_u32 s34, s76, s35
    s_add_u32 s86, s81, 73728
    s_add_u32 m0, s86, 0
    s_add_u32 s35, s34, 0
    buffer_load_dwordx4 v206, s[4:7], s35 offen lds
    s_add_u32 m0, s86, 1024
    s_add_u32 s35, s34, 10240
    buffer_load_dwordx4 v206, s[4:7], s35 offen lds
    s_add_u32 m0, s86, 2048
    s_add_u32 s35, s34, 20480
    buffer_load_dwordx4 v206, s[4:7], s35 offen lds
    s_add_u32 m0, s86, 3072
    s_add_u32 s35, s34, 30720
    buffer_load_dwordx4 v206, s[4:7], s35 offen lds
    s_lshl_b32 s34, s31, 6
    s_lshl_b32 s35, s83, 4
    s_add_u32 s34, s34, s35
    s_mul_i32 s77, s34, 1280
    s_mov_b32 s91, s31
    s_mov_b32 s94, s91
    s_lshl_b32 s92, s83, 11
    s_lshl_b32 s80, s91, 7
    s_add_u32 s80, s80, s77
    s_add_u32 m0, s92, 0
    s_nop 0
    buffer_load_dwordx4 v2, s[16:19], s80 offen lds
    s_add_u32 m0, s92, 1024
    s_nop 0
    buffer_load_dwordx4 v3, s[16:19], s80 offen lds
    s_waitcnt vmcnt(8)
    s_lshl_b32 s80, s91, 7
    s_add_u32 s80, s80, s77
    s_add_u32 m0, s92, 8192
    s_nop 0
    buffer_load_dwordx4 v2, s[20:23], s80 offen lds
    s_add_u32 m0, s92, 9216
    s_nop 0
    buffer_load_dwordx4 v3, s[20:23], s80 offen lds
    s_add_u32 s91, s91, 1
    s_cmp_eq_u32 s91, 10
    s_cselect_b32 s91, 0, s91
    s_waitcnt vmcnt(8)
    s_lshl_b32 s80, s91, 7
    s_add_u32 s80, s80, s77
    s_add_u32 m0, s92, 16384
    s_nop 0
    buffer_load_dwordx4 v2, s[16:19], s80 offen lds
    s_add_u32 m0, s92, 17408
    s_nop 0
    buffer_load_dwordx4 v3, s[16:19], s80 offen lds
    s_waitcnt vmcnt(8)
    s_lshl_b32 s80, s91, 7
    s_add_u32 s80, s80, s77
    s_add_u32 m0, s92, 24576
    s_nop 0
    buffer_load_dwordx4 v2, s[20:23], s80 offen lds
    s_add_u32 m0, s92, 25600
    s_nop 0
    buffer_load_dwordx4 v3, s[20:23], s80 offen lds
    s_add_u32 s91, s91, 1
    s_cmp_eq_u32 s91, 10
    s_cselect_b32 s91, 0, s91
    s_waitcnt vmcnt(8)
    v_mov_b32 v210, 148488
    v_mov_b32 v211, 1
    s_mov_b64 s[88:89], exec
    s_mov_b64 exec, 1
    ds_add_u32 v210, v211
    s_mov_b64 exec, s[88:89]
    s_lshl_b32 s80, s91, 7
    s_add_u32 s80, s80, s77
    s_add_u32 m0, s92, 32768
    s_nop 0
    buffer_load_dwordx4 v2, s[16:19], s80 offen lds
    s_add_u32 m0, s92, 33792
    s_nop 0
    buffer_load_dwordx4 v3, s[16:19], s80 offen lds
    s_waitcnt vmcnt(8)
    s_lshl_b32 s80, s91, 7
    s_add_u32 s80, s80, s77
    s_add_u32 m0, s92, 40960
    s_nop 0
    buffer_load_dwordx4 v2, s[20:23], s80 offen lds
    s_add_u32 m0, s92, 41984
    s_nop 0
    buffer_load_dwordx4 v3, s[20:23], s80 offen lds
    s_add_u32 s91, s91, 1
    s_cmp_eq_u32 s91, 10
    s_cselect_b32 s91, 0, s91
    s_waitcnt vmcnt(8)
    s_lshl_b32 s80, s91, 7
    s_add_u32 s80, s80, s77
    s_add_u32 m0, s92, 49152
    s_nop 0
    buffer_load_dwordx4 v2, s[16:19], s80 offen lds
    s_add_u32 m0, s92, 50176
    s_nop 0
    buffer_load_dwordx4 v3, s[16:19], s80 offen lds
    s_waitcnt vmcnt(8)
    s_lshl_b32 s80, s91, 7
    s_add_u32 s80, s80, s77
    s_add_u32 m0, s92, 57344
    s_nop 0
    buffer_load_dwordx4 v2, s[20:23], s80 offen lds
    s_add_u32 m0, s92, 58368
    s_nop 0
    buffer_load_dwordx4 v3, s[20:23], s80 offen lds
    s_add_u32 s91, s91, 1
    s_cmp_eq_u32 s91, 10
    s_cselect_b32 s91, 0, s91
    s_waitcnt vmcnt(8)
    s_lshl_b32 s80, s91, 7
    s_add_u32 s80, s80, s77
    s_add_u32 m0, s92, 65536
    s_nop 0
    buffer_load_dwordx4 v2, s[16:19], s80 offen lds
    s_add_u32 m0, s92, 66560
    s_nop 0
    buffer_load_dwordx4 v3, s[16:19], s80 offen lds
    s_waitcnt vmcnt(8)
    s_lshl_b32 s80, s91, 7
    s_add_u32 s80, s80, s77
    s_add_u32 m0, s92, 104448
    s_nop 0
    buffer_load_dwordx4 v2, s[20:23], s80 offen lds
    s_add_u32 m0, s92, 105472
    s_nop 0
    buffer_load_dwordx4 v3, s[20:23], s80 offen lds
    s_add_u32 s91, s91, 1
    s_cmp_eq_u32 s91, 10
    s_cselect_b32 s91, 0, s91
    s_waitcnt vmcnt(8)
    s_lshl_b32 s80, s91, 7
    s_add_u32 s80, s80, s77
    s_add_u32 m0, s92, 112640
    s_nop 0
    buffer_load_dwordx4 v2, s[16:19], s80 offen lds
    s_add_u32 m0, s92, 113664
    s_nop 0
    buffer_load_dwordx4 v3, s[16:19], s80 offen lds
    s_waitcnt vmcnt(8)
    s_lshl_b32 s80, s91, 7
    s_add_u32 s80, s80, s77
    s_add_u32 m0, s92, 120832
    s_nop 0
    buffer_load_dwordx4 v2, s[20:23], s80 offen lds
    s_add_u32 m0, s92, 121856
    s_nop 0
    buffer_load_dwordx4 v3, s[20:23], s80 offen lds
    s_add_u32 s91, s91, 1
    s_cmp_eq_u32 s91, 10
    s_cselect_b32 s91, 0, s91
    s_waitcnt vmcnt(8)
    s_lshl_b32 s80, s91, 7
    s_add_u32 s80, s80, s77
    s_add_u32 m0, s92, 129024
    s_nop 0
    buffer_load_dwordx4 v2, s[16:19], s80 offen lds
    s_add_u32 m0, s92, 130048
    s_nop 0
    buffer_load_dwordx4 v3, s[16:19], s80 offen lds
    s_waitcnt vmcnt(8)
    s_lshl_b32 s80, s91, 7
    s_add_u32 s80, s80, s77
    s_add_u32 m0, s92, 137216
    s_nop 0
    buffer_load_dwordx4 v2, s[20:23], s80 offen lds
    s_add_u32 m0, s92, 138240
    s_nop 0
    buffer_load_dwordx4 v3, s[20:23], s80 offen lds
    s_add_u32 s91, s91, 1
    s_cmp_eq_u32 s91, 10
    s_cselect_b32 s91, 0, s91
    s_waitcnt vmcnt(8)
    s_waitcnt vmcnt(0)
    v_mov_b32 v210, 148500
    v_mov_b32 v211, 1
    s_mov_b64 s[88:89], exec
    s_mov_b64 exec, 1
    ds_add_u32 v210, v211
    s_mov_b64 exec, s[88:89]
    s_mov_b32 s82, 100000
    s_waitcnt vmcnt(0)
LNP_3:
    v_readfirstlane_b32 s28, v204
    v_readfirstlane_b32 s29, v205
    s_nop 0
    s_cmp_lg_u32 s28, 0
    s_cbranch_scc1 LNOK_4
    s_sub_u32 s82, s82, 1
    s_cbranch_scc1 L_END
    buffer_load_dwordx2 v[204:205], v224, s[24:27], 0 offen sc1
    s_waitcnt vmcnt(0)
    s_branch LNP_3
LNOK_4:
    s_mul_i32 s34, s30, 327680
    s_lshl_b32 s35, s83, 12
    s_add_u32 s34, s34, s35
    s_add_u32 s76, s34, 1048576
    s_mov_b32 s78, s94
    s_mul_i32 s81, s83, 4352
    v_mov_b32 v210, 148504
    s_mov_b32 s82, 2000000
SPIN_5:
    ds_read_b32 v212, v210
    s_waitcnt lgkmcnt(0)
    v_readfirstlane_b32 s87, v212
    s_nop 0
    s_cmp_ge_u32 s87, 4
    s_cbranch_scc1 SPOK_6
    s_sleep 1
    s_sub_u32 s82, s82, 1
    s_cbranch_scc0 SPIN_5
SPOK_6:
    s_lshl_b32 s79, s78, 14
    s_add_u32 s79, s79, s76
    s_add_u32 m0, s81, 0
    s_nop 0
    buffer_load_dwordx4 v225, s[8:11], s79 offen offset:0 sc1 lds
    s_add_u32 m0, s81, 64
    s_nop 0
    buffer_load_dwordx4 v225, s[8:11], s79 offen offset:1024 sc1 lds
    s_add_u32 m0, s81, 128
    s_nop 0
    buffer_load_dwordx4 v225, s[8:11], s79 offen offset:2048 sc1 lds
    s_add_u32 m0, s81, 192
    s_nop 0
    buffer_load_dwordx4 v225, s[8:11], s79 offen offset:3072 sc1 lds
    s_lshl_b32 s79, s78, 14
    s_add_u32 s79, s79, s76
    s_add_u32 s79, s79, 163840
    s_add_u32 m0, s81, 17408
    s_nop 0
    buffer_load_dwordx4 v225, s[8:11], s79 offen offset:0 sc1 lds
    s_add_u32 m0, s81, 17472
    s_nop 0
    buffer_load_dwordx4 v225, s[8:11], s79 offen offset:1024 sc1 lds
    s_add_u32 m0, s81, 17536
    s_nop 0
    buffer_load_dwordx4 v225, s[8:11], s79 offen offset:2048 sc1 lds
    s_add_u32 m0, s81, 17600
    s_nop 0
    buffer_load_dwordx4 v225, s[8:11], s79 offen offset:3072 sc1 lds
    s_add_u32 s78, s78, 1
    s_cmp_eq_u32 s78, 10
    s_cselect_b32 s78, 0, s78
    s_waitcnt vmcnt(4)
    s_barrier
    s_waitcnt vmcnt(0)
    s_barrier
    v_mov_b32 v210, 148492
    s_cmp_lg_u32 s83, 0
    s_cbranch_scc1 HP1_7
    s_lshl_b32 s34, s30, 7
    s_add_u32 s34, s34, 262144
    v_lshlrev_b32 v206, 3, v1
    v_cmp_gt_u32 vcc, 10, v1
    s_and_saveexec_b64 s[88:89], vcc
    s_mov_b32 s82, 100000
FPOLL_9:
    buffer_load_dwordx2 v[208:209], v206, s[8:11], s34 offen sc1
    s_waitcnt vmcnt(0)
    v_cmp_ne_u32 vcc, s28, v208
    s_mov_b64 s[84:85], vcc
    v_cmp_ne_u32 vcc, s29, v209
    s_or_b64 s[84:85], s[84:85], vcc
    s_cmp_eq_u64 s[84:85], 0
    s_cbranch_scc1 FDONE_10
    s_sleep 2
    s_sub_u32 s82, s82, 1
    s_cbranch_scc0 FPOLL_9
    s_mov_b32 s82, -1
FDONE_10:
    s_mov_b64 exec, s[88:89]
    v_mov_b32 v211, 1
    s_mov_b64 s[88:89], exec
    s_mov_b64 exec, 1
    ds_add_u32 v210, v211
    s_mov_b64 exec, s[88:89]
    s_branch HP2_8
HP1_7:
    s_cmp_lg_u32 s83, 1
    s_cbranch_scc1 GT_11
    s_lshl_b32 s34, s30, 7
    s_add_u32 s34, s34, 262224
    v_lshlrev_b32 v206, 3, v1
    v_cmp_gt_u32 vcc, 1, v1
    s_and_saveexec_b64 s[88:89], vcc
    s_mov_b32 s82, 100000
FPOLL_12:
    buffer_load_dwordx2 v[208:209], v206, s[8:11], s34 offen sc1
    s_waitcnt vmcnt(0)
    v_cmp_ne_u32 vcc, s28, v208
    s_mov_b64 s[84:85], vcc
    v_cmp_ne_u32 vcc, s29, v209
    s_or_b64 s[84:85], s[84:85], vcc
    s_cmp_eq_u64 s[84:85], 0
    s_cbranch_scc1 FDONE_13
    s_sleep 2
    s_sub_u32 s82, s82, 1
    s_cbranch_scc0 FPOLL_12
    s_mov_b32 s82, -1
FDONE_13:
    s_mov_b64 exec, s[88:89]
    s_lshl_b32 s34, s30, 10
    s_add_u32 s34, s34, 327680
    s_mov_b32 m0, 147456
    s_nop 0
    buffer_load_dwordx4 v225, s[8:11], s34 offen sc1 lds
GT_11:
    v_mov_b32 v210, 148492
    s_mov_b32 s82, 2000000
SPIN_14:
    ds_read_b32 v212, v210
    s_waitcnt lgkmcnt(0)
    v_readfirstlane_b32 s87, v212
    s_nop 0
    s_cmp_ge_u32 s87, 1
    s_cbranch_scc1 SPOK_15
    s_sleep 1
    s_sub_u32 s82, s82, 1
    s_cbranch_scc0 SPIN_14
SPOK_15:
HP2_8:
    s_lshl_b32 s79, s78, 14
    s_add_u32 s79, s79, s76
    s_add_u32 m0, s81, 34816
    s_nop 0
    buffer_load_dwordx4 v225, s[8:11], s79 offen offset:0 sc1 lds
    s_add_u32 m0, s81, 34880
    s_nop 0
    buffer_load_dwordx4 v225, s[8:11], s79 offen offset:1024 sc1 lds
    s_add_u32 m0, s81, 34944
    s_nop 0
    buffer_load_dwordx4 v225, s[8:11], s79 offen offset:2048 sc1 lds
    s_add_u32 m0, s81, 35008
    s_nop 0
    buffer_load_dwordx4 v225, s[8:11], s79 offen offset:3072 sc1 lds
    s_lshl_b32 s79, s78, 14
    s_add_u32 s79, s79, s76
    s_add_u32 s79, s79, 163840
    s_add_u32 m0, s81, 52224
    s_nop 0
    buffer_load_dwordx4 v225, s[8:11], s79 offen offset:0 sc1 lds
    s_add_u32 m0, s81, 52288
    s_nop 0
    buffer_load_dwordx4 v225, s[8:11], s79 offen offset:1024 sc1 lds
    s_add_u32 m0, s81, 52352
    s_nop 0
    buffer_load_dwordx4 v225, s[8:11], s79 offen offset:2048 sc1 lds
    s_add_u32 m0, s81, 52416
    s_nop 0
    buffer_load_dwordx4 v225, s[8:11], s79 offen offset:3072 sc1 lds
    s_add_u32 s78, s78, 1
    s_cmp_eq_u32 s78, 10
    s_cselect_b32 s78, 0, s78
    s_lshl_b32 s79, s78, 14
    s_add_u32 s79, s79, s76
    s_add_u32 m0, s81, 69632
    s_nop 0
    buffer_load_dwordx4 v225, s[8:11], s79 offen offset:0 sc1 lds
    s_add_u32 m0, s81, 69696
    s_nop 0
    buffer_load_dwordx4 v225, s[8:11], s79 offen offset:1024 sc1 lds
    s_add_u32 m0, s81, 69760
    s_nop 0
    buffer_load_dwordx4 v225, s[8:11], s79 offen offset:2048 sc1 lds
    s_add_u32 m0, s81, 69824
    s_nop 0
    buffer_load_dwordx4 v225, s[8:11], s79 offen offset:3072 sc1 lds
    s_lshl_b32 s79, s78, 14
    s_add_u32 s79, s79, s76
    s_add_u32 s79, s79, 163840
    s_add_u32 m0, s81, 87040
    s_nop 0
    buffer_load_dwordx4 v225, s[8:11], s79 offen offset:0 sc1 lds
    s_add_u32 m0, s81, 87104
    s_nop 0
    buffer_load_dwordx4 v225, s[8:11], s79 offen offset:1024 sc1 lds
    s_add_u32 m0, s81, 87168
    s_nop 0
    buffer_load_dwordx4 v225, s[8:11], s79 offen offset:2048 sc1 lds
    s_add_u32 m0, s81, 87232
    s_nop 0
    buffer_load_dwordx4 v225, s[8:11], s79 offen offset:3072 sc1 lds
    s_add_u32 s78, s78, 1
    s_cmp_eq_u32 s78, 10
    s_cselect_b32 s78, 0, s78
    s_mov_b32 s90, 0
    s_waitcnt vmcnt(12)
    s_barrier
    s_lshl_b32 s79, s78, 14
    s_add_u32 s79, s79, s76
    s_add_u32 m0, s81, 0
    s_nop 0
    buffer_load_dwordx4 v225, s[8:11], s79 offen offset:0 sc1 lds
    s_add_u32 m0, s81, 64
    s_nop 0
    buffer_load_dwordx4 v225, s[8:11], s79 offen offset:1024 sc1 lds
    s_add_u32 m0, s81, 128
    s_nop 0
    buffer_load_dwordx4 v225, s[8:11], s79 offen offset:2048 sc1 lds
    s_add_u32 m0, s81, 192
    s_nop 0
    buffer_load_dwordx4 v225, s[8:11], s79 offen offset:3072 sc1 lds
    s_waitcnt vmcnt(12)
    s_barrier
    s_lshl_b32 s79, s78, 14
    s_add_u32 s79, s79, s76
    s_add_u32 s79, s79, 163840
    s_add_u32 m0, s81, 17408
    s_nop 0
    buffer_load_dwordx4 v225, s[8:11], s79 offen offset:0 sc1 lds
    s_add_u32 m0, s81, 17472
    s_nop 0
    buffer_load_dwordx4 v225, s[8:11], s79 offen offset:1024 sc1 lds
    s_add_u32 m0, s81, 17536
    s_nop 0
    buffer_load_dwordx4 v225, s[8:11], s79 offen offset:2048 sc1 lds
    s_add_u32 m0, s81, 17600
    s_nop 0
    buffer_load_dwordx4 v225, s[8:11], s79 offen offset:3072 sc1 lds
    s_add_u32 s78, s78, 1
    s_cmp_eq_u32 s78, 10
    s_cselect_b32 s78, 0, s78
    s_waitcnt vmcnt(12)
    s_barrier
    s_lshl_b32 s79, s78, 14
    s_add_u32 s79, s79, s76
    s_add_u32 m0, s81, 34816
    s_nop 0
    buffer_load_dwordx4 v225, s[8:11], s79 offen offset:0 sc1 lds
    s_add_u32 m0, s81, 34880
    s_nop 0
    buffer_load_dwordx4 v225, s[8:11], s79 offen offset:1024 sc1 lds
    s_add_u32 m0, s81, 34944
    s_nop 0
    buffer_load_dwordx4 v225, s[8:11], s79 offen offset:2048 sc1 lds
    s_add_u32 m0, s81, 35008
    s_nop 0
    buffer_load_dwordx4 v225, s[8:11], s79 offen offset:3072 sc1 lds
    s_waitcnt vmcnt(12)
    s_barrier
    s_lshl_b32 s79, s78, 14
    s_add_u32 s79, s79, s76
    s_add_u32 s79, s79, 163840
    s_add_u32 m0, s81, 52224
    s_nop 0
    buffer_load_dwordx4 v225, s[8:11], s79 offen offset:0 sc1 lds
    s_add_u32 m0, s81, 52288
    s_nop 0
    buffer_load_dwordx4 v225, s[8:11], s79 offen offset:1024 sc1 lds
    s_add_u32 m0, s81, 52352
    s_nop 0
    buffer_load_dwordx4 v225, s[8:11], s79 offen offset:2048 sc1 lds
    s_add_u32 m0, s81, 52416
    s_nop 0
    buffer_load_dwordx4 v225, s[8:11], s79 offen offset:3072 sc1 lds
    s_add_u32 s78, s78, 1
    s_cmp_eq_u32 s78, 10
    s_cselect_b32 s78, 0, s78
    s_waitcnt vmcnt(12)
    s_barrier
    s_lshl_b32 s79, s78, 14
    s_add_u32 s79, s79, s76
    s_add_u32 m0, s81, 69632
    s_nop 0
    buffer_load_dwordx4 v225, s[8:11], s79 offen offset:0 sc1 lds
    s_add_u32 m0, s81, 69696
    s_nop 0
    buffer_load_dwordx4 v225, s[8:11], s79 offen offset:1024 sc1 lds
    s_add_u32 m0, s81, 69760
    s_nop 0
    buffer_load_dwordx4 v225, s[8:11], s79 offen offset:2048 sc1 lds
    s_add_u32 m0, s81, 69824
    s_nop 0
    buffer_load_dwordx4 v225, s[8:11], s79 offen offset:3072 sc1 lds
    s_waitcnt vmcnt(12)
    s_barrier
    s_lshl_b32 s79, s78, 14
    s_add_u32 s79, s79, s76
    s_add_u32 s79, s79, 163840
    s_add_u32 m0, s81, 87040
    s_nop 0
    buffer_load_dwordx4 v225, s[8:11], s79 offen offset:0 sc1 lds
    s_add_u32 m0, s81, 87104
    s_nop 0
    buffer_load_dwordx4 v225, s[8:11], s79 offen offset:1024 sc1 lds
    s_add_u32 m0, s81, 87168
    s_nop 0
    buffer_load_dwordx4 v225, s[8:11], s79 offen offset:2048 sc1 lds
    s_add_u32 m0, s81, 87232
    s_nop 0
    buffer_load_dwordx4 v225, s[8:11], s79 offen offset:3072 sc1 lds
    s_add_u32 s78, s78, 1
    s_cmp_eq_u32 s78, 10
    s_cselect_b32 s78, 0, s78
    s_waitcnt vmcnt(12)
    s_barrier
    s_lshl_b32 s79, s78, 14
    s_add_u32 s79, s79, s76
    s_add_u32 m0, s81, 0
    s_nop 0
    buffer_load_dwordx4 v225, s[8:11], s79 offen offset:0 sc1 lds
    s_add_u32 m0, s81, 64
    s_nop 0
    buffer_load_dwordx4 v225, s[8:11], s79 offen offset:1024 sc1 lds
    s_add_u32 m0, s81, 128
    s_nop 0
    buffer_load_dwordx4 v225, s[8:11], s79 offen offset:2048 sc1 lds
    s_add_u32 m0, s81, 192
    s_nop 0
    buffer_load_dwordx4 v225, s[8:11], s79 offen offset:3072 sc1 lds
    s_waitcnt vmcnt(12)
    s_barrier
    s_lshl_b32 s79, s78, 14
    s_add_u32 s79, s79, s76
    s_add_u32 s79, s79, 163840
    s_add_u32 m0, s81, 17408
    s_nop 0
    buffer_load_dwordx4 v225, s[8:11], s79 offen offset:0 sc1 lds
    s_add_u32 m0, s81, 17472
    s_nop 0
    buffer_load_dwordx4 v225, s[8:11], s79 offen offset:1024 sc1 lds
    s_add_u32 m0, s81, 17536
    s_nop 0
    buffer_load_dwordx4 v225, s[8:11], s79 offen offset:2048 sc1 lds
    s_add_u32 m0, s81, 17600
    s_nop 0
    buffer_load_dwordx4 v225, s[8:11], s79 offen offset:3072 sc1 lds
    s_add_u32 s78, s78, 1
    s_cmp_eq_u32 s78, 10
    s_cselect_b32 s78, 0, s78
    s_waitcnt vmcnt(12)
    s_barrier
    s_lshl_b32 s79, s78, 14
    s_add_u32 s79, s79, s76
    s_add_u32 m0, s81, 34816
    s_nop 0
    buffer_load_dwordx4 v225, s[8:11], s79 offen offset:0 sc1 lds
    s_add_u32 m0, s81, 34880
    s_nop 0
    buffer_load_dwordx4 v225, s[8:11], s79 offen offset:1024 sc1 lds
    s_add_u32 m0, s81, 34944
    s_nop 0
    buffer_load_dwordx4 v225, s[8:11], s79 offen offset:2048 sc1 lds
    s_add_u32 m0, s81, 35008
    s_nop 0
    buffer_load_dwordx4 v225, s[8:11], s79 offen offset:3072 sc1 lds
    s_waitcnt vmcnt(12)
    s_barrier
    s_lshl_b32 s80, s91, 7
    s_add_u32 s80, s80, s77
    s_add_u32 m0, s92, 104448
    s_nop 0
    buffer_load_dwordx4 v2, s[16:19], s80 offen lds
    s_add_u32 m0, s92, 105472
    s_nop 0
    buffer_load_dwordx4 v3, s[16:19], s80 offen lds
    s_lshl_b32 s79, s78, 14
    s_add_u32 s79, s79, s76
    s_add_u32 s79, s79, 163840
    s_add_u32 m0, s81, 52224
    s_nop 0
    buffer_load_dwordx4 v225, s[8:11], s79 offen offset:0 sc1 lds
    s_add_u32 m0, s81, 52288
    s_nop 0
    buffer_load_dwordx4 v225, s[8:11], s79 offen offset:1024 sc1 lds
    s_add_u32 m0, s81, 52352
    s_nop 0
    buffer_load_dwordx4 v225, s[8:11], s79 offen offset:2048 sc1 lds
    s_add_u32 m0, s81, 52416
    s_nop 0
    buffer_load_dwordx4 v225, s[8:11], s79 offen offset:3072 sc1 lds
    s_add_u32 s78, s78, 1
    s_cmp_eq_u32 s78, 10
    s_cselect_b32 s78, 0, s78
    s_waitcnt vmcnt(14)
    s_barrier
    s_lshl_b32 s80, s91, 7
    s_add_u32 s80, s80, s77
    s_add_u32 m0, s92, 112640
    s_nop 0
    buffer_load_dwordx4 v2, s[20:23], s80 offen lds
    s_add_u32 m0, s92, 113664
    s_nop 0
    buffer_load_dwordx4 v3, s[20:23], s80 offen lds
    s_add_u32 s91, s91, 1
    s_cmp_eq_u32 s91, 10
    s_cselect_b32 s91, 0, s91
    s_lshl_b32 s79, s78, 14
    s_add_u32 s79, s79, s76
    s_add_u32 m0, s81, 69632
    s_nop 0
    buffer_load_dwordx4 v225, s[8:11], s79 offen offset:0 sc1 lds
    s_add_u32 m0, s81, 69696
    s_nop 0
    buffer_load_dwordx4 v225, s[8:11], s79 offen offset:1024 sc1 lds
    s_add_u32 m0, s81, 69760
    s_nop 0
    buffer_load_dwordx4 v225, s[8:11], s79 offen offset:2048 sc1 lds
    s_add_u32 m0, s81, 69824
    s_nop 0
    buffer_load_dwordx4 v225, s[8:11], s79 offen offset:3072 sc1 lds
    v_lshlrev_b32 v206, 3, v1
    s_lshl_b32 s34, s31, 7
    s_add_u32 s34, s34, 266240
    v_add_u32 v220, s34, v206
    v_lshrrev_b32 v206, 4, v1
    v_and_b32 v207, 15, v1
    s_lshl_b32 s34, s31, 6
    s_lshl_b32 s35, s83, 4
    s_add_u32 s34, s34, s35
    s_lshl_b32 s34, s34, 12
    s_lshl_b32 s35, s30, 8
    s_add_u32 s34, s34, s35
    s_add_u32 s95, s34, 6291456
    s_lshl_b32 s101, s83, 12
    s_add_u32 s101, s101, 34816
    v_add_u32 v208, 0, v206
    v_xor_b32 v208, v208, v207
    v_lshlrev_b32 v208, 4, v208
    v_lshl_add_u32 v236, v206, 12, v208
    v_add_u32 v208, 4, v206
    v_xor_b32 v208, v208, v207
    v_lshlrev_b32 v208, 4, v208
    v_lshl_add_u32 v237, v206, 12, v208
    v_add_u32 v208, 8, v206
    v_xor_b32 v208, v208, v207
    v_lshlrev_b32 v208, 4, v208
    v_lshl_add_u32 v238, v206, 12, v208
    v_add_u32 v208, 12, v206
    v_xor_b32 v208, v208, v207
    v_lshlrev_b32 v208, 4, v208
    v_lshl_add_u32 v239, v206, 12, v208
    s_waitcnt vmcnt(16)
    s_barrier
    s_lshl_b32 s80, s91, 7
    s_add_u32 s80, s80, s77
    s_add_u32 m0, s92, 120832
    s_nop 0
    buffer_load_dwordx4 v2, s[16:19], s80 offen lds
    s_add_u32 m0, s92, 121856
    s_nop 0
    buffer_load_dwordx4 v3, s[16:19], s80 offen lds
    s_lshl_b32 s79, s78, 14
    s_add_u32 s79, s79, s76
    s_add_u32 s79, s79, 163840
    s_add_u32 m0, s81, 87040
    s_nop 0
    buffer_load_dwordx4 v225, s[8:11], s79 offen offset:0 sc1 lds
    s_add_u32 m0, s81, 87104
    s_nop 0
    buffer_load_dwordx4 v225, s[8:11], s79 offen offset:1024 sc1 lds
    s_add_u32 m0, s81, 87168
    s_nop 0
    buffer_load_dwordx4 v225, s[8:11], s79 offen offset:2048 sc1 lds
    s_add_u32 m0, s81, 87232
    s_nop 0
    buffer_load_dwordx4 v225, s[8:11], s79 offen offset:3072 sc1 lds
    s_add_u32 s78, s78, 1
    s_cmp_eq_u32 s78, 10
    s_cselect_b32 s78, 0, s78
    s_waitcnt vmcnt(16)
    s_barrier
    s_lshl_b32 s80, s91, 7
    s_add_u32 s80, s80, s77
    s_add_u32 m0, s92, 129024
    s_nop 0
    buffer_load_dwordx4 v2, s[20:23], s80 offen lds
    s_add_u32 m0, s92, 130048
    s_nop 0
    buffer_load_dwordx4 v3, s[20:23], s80 offen lds
    s_add_u32 s91, s91, 1
    s_cmp_eq_u32 s91, 10
    s_cselect_b32 s91, 0, s91
    s_lshl_b32 s79, s78, 14
    s_add_u32 s79, s79, s76
    s_add_u32 m0, s81, 0
    s_nop 0
    buffer_load_dwordx4 v225, s[8:11], s79 offen offset:0 sc1 lds
    s_add_u32 m0, s81, 64
    s_nop 0
    buffer_load_dwordx4 v225, s[8:11], s79 offen offset:1024 sc1 lds
    s_add_u32 m0, s81, 128
    s_nop 0
    buffer_load_dwordx4 v225, s[8:11], s79 offen offset:2048 sc1 lds
    s_add_u32 m0, s81, 192
    s_nop 0
    buffer_load_dwordx4 v225, s[8:11], s79 offen offset:3072 sc1 lds
    s_waitcnt vmcnt(16)
    s_barrier
    s_lshl_b32 s80, s91, 7
    s_add_u32 s80, s80, s77
    s_add_u32 m0, s92, 137216
    s_nop 0
    buffer_load_dwordx4 v2, s[16:19], s80 offen lds
    s_add_u32 m0, s92, 138240
    s_nop 0
    buffer_load_dwordx4 v3, s[16:19], s80 offen lds
    s_lshl_b32 s79, s78, 14
    s_add_u32 s79, s79, s76
    s_add_u32 s79, s79, 163840
    s_add_u32 m0, s81, 17408
    s_nop 0
    buffer_load_dwordx4 v225, s[8:11], s79 offen offset:0 sc1 lds
    s_add_u32 m0, s81, 17472
    s_nop 0
    buffer_load_dwordx4 v225, s[8:11], s79 offen offset:1024 sc1 lds
    s_add_u32 m0, s81, 17536
    s_nop 0
    buffer_load_dwordx4 v225, s[8:11], s79 offen offset:2048 sc1 lds
    s_add_u32 m0, s81, 17600
    s_nop 0
    buffer_load_dwordx4 v225, s[8:11], s79 offen offset:3072 sc1 lds
    s_add_u32 s78, s78, 1
    s_cmp_eq_u32 s78, 10
    s_cselect_b32 s78, 0, s78
    s_mov_b64 s[88:89], exec
    s_mov_b64 exec, 0xff
    buffer_load_dwordx2 v[216:217], v220, s[8:11], 0 offen sc1
    s_mov_b64 exec, s[88:89]
    s_waitcnt vmcnt(17)
    s_barrier
    s_lshl_b32 s80, s91, 7
    s_add_u32 s80, s80, s77
    s_add_u32 m0, s92, 104448
    s_nop 0
    buffer_load_dwordx4 v2, s[20:23], s80 offen lds
    s_add_u32 m0, s92, 105472
    s_nop 0
    buffer_load_dwordx4 v3, s[20:23], s80 offen lds
    s_add_u32 s91, s91, 1
    s_cmp_eq_u32 s91, 10
    s_cselect_b32 s91, 0, s91
    s_waitcnt vmcnt(13)
    s_barrier
    s_waitcnt vmcnt(7)
    s_barrier
    s_waitcnt vmcnt(2)
    s_mov_b64 s[88:89], exec
    s_mov_b64 exec, 0xff
    v_cmp_ne_u64 vcc, s[28:29], v[216:217]
    s_mov_b64 exec, s[88:89]
    s_cmp_lg_u64 vcc, 0
    s_cbranch_scc1 ANR_16
    s_add_u32 m0, s101, 0
    s_add_u32 s35, s95, 0
    buffer_load_dwordx4 v236, s[8:11], s35 offen sc1 lds
    s_add_u32 m0, s101, 1024
    s_add_u32 s35, s95, 16384
    buffer_load_dwordx4 v237, s[8:11], s35 offen sc1 lds
    s_add_u32 m0, s101, 2048
    s_add_u32 s35, s95, 32768
    buffer_load_dwordx4 v238, s[8:11], s35 offen sc1 lds
    s_add_u32 m0, s101, 3072
    s_add_u32 s35, s95, 49152
    buffer_load_dwordx4 v239, s[8:11], s35 offen sc1 lds
    s_mov_b32 s90, 1
    s_branch ANR2_17
ANR_16:
    buffer_load_dword v214, v224, s[4:7], 0 offen
    buffer_load_dword v214, v224, s[4:7], 0 offen
    buffer_load_dword v214, v224, s[4:7], 0 offen
    buffer_load_dword v214, v224, s[4:7], 0 offen
ANR2_17:
    s_waitcnt vmcnt(4)
    s_barrier
    s_cmp_eq_u32 s90, 1
    s_cbranch_scc1 ADONE_18
    s_mov_b32 s82, 100000
    s_mov_b64 s[88:89], exec
    s_mov_b64 exec, 0xff
AGP_19:
    buffer_load_dwordx2 v[216:217], v220, s[8:11], 0 offen sc1
    s_waitcnt vmcnt(0)
    v_cmp_ne_u64 vcc, s[28:29], v[216:217]
    s_cmp_eq_u64 vcc, 0
    s_cbranch_scc1 AGD_20
    s_sleep 1
    s_sub_u32 s82, s82, 1
    s_cbranch_scc0 AGP_19
AGD_20:
    s_mov_b64 exec, s[88:89]
    s_add_u32 m0, s101, 0
    s_add_u32 s35, s95, 0
    buffer_load_dwordx4 v236, s[8:11], s35 offen sc1 lds
    s_add_u32 m0, s101, 1024
    s_add_u32 s35, s95, 16384
    buffer_load_dwordx4 v237, s[8:11], s35 offen sc1 lds
    s_add_u32 m0, s101, 2048
    s_add_u32 s35, s95, 32768
    buffer_load_dwordx4 v238, s[8:11], s35 offen sc1 lds
    s_add_u32 m0, s101, 3072
    s_add_u32 s35, s95, 49152
    buffer_load_dwordx4 v239, s[8:11], s35 offen sc1 lds
ADONE_18:
    s_waitcnt vmcnt(0)
    s_barrier
    s_branch L_END
L_COMPUTE:
    s_waitcnt lgkmcnt(0)
    s_mov_b32 s4, s36
    s_and_b32 s5, s37, 0xffff
    s_mov_b32 s6, 2621440
    s_mov_b32 s7, 0x00020000
    s_mov_b32 s8, s74
    s_and_b32 s9, s75, 0xffff
    s_mov_b32 s10, 12582912
    s_mov_b32 s11, 0x00020000
    s_mov_b32 s24, s72
    s_and_b32 s25, s73, 0xffff
    s_mov_b32 s26, 256
    s_mov_b32 s27, 0x00020000
    s_or_b32 s34, s2, s3
    s_cmp_lg_u32 s34, 0
    s_cbranch_scc1 NONONCE_21
    s_memrealtime s[28:29]
    s_waitcnt lgkmcnt(0)
    s_or_b32 s28, s28, 1
    v_mov_b32 v2, s28
    v_mov_b32 v3, s29
    v_mov_b32 v4, 0
    s_mov_b64 s[34:35], exec
    s_mov_b64 exec, 1
    buffer_store_dwordx2 v[2:3], v4, s[24:27], 0 offen sc1
    s_mov_b64 exec, s[34:35]
NONONCE_21:
    s_lshr_b32 s32, s3, 1
    s_and_b32 s33, s3, 1
    s_cmp_lg_u32 s3, 0
    s_cbranch_scc1 NOINIT_22
    v_lshlrev_b32 v206, 2, v1
    v_add_u32 v206, 148480, v206
    v_mov_b32 v207, 0
    s_mov_b64 exec, 0xffff
    ds_write_b32 v206, v207
    s_mov_b64 exec, -1
NOINIT_22:
    v_and_b32 v206, 31, v1
    s_lshl_b32 s34, s31, 6
    s_lshl_b32 s35, s33, 5
    s_add_u32 s34, s34, s35
    v_add_u32 v207, s34, v206
    v_lshlrev_b32 v226, 4, v207
    v_lshlrev_b32 v207, 1, v207
    s_mov_b32 s16, s52
    s_and_b32 s17, s53, 0xffff
    s_mov_b32 s18, 1280
    s_mov_b32 s19, 0x00020000
    buffer_load_ushort v208, v207, s[16:19], 0 offen
    s_mov_b32 s12, s54
    s_and_b32 s13, s55, 0xffff
    s_mov_b32 s14, 1280
    s_mov_b32 s15, 0x00020000
    buffer_load_ushort v209, v207, s[12:15], 0 offen
    s_mov_b32 s92, s64
    s_and_b32 s93, s65, 0xffff
    s_mov_b32 s94, 1280
    s_mov_b32 s95, 0x00020000
    buffer_load_ushort v210, v207, s[92:95], 0 offen
    s_mov_b32 s16, s66
    s_and_b32 s17, s67, 0xffff
    s_mov_b32 s18, 1280
    s_mov_b32 s19, 0x00020000
    buffer_load_ushort v227, v207, s[16:19], 0 offen
    s_mov_b32 s20, s70
    s_and_b32 s21, s71, 0xffff
    s_mov_b32 s22, 5242880
    s_mov_b32 s23, 0x00020000
    v_and_b32 v211, 31, v1
    v_lshrrev_b32 v212, 5, v1
    v_bfe_u32 v213, v211, 2, 1
    v_lshlrev_b32 v213, 5, v213
    v_lshrrev_b32 v214, 3, v211
    v_lshl_add_u32 v213, v214, 2, v213
    v_and_b32 v214, 3, v211
    v_add_u32 v213, v213, v214
    s_lshl_b32 s34, s32, 6
    v_add_u32 v213, s34, v213
    v_bfe_u32 v214, v213, 1, 3
    v_xor_b32 v214, v214, v212
    v_lshlrev_b32 v214, 4, v214
    v_lshl_add_u32 v6, v213, 7, v214
    v_xor_b32 v7, 32, v6
    v_xor_b32 v8, 64, v6
    v_xor_b32 v9, 96, v6
    s_lshl_b32 s34, s33, 5
    v_add_u32 v213, s34, v211
    v_bfe_u32 v214, v213, 1, 3
    v_xor_b32 v214, v214, v212
    v_lshlrev_b32 v214, 4, v214
    v_lshl_add_u32 v10, v213, 7, v214
    v_mov_b32 v221, v10
    v_add_u32 v10, 0x10000, v10
    v_xor_b32 v11, 32, v10
    v_xor_b32 v12, 64, v10
    v_xor_b32 v13, 96, v10
    v_mov_b32 v224, 0
    v_lshlrev_b32 v225, 4, v1
    s_waitcnt vmcnt(0)
    v_lshlrev_b32 v227, 16, v227
    v_lshlrev_b32 v208, 16, v208
    v_lshlrev_b32 v209, 16, v209
    v_lshlrev_b32 v210, 16, v210
    v_mul_f32 v211, 0x3fb8aa3b, v210
    s_mov_b32 s34, 0x3fb8aa3b
    v_fma_f32 v212, v210, s34, -v211
    v_fmac_f32 v212, 0x32a57060, v210
    v_exp_f32 v213, v211
    v_mul_f32 v212, 0x3f317218, v212
    s_nop 0
    v_fma_f32 v210, v213, v212, v213
    v_cvt_pk_bf16_f32 v210, v210, v210
    v_and_b32 v210, 0xffff0000, v210
    v_mul_f32 v211, v210, v208
    v_mul_f32 v212, v210, v209
    v_mul_f32 v213, 0x3fb8aa3b, v211
    s_mov_b32 s34, 0x3fb8aa3b
    v_fma_f32 v214, v211, s34, -v213
    v_fmac_f32 v214, 0x32a57060, v211
    v_exp_f32 v215, v213
    v_mul_f32 v214, 0x3f317218, v214
    s_nop 0
    v_fma_f32 v211, v215, v214, v215
    v_mul_f32 v212, 0x3e22f983, v212
    v_fract_f32 v212, v212
    v_cos_f32 v213, v212
    v_sin_f32 v214, v212
    s_nop 0
    v_mul_f32 v192, v211, v213
    v_mul_f32 v193, v211, v214
    v_add_f32 v211, -1.0, v192
    v_mul_f32 v212, v208, v208
    v_fma_f32 v212, v209, v209, v212
    v_rcp_f32 v213, v212
    v_mul_f32 v214, v211, v208
    v_fma_f32 v215, -v212, v213, 2.0
    v_mul_f32 v213, v213, v215
    v_fma_f32 v214, v193, v209, v214
    v_mul_f32 v215, v193, v208
    v_fma_f32 v215, -v211, v209, v215
    v_add_f32 v213, v213, v213
    v_mul_f32 v194, v214, v213
    v_mul_f32 v195, v215, v213
    v_mov_b32 v196, v192
    v_mov_b32 v197, v193
    v_mul_f32 v211, v196, v196
    v_mul_f32 v212, v196, v197
    v_fma_f32 v211, -v197, v197, v211
    v_fma_f32 v197, v197, v196, v212
    v_mov_b32 v196, v211
    v_mul_f32 v211, v196, v196
    v_mul_f32 v212, v196, v197
    v_fma_f32 v211, -v197, v197, v211
    v_fma_f32 v197, v197, v196, v212
    v_mov_b32 v196, v211
    v_mul_f32 v211, v196, v196
    v_mul_f32 v212, v196, v197
    v_fma_f32 v211, -v197, v197, v211
    v_fma_f32 v197, v197, v196, v212
    v_mov_b32 v196, v211
    v_mul_f32 v211, v196, v196
    v_mul_f32 v212, v196, v197
    v_fma_f32 v211, -v197, v197, v211
    v_fma_f32 v197, v197, v196, v212
    v_mov_b32 v196, v211
    v_mul_f32 v211, v196, v196
    v_mul_f32 v212, v196, v197
    v_fma_f32 v211, -v197, v197, v211
    v_fma_f32 v197, v197, v196, v212
    v_mov_b32 v196, v211
    v_mul_f32 v211, v196, v196
    v_mul_f32 v212, v196, v197
    v_fma_f32 v211, -v197, v197, v211
    v_fma_f32 v199, v197, v196, v212
    v_mov_b32 v198, v211
    v_mul_f32 v211, v198, v198
    v_mul_f32 v212, v198, v199
    v_fma_f32 v211, -v199, v199, v211
    v_fma_f32 v199, v199, v198, v212
    v_mov_b32 v198, v211
    s_waitcnt lgkmcnt(0)
    s_barrier
    ds_read_b128 v[16:19], v6 offset:0
    ds_read_b128 v[24:27], v10 offset:0
    ds_read_b128 v[20:23], v6 offset:2048
    ds_read_b128 v[28:31], v10 offset:8192
    ds_read_b128 v[32:35], v7 offset:0
    ds_read_b128 v[40:43], v11 offset:0
    ds_read_b128 v[36:39], v7 offset:2048
    ds_read_b128 v[44:47], v11 offset:8192
    s_waitcnt lgkmcnt(4)
    v_mfma_f32_32x32x16_bf16 v[64:79], v[16:19], v[24:27], 0
    ds_read_b128 v[48:51], v8 offset:0
    v_mfma_f32_32x32x16_bf16 v[80:95], v[16:19], v[28:31], 0
    ds_read_b128 v[56:59], v12 offset:0
    v_mfma_f32_32x32x16_bf16 v[96:111], v[20:23], v[24:27], 0
    ds_read_b128 v[52:55], v8 offset:2048
    v_mfma_f32_32x32x16_bf16 v[112:127], v[20:23], v[28:31], 0
    ds_read_b128 v[60:63], v12 offset:8192
    s_waitcnt lgkmcnt(4)
    v_mfma_f32_32x32x16_bf16 v[64:79], v[32:35], v[40:43], v[64:79]
    ds_read_b128 v[16:19], v9 offset:0
    v_mfma_f32_32x32x16_bf16 v[80:95], v[32:35], v[44:47], v[80:95]
    ds_read_b128 v[24:27], v13 offset:0
    v_mfma_f32_32x32x16_bf16 v[96:111], v[36:39], v[40:43], v[96:111]
    ds_read_b128 v[20:23], v9 offset:2048
    v_mfma_f32_32x32x16_bf16 v[112:127], v[36:39], v[44:47], v[112:127]
    ds_read_b128 v[28:31], v13 offset:8192
    s_waitcnt lgkmcnt(4)
    s_barrier
    v_mfma_f32_32x32x16_bf16 v[64:79], v[48:51], v[56:59], v[64:79]
    ds_read_b128 v[32:35], v6 offset:16384
    v_mfma_f32_32x32x16_bf16 v[80:95], v[48:51], v[60:63], v[80:95]
    ds_read_b128 v[40:43], v10 offset:16384
    v_mfma_f32_32x32x16_bf16 v[96:111], v[52:55], v[56:59], v[96:111]
    ds_read_b128 v[36:39], v6 offset:18432
    v_mfma_f32_32x32x16_bf16 v[112:127], v[52:55], v[60:63], v[112:127]
    ds_read_b128 v[44:47], v10 offset:24576
    s_waitcnt lgkmcnt(4)
    v_mfma_f32_32x32x16_bf16 v[64:79], v[16:19], v[24:27], v[64:79]
    ds_read_b128 v[48:51], v7 offset:16384
    v_mfma_f32_32x32x16_bf16 v[80:95], v[16:19], v[28:31], v[80:95]
    ds_read_b128 v[56:59], v11 offset:16384
    v_mfma_f32_32x32x16_bf16 v[96:111], v[20:23], v[24:27], v[96:111]
    ds_read_b128 v[52:55], v7 offset:18432
    v_mfma_f32_32x32x16_bf16 v[112:127], v[20:23], v[28:31], v[112:127]
    ds_read_b128 v[60:63], v11 offset:24576
    s_waitcnt lgkmcnt(4)
    v_mfma_f32_32x32x16_bf16 v[64:79], v[32:35], v[40:43], v[64:79]
    ds_read_b128 v[16:19], v8 offset:16384
    v_mfma_f32_32x32x16_bf16 v[80:95], v[32:35], v[44:47], v[80:95]
    ds_read_b128 v[24:27], v12 offset:16384
    v_mfma_f32_32x32x16_bf16 v[96:111], v[36:39], v[40:43], v[96:111]
    ds_read_b128 v[20:23], v8 offset:18432
    v_mfma_f32_32x32x16_bf16 v[112:127], v[36:39], v[44:47], v[112:127]
    ds_read_b128 v[28:31], v12 offset:24576
    s_waitcnt lgkmcnt(4)
    v_mfma_f32_32x32x16_bf16 v[64:79], v[48:51], v[56:59], v[64:79]
    ds_read_b128 v[32:35], v9 offset:16384
    v_mfma_f32_32x32x16_bf16 v[80:95], v[48:51], v[60:63], v[80:95]
    ds_read_b128 v[40:43], v13 offset:16384
    v_mfma_f32_32x32x16_bf16 v[96:111], v[52:55], v[56:59], v[96:111]
    ds_read_b128 v[36:39], v9 offset:18432
    v_mfma_f32_32x32x16_bf16 v[112:127], v[52:55], v[60:63], v[112:127]
    ds_read_b128 v[44:47], v13 offset:24576
    s_waitcnt lgkmcnt(4)
    s_barrier
    v_mfma_f32_32x32x16_bf16 v[64:79], v[16:19], v[24:27], v[64:79]
    ds_read_b128 v[48:51], v6 offset:32768
    v_mfma_f32_32x32x16_bf16 v[80:95], v[16:19], v[28:31], v[80:95]
    ds_read_b128 v[56:59], v10 offset:32768
    v_mfma_f32_32x32x16_bf16 v[96:111], v[20:23], v[24:27], v[96:111]
    ds_read_b128 v[52:55], v6 offset:34816
    v_mfma_f32_32x32x16_bf16 v[112:127], v[20:23], v[28:31], v[112:127]
    ds_read_b128 v[60:63], v10 offset:40960
    s_waitcnt lgkmcnt(4)
    v_mfma_f32_32x32x16_bf16 v[64:79], v[32:35], v[40:43], v[64:79]
    ds_read_b128 v[16:19], v7 offset:32768
    v_mfma_f32_32x32x16_bf16 v[80:95], v[32:35], v[44:47], v[80:95]
    ds_read_b128 v[24:27], v11 offset:32768
    v_mfma_f32_32x32x16_bf16 v[96:111], v[36:39], v[40:43], v[96:111]
    ds_read_b128 v[20:23], v7 offset:34816
    v_mfma_f32_32x32x16_bf16 v[112:127], v[36:39], v[44:47], v[112:127]
    ds_read_b128 v[28:31], v11 offset:40960
    s_waitcnt lgkmcnt(4)
    v_mfma_f32_32x32x16_bf16 v[64:79], v[48:51], v[56:59], v[64:79]
    ds_read_b128 v[32:35], v8 offset:32768
    v_mfma_f32_32x32x16_bf16 v[80:95], v[48:51], v[60:63], v[80:95]
    ds_read_b128 v[40:43], v12 offset:32768
    v_mfma_f32_32x32x16_bf16 v[96:111], v[52:55], v[56:59], v[96:111]
    ds_read_b128 v[36:39], v8 offset:34816
    v_mfma_f32_32x32x16_bf16 v[112:127], v[52:55], v[60:63], v[112:127]
    ds_read_b128 v[44:47], v12 offset:40960
    s_waitcnt lgkmcnt(4)
    v_mfma_f32_32x32x16_bf16 v[64:79], v[16:19], v[24:27], v[64:79]
    ds_read_b128 v[48:51], v9 offset:32768
    v_mfma_f32_32x32x16_bf16 v[80:95], v[16:19], v[28:31], v[80:95]
    ds_read_b128 v[56:59], v13 offset:32768
    v_mfma_f32_32x32x16_bf16 v[96:111], v[20:23], v[24:27], v[96:111]
    ds_read_b128 v[52:55], v9 offset:34816
    v_mfma_f32_32x32x16_bf16 v[112:127], v[20:23], v[28:31], v[112:127]
    ds_read_b128 v[60:63], v13 offset:40960
    s_waitcnt lgkmcnt(4)
    s_barrier
    v_mfma_f32_32x32x16_bf16 v[64:79], v[32:35], v[40:43], v[64:79]
    ds_read_b128 v[16:19], v6 offset:49152
    v_mfma_f32_32x32x16_bf16 v[80:95], v[32:35], v[44:47], v[80:95]
    ds_read_b128 v[24:27], v10 offset:49152
    v_mfma_f32_32x32x16_bf16 v[96:111], v[36:39], v[40:43], v[96:111]
    ds_read_b128 v[20:23], v6 offset:51200
    v_mfma_f32_32x32x16_bf16 v[112:127], v[36:39], v[44:47], v[112:127]
    ds_read_b128 v[28:31], v10 offset:57344
    s_waitcnt lgkmcnt(4)
    v_mfma_f32_32x32x16_bf16 v[64:79], v[48:51], v[56:59], v[64:79]
    ds_read_b128 v[32:35], v7 offset:49152
    v_mfma_f32_32x32x16_bf16 v[80:95], v[48:51], v[60:63], v[80:95]
    ds_read_b128 v[40:43], v11 offset:49152
    v_mfma_f32_32x32x16_bf16 v[96:111], v[52:55], v[56:59], v[96:111]
    ds_read_b128 v[36:39], v7 offset:51200
    v_mfma_f32_32x32x16_bf16 v[112:127], v[52:55], v[60:63], v[112:127]
    ds_read_b128 v[44:47], v11 offset:57344
    s_waitcnt lgkmcnt(4)
    v_mfma_f32_32x32x16_bf16 v[64:79], v[16:19], v[24:27], v[64:79]
    ds_read_b128 v[48:51], v8 offset:49152
    v_mfma_f32_32x32x16_bf16 v[80:95], v[16:19], v[28:31], v[80:95]
    ds_read_b128 v[56:59], v12 offset:49152
    v_mfma_f32_32x32x16_bf16 v[96:111], v[20:23], v[24:27], v[96:111]
    ds_read_b128 v[52:55], v8 offset:51200
    v_mfma_f32_32x32x16_bf16 v[112:127], v[20:23], v[28:31], v[112:127]
    ds_read_b128 v[60:63], v12 offset:57344
    s_waitcnt lgkmcnt(4)
    v_mfma_f32_32x32x16_bf16 v[64:79], v[32:35], v[40:43], v[64:79]
    ds_read_b128 v[16:19], v9 offset:49152
    v_mfma_f32_32x32x16_bf16 v[80:95], v[32:35], v[44:47], v[80:95]
    ds_read_b128 v[24:27], v13 offset:49152
    v_mfma_f32_32x32x16_bf16 v[96:111], v[36:39], v[40:43], v[96:111]
    ds_read_b128 v[20:23], v9 offset:51200
    v_mfma_f32_32x32x16_bf16 v[112:127], v[36:39], v[44:47], v[112:127]
    ds_read_b128 v[28:31], v13 offset:57344
    s_waitcnt lgkmcnt(4)
    s_barrier
    v_mfma_f32_32x32x16_bf16 v[64:79], v[48:51], v[56:59], v[64:79]
    ds_read_b128 v[32:35], v6 offset:0
    v_mfma_f32_32x32x16_bf16 v[80:95], v[48:51], v[60:63], v[80:95]
    ds_read_b128 v[40:43], v10 offset:0
    v_mfma_f32_32x32x16_bf16 v[96:111], v[52:55], v[56:59], v[96:111]
    ds_read_b128 v[36:39], v6 offset:2048
    v_mfma_f32_32x32x16_bf16 v[112:127], v[52:55], v[60:63], v[112:127]
    ds_read_b128 v[44:47], v10 offset:8192
    s_waitcnt lgkmcnt(4)
    v_mfma_f32_32x32x16_bf16 v[64:79], v[16:19], v[24:27], v[64:79]
    ds_read_b128 v[48:51], v7 offset:0
    v_mfma_f32_32x32x16_bf16 v[80:95], v[16:19], v[28:31], v[80:95]
    ds_read_b128 v[56:59], v11 offset:0
    v_mfma_f32_32x32x16_bf16 v[96:111], v[20:23], v[24:27], v[96:111]
    ds_read_b128 v[52:55], v7 offset:2048
    v_mfma_f32_32x32x16_bf16 v[112:127], v[20:23], v[28:31], v[112:127]
    ds_read_b128 v[60:63], v11 offset:8192
    s_waitcnt lgkmcnt(4)
    v_mfma_f32_32x32x16_bf16 v[64:79], v[32:35], v[40:43], v[64:79]
    ds_read_b128 v[16:19], v8 offset:0
    v_mfma_f32_32x32x16_bf16 v[80:95], v[32:35], v[44:47], v[80:95]
    ds_read_b128 v[24:27], v12 offset:0
    v_mfma_f32_32x32x16_bf16 v[96:111], v[36:39], v[40:43], v[96:111]
    ds_read_b128 v[20:23], v8 offset:2048
    v_mfma_f32_32x32x16_bf16 v[112:127], v[36:39], v[44:47], v[112:127]
    ds_read_b128 v[28:31], v12 offset:8192
    s_waitcnt lgkmcnt(4)
    v_mfma_f32_32x32x16_bf16 v[64:79], v[48:51], v[56:59], v[64:79]
    ds_read_b128 v[32:35], v9 offset:0
    v_mfma_f32_32x32x16_bf16 v[80:95], v[48:51], v[60:63], v[80:95]
    ds_read_b128 v[40:43], v13 offset:0
    v_mfma_f32_32x32x16_bf16 v[96:111], v[52:55], v[56:59], v[96:111]
    ds_read_b128 v[36:39], v9 offset:2048
    v_mfma_f32_32x32x16_bf16 v[112:127], v[52:55], v[60:63], v[112:127]
    ds_read_b128 v[44:47], v13 offset:8192
    s_waitcnt lgkmcnt(4)
    s_barrier
    v_mfma_f32_32x32x16_bf16 v[64:79], v[16:19], v[24:27], v[64:79]
    ds_read_b128 v[48:51], v6 offset:16384
    ds_read_b128 v[56:59], v10 offset:16384
    v_mfma_f32_32x32x16_bf16 v[80:95], v[16:19], v[28:31], v[80:95]
    ds_read_b128 v[52:55], v6 offset:18432
    ds_read_b128 v[60:63], v10 offset:24576
    v_mfma_f32_32x32x16_bf16 v[96:111], v[20:23], v[24:27], v[96:111]
    buffer_load_dwordx2 v[204:205], v224, s[24:27], 0 offen sc1
    v_mfma_f32_32x32x16_bf16 v[112:127], v[20:23], v[28:31], v[112:127]
    s_waitcnt lgkmcnt(4)
    v_mfma_f32_32x32x16_bf16 v[64:79], v[32:35], v[40:43], v[64:79]
    ds_read_b128 v[16:19], v7 offset:16384
    v_mfma_f32_32x32x16_bf16 v[80:95], v[32:35], v[44:47], v[80:95]
    ds_read_b128 v[24:27], v11 offset:16384
    v_mfma_f32_32x32x16_bf16 v[96:111], v[36:39], v[40:43], v[96:111]
    ds_read_b128 v[20:23], v7 offset:18432
    v_mfma_f32_32x32x16_bf16 v[112:127], v[36:39], v[44:47], v[112:127]
    ds_read_b128 v[28:31], v11 offset:24576
    s_waitcnt lgkmcnt(4)
    v_mfma_f32_32x32x16_bf16 v[64:79], v[48:51], v[56:59], v[64:79]
    ds_read_b128 v[32:35], v8 offset:16384
    v_mfma_f32_32x32x16_bf16 v[80:95], v[48:51], v[60:63], v[80:95]
    ds_read_b128 v[40:43], v12 offset:16384
    v_mfma_f32_32x32x16_bf16 v[96:111], v[52:55], v[56:59], v[96:111]
    ds_read_b128 v[36:39], v8 offset:18432
    v_mfma_f32_32x32x16_bf16 v[112:127], v[52:55], v[60:63], v[112:127]
    ds_read_b128 v[44:47], v12 offset:24576
    s_waitcnt lgkmcnt(4)
    v_mfma_f32_32x32x16_bf16 v[64:79], v[16:19], v[24:27], v[64:79]
    ds_read_b128 v[48:51], v9 offset:16384
    v_mfma_f32_32x32x16_bf16 v[80:95], v[16:19], v[28:31], v[80:95]
    ds_read_b128 v[56:59], v13 offset:16384
    v_mfma_f32_32x32x16_bf16 v[96:111], v[20:23], v[24:27], v[96:111]
    ds_read_b128 v[52:55], v9 offset:18432
    v_mfma_f32_32x32x16_bf16 v[112:127], v[20:23], v[28:31], v[112:127]
    ds_read_b128 v[60:63], v13 offset:24576
    s_waitcnt lgkmcnt(4)
    s_barrier
    v_mfma_f32_32x32x16_bf16 v[64:79], v[32:35], v[40:43], v[64:79]
    ds_read_b128 v[16:19], v6 offset:32768
    v_mfma_f32_32x32x16_bf16 v[80:95], v[32:35], v[44:47], v[80:95]
    ds_read_b128 v[24:27], v10 offset:32768
    v_mfma_f32_32x32x16_bf16 v[96:111], v[36:39], v[40:43], v[96:111]
    ds_read_b128 v[20:23], v6 offset:34816
    v_mfma_f32_32x32x16_bf16 v[112:127], v[36:39], v[44:47], v[112:127]
    ds_read_b128 v[28:31], v10 offset:40960
    s_waitcnt lgkmcnt(4)
    v_mfma_f32_32x32x16_bf16 v[64:79], v[48:51], v[56:59], v[64:79]
    ds_read_b128 v[32:35], v7 offset:32768
    v_mfma_f32_32x32x16_bf16 v[80:95], v[48:51], v[60:63], v[80:95]
    ds_read_b128 v[40:43], v11 offset:32768
    v_mfma_f32_32x32x16_bf16 v[96:111], v[52:55], v[56:59], v[96:111]
    ds_read_b128 v[36:39], v7 offset:34816
    v_mfma_f32_32x32x16_bf16 v[112:127], v[52:55], v[60:63], v[112:127]
    ds_read_b128 v[44:47], v11 offset:40960
    s_waitcnt lgkmcnt(4)
    v_mfma_f32_32x32x16_bf16 v[64:79], v[16:19], v[24:27], v[64:79]
    ds_read_b128 v[48:51], v8 offset:32768
    v_mfma_f32_32x32x16_bf16 v[80:95], v[16:19], v[28:31], v[80:95]
    ds_read_b128 v[56:59], v12 offset:32768
    v_mfma_f32_32x32x16_bf16 v[96:111], v[20:23], v[24:27], v[96:111]
    ds_read_b128 v[52:55], v8 offset:34816
    v_mfma_f32_32x32x16_bf16 v[112:127], v[20:23], v[28:31], v[112:127]
    ds_read_b128 v[60:63], v12 offset:40960
    s_waitcnt lgkmcnt(4)
    v_mfma_f32_32x32x16_bf16 v[64:79], v[32:35], v[40:43], v[64:79]
    ds_read_b128 v[16:19], v9 offset:32768
    v_mfma_f32_32x32x16_bf16 v[80:95], v[32:35], v[44:47], v[80:95]
    ds_read_b128 v[24:27], v13 offset:32768
    v_mfma_f32_32x32x16_bf16 v[96:111], v[36:39], v[40:43], v[96:111]
    ds_read_b128 v[20:23], v9 offset:34816
    v_mfma_f32_32x32x16_bf16 v[112:127], v[36:39], v[44:47], v[112:127]
    ds_read_b128 v[28:31], v13 offset:40960
    s_waitcnt lgkmcnt(4)
    s_barrier
    v_mfma_f32_32x32x16_bf16 v[64:79], v[48:51], v[56:59], v[64:79]
    ds_read_b128 v[32:35], v6 offset:49152
    v_mfma_f32_32x32x16_bf16 v[80:95], v[48:51], v[60:63], v[80:95]
    ds_read_b128 v[40:43], v10 offset:49152
    v_mfma_f32_32x32x16_bf16 v[96:111], v[52:55], v[56:59], v[96:111]
    ds_read_b128 v[36:39], v6 offset:51200
    v_mfma_f32_32x32x16_bf16 v[112:127], v[52:55], v[60:63], v[112:127]
    ds_read_b128 v[44:47], v10 offset:57344
    s_waitcnt lgkmcnt(4)
    v_mfma_f32_32x32x16_bf16 v[64:79], v[16:19], v[24:27], v[64:79]
    ds_read_b128 v[48:51], v7 offset:49152
    v_mfma_f32_32x32x16_bf16 v[80:95], v[16:19], v[28:31], v[80:95]
    ds_read_b128 v[56:59], v11 offset:49152
    v_mfma_f32_32x32x16_bf16 v[96:111], v[20:23], v[24:27], v[96:111]
    ds_read_b128 v[52:55], v7 offset:51200
    v_mfma_f32_32x32x16_bf16 v[112:127], v[20:23], v[28:31], v[112:127]
    ds_read_b128 v[60:63], v11 offset:57344
    s_waitcnt lgkmcnt(4)
    v_mfma_f32_32x32x16_bf16 v[64:79], v[32:35], v[40:43], v[64:79]
    ds_read_b128 v[16:19], v8 offset:49152
    v_mfma_f32_32x32x16_bf16 v[80:95], v[32:35], v[44:47], v[80:95]
    ds_read_b128 v[24:27], v12 offset:49152
    v_mfma_f32_32x32x16_bf16 v[96:111], v[36:39], v[40:43], v[96:111]
    ds_read_b128 v[20:23], v8 offset:51200
    v_mfma_f32_32x32x16_bf16 v[112:127], v[36:39], v[44:47], v[112:127]
    ds_read_b128 v[28:31], v12 offset:57344
    s_waitcnt lgkmcnt(4)
    v_mfma_f32_32x32x16_bf16 v[64:79], v[48:51], v[56:59], v[64:79]
    ds_read_b128 v[32:35], v9 offset:49152
    v_mfma_f32_32x32x16_bf16 v[80:95], v[48:51], v[60:63], v[80:95]
    ds_read_b128 v[40:43], v13 offset:49152
    v_mfma_f32_32x32x16_bf16 v[96:111], v[52:55], v[56:59], v[96:111]
    ds_read_b128 v[36:39], v9 offset:51200
    v_mfma_f32_32x32x16_bf16 v[112:127], v[52:55], v[60:63], v[112:127]
    ds_read_b128 v[44:47], v13 offset:57344
    s_waitcnt lgkmcnt(4)
    s_barrier
    v_mfma_f32_32x32x16_bf16 v[64:79], v[16:19], v[24:27], v[64:79]
    ds_read_b128 v[48:51], v6 offset:0
    v_mfma_f32_32x32x16_bf16 v[80:95], v[16:19], v[28:31], v[80:95]
    ds_read_b128 v[56:59], v10 offset:0
    v_mfma_f32_32x32x16_bf16 v[96:111], v[20:23], v[24:27], v[96:111]
    ds_read_b128 v[52:55], v6 offset:2048
    v_mfma_f32_32x32x16_bf16 v[112:127], v[20:23], v[28:31], v[112:127]
    ds_read_b128 v[60:63], v10 offset:8192
    s_waitcnt lgkmcnt(4)
    v_mfma_f32_32x32x16_bf16 v[64:79], v[32:35], v[40:43], v[64:79]
    ds_read_b128 v[16:19], v7 offset:0
    v_mfma_f32_32x32x16_bf16 v[80:95], v[32:35], v[44:47], v[80:95]
    ds_read_b128 v[24:27], v11 offset:0
    v_mfma_f32_32x32x16_bf16 v[96:111], v[36:39], v[40:43], v[96:111]
    ds_read_b128 v[20:23], v7 offset:2048
    v_mfma_f32_32x32x16_bf16 v[112:127], v[36:39], v[44:47], v[112:127]
    ds_read_b128 v[28:31], v11 offset:8192
    s_waitcnt lgkmcnt(4)
    v_mfma_f32_32x32x16_bf16 v[64:79], v[48:51], v[56:59], v[64:79]
    ds_read_b128 v[32:35], v8 offset:0
    v_mfma_f32_32x32x16_bf16 v[80:95], v[48:51], v[60:63], v[80:95]
    ds_read_b128 v[40:43], v12 offset:0
    v_mfma_f32_32x32x16_bf16 v[96:111], v[52:55], v[56:59], v[96:111]
    ds_read_b128 v[36:39], v8 offset:2048
    v_mfma_f32_32x32x16_bf16 v[112:127], v[52:55], v[60:63], v[112:127]
    ds_read_b128 v[44:47], v12 offset:8192
    s_waitcnt lgkmcnt(4)
    v_mfma_f32_32x32x16_bf16 v[64:79], v[16:19], v[24:27], v[64:79]
    ds_read_b128 v[48:51], v9 offset:0
    v_mfma_f32_32x32x16_bf16 v[80:95], v[16:19], v[28:31], v[80:95]
    ds_read_b128 v[56:59], v13 offset:0
    v_mfma_f32_32x32x16_bf16 v[96:111], v[20:23], v[24:27], v[96:111]
    ds_read_b128 v[52:55], v9 offset:2048
    v_mfma_f32_32x32x16_bf16 v[112:127], v[20:23], v[28:31], v[112:127]
    ds_read_b128 v[60:63], v13 offset:8192
    s_waitcnt lgkmcnt(4)
    s_barrier
    v_mfma_f32_32x32x16_bf16 v[64:79], v[32:35], v[40:43], v[64:79]
    ds_read_b128 v[16:19], v6 offset:16384
    v_mfma_f32_32x32x16_bf16 v[80:95], v[32:35], v[44:47], v[80:95]
    ds_read_b128 v[24:27], v10 offset:16384
    v_mfma_f32_32x32x16_bf16 v[96:111], v[36:39], v[40:43], v[96:111]
    ds_read_b128 v[20:23], v6 offset:18432
    v_mfma_f32_32x32x16_bf16 v[112:127], v[36:39], v[44:47], v[112:127]
    ds_read_b128 v[28:31], v10 offset:24576
    s_waitcnt lgkmcnt(4)
    v_mfma_f32_32x32x16_bf16 v[64:79], v[48:51], v[56:59], v[64:79]
    ds_read_b128 v[32:35], v7 offset:16384
    v_mfma_f32_32x32x16_bf16 v[80:95], v[48:51], v[60:63], v[80:95]
    ds_read_b128 v[40:43], v11 offset:16384
    v_mfma_f32_32x32x16_bf16 v[96:111], v[52:55], v[56:59], v[96:111]
    ds_read_b128 v[36:39], v7 offset:18432
    v_mfma_f32_32x32x16_bf16 v[112:127], v[52:55], v[60:63], v[112:127]
    ds_read_b128 v[44:47], v11 offset:24576
    s_waitcnt lgkmcnt(4)
    v_mfma_f32_32x32x16_bf16 v[64:79], v[16:19], v[24:27], v[64:79]
    ds_read_b128 v[48:51], v8 offset:16384
    v_mfma_f32_32x32x16_bf16 v[80:95], v[16:19], v[28:31], v[80:95]
    ds_read_b128 v[56:59], v12 offset:16384
    v_mfma_f32_32x32x16_bf16 v[96:111], v[20:23], v[24:27], v[96:111]
    ds_read_b128 v[52:55], v8 offset:18432
    v_mfma_f32_32x32x16_bf16 v[112:127], v[20:23], v[28:31], v[112:127]
    ds_read_b128 v[60:63], v12 offset:24576
    s_waitcnt lgkmcnt(4)
    v_mfma_f32_32x32x16_bf16 v[64:79], v[32:35], v[40:43], v[64:79]
    ds_read_b128 v[16:19], v9 offset:16384
    v_mfma_f32_32x32x16_bf16 v[80:95], v[32:35], v[44:47], v[80:95]
    ds_read_b128 v[24:27], v13 offset:16384
    v_mfma_f32_32x32x16_bf16 v[96:111], v[36:39], v[40:43], v[96:111]
    ds_read_b128 v[20:23], v9 offset:18432
    v_mfma_f32_32x32x16_bf16 v[112:127], v[36:39], v[44:47], v[112:127]
    ds_read_b128 v[28:31], v13 offset:24576
    s_waitcnt lgkmcnt(4)
    v_mfma_f32_32x32x16_bf16 v[64:79], v[48:51], v[56:59], v[64:79]
    v_mfma_f32_32x32x16_bf16 v[80:95], v[48:51], v[60:63], v[80:95]
    v_mfma_f32_32x32x16_bf16 v[96:111], v[52:55], v[56:59], v[96:111]
    v_mfma_f32_32x32x16_bf16 v[112:127], v[52:55], v[60:63], v[112:127]
    s_waitcnt lgkmcnt(0)
    s_barrier
    v_mfma_f32_32x32x16_bf16 v[64:79], v[16:19], v[24:27], v[64:79]
    v_mfma_f32_32x32x16_bf16 v[80:95], v[16:19], v[28:31], v[80:95]
    v_mfma_f32_32x32x16_bf16 v[96:111], v[20:23], v[24:27], v[96:111]
    v_mfma_f32_32x32x16_bf16 v[112:127], v[20:23], v[28:31], v[112:127]
    s_nop 7
    s_nop 7
    v_mov_b32 v200, v64
    v_mov_b32 v201, v80
    v_fma_f32 v206, v192, v200, v65
    v_fma_f32 v207, v192, v201, v81
    v_fma_f32 v206, -v193, v201, v206
    v_fma_f32 v207, v193, v200, v207
    v_fma_f32 v200, v192, v206, v66
    v_fma_f32 v201, v192, v207, v82
    v_fma_f32 v200, -v193, v207, v200
    v_fma_f32 v201, v193, v206, v201
    v_fma_f32 v206, v192, v200, v67
    v_fma_f32 v207, v192, v201, v83
    v_fma_f32 v206, -v193, v201, v206
    v_fma_f32 v207, v193, v200, v207
    v_fma_f32 v200, v192, v206, v68
    v_fma_f32 v201, v192, v207, v84
    v_fma_f32 v200, -v193, v207, v200
    v_fma_f32 v201, v193, v206, v201
    v_fma_f32 v206, v192, v200, v69
    v_fma_f32 v207, v192, v201, v85
    v_fma_f32 v206, -v193, v201, v206
    v_fma_f32 v207, v193, v200, v207
    v_fma_f32 v200, v192, v206, v70
    v_fma_f32 v201, v192, v207, v86
    v_fma_f32 v200, -v193, v207, v200
    v_fma_f32 v201, v193, v206, v201
    v_fma_f32 v206, v192, v200, v71
    v_fma_f32 v207, v192, v201, v87
    v_fma_f32 v206, -v193, v201, v206
    v_fma_f32 v207, v193, v200, v207
    v_fma_f32 v200, v192, v206, v72
    v_fma_f32 v201, v192, v207, v88
    v_fma_f32 v200, -v193, v207, v200
    v_fma_f32 v201, v193, v206, v201
    v_fma_f32 v206, v192, v200, v73
    v_fma_f32 v207, v192, v201, v89
    v_fma_f32 v206, -v193, v201, v206
    v_fma_f32 v207, v193, v200, v207
    v_fma_f32 v200, v192, v206, v74
    v_fma_f32 v201, v192, v207, v90
    v_fma_f32 v200, -v193, v207, v200
    v_fma_f32 v201, v193, v206, v201
    v_fma_f32 v206, v192, v200, v75
    v_fma_f32 v207, v192, v201, v91
    v_fma_f32 v206, -v193, v201, v206
    v_fma_f32 v207, v193, v200, v207
    v_fma_f32 v200, v192, v206, v76
    v_fma_f32 v201, v192, v207, v92
    v_fma_f32 v200, -v193, v207, v200
    v_fma_f32 v201, v193, v206, v201
    v_fma_f32 v206, v192, v200, v77
    v_fma_f32 v207, v192, v201, v93
    v_fma_f32 v206, -v193, v201, v206
    v_fma_f32 v207, v193, v200, v207
    v_fma_f32 v200, v192, v206, v78
    v_fma_f32 v201, v192, v207, v94
    v_fma_f32 v200, -v193, v207, v200
    v_fma_f32 v201, v193, v206, v201
    v_fma_f32 v206, v192, v200, v79
    v_fma_f32 v207, v192, v201, v95
    v_fma_f32 v206, -v193, v201, v206
    v_fma_f32 v207, v193, v200, v207
    v_fma_f32 v200, v192, v206, v96
    v_fma_f32 v201, v192, v207, v112
    v_fma_f32 v200, -v193, v207, v200
    v_fma_f32 v201, v193, v206, v201
    v_fma_f32 v206, v192, v200, v97
    v_fma_f32 v207, v192, v201, v113
    v_fma_f32 v206, -v193, v201, v206
    v_fma_f32 v207, v193, v200, v207
    v_fma_f32 v200, v192, v206, v98
    v_fma_f32 v201, v192, v207, v114
    v_fma_f32 v200, -v193, v207, v200
    v_fma_f32 v201, v193, v206, v201
    v_fma_f32 v206, v192, v200, v99
    v_fma_f32 v207, v192, v201, v115
    v_fma_f32 v206, -v193, v201, v206
    v_fma_f32 v207, v193, v200, v207
    v_fma_f32 v200, v192, v206, v100
    v_fma_f32 v201, v192, v207, v116
    v_fma_f32 v200, -v193, v207, v200
    v_fma_f32 v201, v193, v206, v201
    v_fma_f32 v206, v192, v200, v101
    v_fma_f32 v207, v192, v201, v117
    v_fma_f32 v206, -v193, v201, v206
    v_fma_f32 v207, v193, v200, v207
    v_fma_f32 v200, v192, v206, v102
    v_fma_f32 v201, v192, v207, v118
    v_fma_f32 v200, -v193, v207, v200
    v_fma_f32 v201, v193, v206, v201
    v_fma_f32 v206, v192, v200, v103
    v_fma_f32 v207, v192, v201, v119
    v_fma_f32 v206, -v193, v201, v206
    v_fma_f32 v207, v193, v200, v207
    v_fma_f32 v200, v192, v206, v104
    v_fma_f32 v201, v192, v207, v120
    v_fma_f32 v200, -v193, v207, v200
    v_fma_f32 v201, v193, v206, v201
    v_fma_f32 v206, v192, v200, v105
    v_fma_f32 v207, v192, v201, v121
    v_fma_f32 v206, -v193, v201, v206
    v_fma_f32 v207, v193, v200, v207
    v_fma_f32 v200, v192, v206, v106
    v_fma_f32 v201, v192, v207, v122
    v_fma_f32 v200, -v193, v207, v200
    v_fma_f32 v201, v193, v206, v201
    v_fma_f32 v206, v192, v200, v107
    v_fma_f32 v207, v192, v201, v123
    v_fma_f32 v206, -v193, v201, v206
    v_fma_f32 v207, v193, v200, v207
    v_fma_f32 v200, v192, v206, v108
    v_fma_f32 v201, v192, v207, v124
    v_fma_f32 v200, -v193, v207, v200
    v_fma_f32 v201, v193, v206, v201
    v_fma_f32 v206, v192, v200, v109
    v_fma_f32 v207, v192, v201, v125
    v_fma_f32 v206, -v193, v201, v206
    v_fma_f32 v207, v193, v200, v207
    v_fma_f32 v200, v192, v206, v110
    v_fma_f32 v201, v192, v207, v126
    v_fma_f32 v200, -v193, v207, v200
    v_fma_f32 v201, v193, v206, v201
    v_fma_f32 v206, v192, v200, v111
    v_fma_f32 v207, v192, v201, v127
    v_fma_f32 v206, -v193, v201, v206
    v_fma_f32 v207, v193, v200, v207
    v_mov_b32 v200, v206
    v_mov_b32 v201, v207
    v_lshrrev_b32 v208, 5, v1
    s_lshl_b32 s34, s32, 1
    v_add_u32 v208, s34, v208
    v_and_b32 v209, 31, v1
    s_lshl_b32 s34, s33, 5
    v_add_u32 v209, s34, v209
    v_lshlrev_b32 v209, 3, v209
    v_add_u32 v209, 145408, v209
    v_lshl_add_u32 v208, v208, 9, v209
    ds_write_b64 v208, v[200:201]
    v_mov_b32 v210, 148480
    v_mov_b32 v211, 1
    s_waitcnt lgkmcnt(0)
    s_mov_b64 s[88:89], exec
    s_mov_b64 exec, 1
    ds_add_u32 v210, v211
    s_mov_b64 exec, s[88:89]
    s_mov_b32 s82, 100000
    s_waitcnt vmcnt(0)
NPOLL_24:
    v_readfirstlane_b32 s28, v204
    v_readfirstlane_b32 s29, v205
    s_nop 0
    s_cmp_lg_u32 s28, 0
    s_cbranch_scc1 NOK_23
    s_sub_u32 s82, s82, 1
    s_cbranch_scc1 L_END
    buffer_load_dwordx2 v[204:205], v224, s[24:27], 0 offen sc1
    s_waitcnt vmcnt(0)
    s_branch NPOLL_24
NOK_23:
    s_mov_b32 s82, 2000000
SPIN_25:
    ds_read_b32 v212, v210
    s_waitcnt lgkmcnt(0)
    v_readfirstlane_b32 s87, v212
    s_nop 0
    s_cmp_ge_u32 s87, 4
    s_cbranch_scc1 SPOK_26
    s_sleep 1
    s_sub_u32 s82, s82, 1
    s_cbranch_scc0 SPIN_25
SPOK_26:
    ds_read_b64 v[240:241], v209 offset:0
    ds_read_b64 v[242:243], v209 offset:512
    ds_read_b64 v[244:245], v209 offset:1024
    ds_read_b64 v[246:247], v209 offset:1536
    s_waitcnt lgkmcnt(0)
    v_mov_b32 v202, v240
    v_mov_b32 v203, v241
    v_fma_f32 v206, v202, v196, v242
    v_fma_f32 v207, v203, v196, v243
    v_fma_f32 v206, -v203, v197, v206
    v_fma_f32 v203, v202, v197, v207
    v_mov_b32 v202, v206
    v_fma_f32 v206, v202, v196, v244
    v_fma_f32 v207, v203, v196, v245
    v_fma_f32 v206, -v203, v197, v206
    v_fma_f32 v203, v202, v197, v207
    v_mov_b32 v202, v206
    v_fma_f32 v206, v202, v196, v246
    v_fma_f32 v207, v203, v196, v247
    v_fma_f32 v206, -v203, v197, v206
    v_fma_f32 v203, v202, v197, v207
    v_mov_b32 v202, v206
    s_cmp_lg_u32 s32, 0
    s_cbranch_scc1 NOPUB_27
    v_mov_b32 v248, v202
    v_mov_b32 v249, v203
    v_mov_b32 v250, s28
    v_mov_b32 v251, s29
    s_mul_i32 s34, s30, 10240
    s_add_u32 s34, s34, 0
    s_mov_b64 s[88:89], exec
    s_mov_b32 exec_lo, -1
    s_mov_b32 exec_hi, 0
    buffer_store_dwordx4 v[248:251], v226, s[8:11], s34 offen sc1
    s_mov_b64 exec, s[88:89]
NOPUB_27:
    v_mov_b32 v210, 148516
    v_mov_b32 v211, 1
    s_mov_b64 s[88:89], exec
    s_mov_b64 exec, 1
    ds_add_u32 v210, v211
    s_mov_b64 exec, s[88:89]
    v_pk_mul_f32 v[128:129], v[64:65], v[194:195] op_sel:[0,0] op_sel_hi:[1,0]
    v_pk_mul_f32 v[144:145], v[80:81], v[194:195] op_sel:[0,0] op_sel_hi:[1,0] neg_lo:[1,0] neg_hi:[1,0]
    v_pk_fma_f32 v[128:129], v[80:81], v[194:195], v[128:129] op_sel:[0,1,0] op_sel_hi:[1,1,1] neg_lo:[1,0,0] neg_hi:[1,0,0]
    v_pk_fma_f32 v[144:145], v[64:65], v[194:195], v[144:145] op_sel:[0,1,0] op_sel_hi:[1,1,1] neg_lo:[1,0,0] neg_hi:[1,0,0]
    v_pk_mul_f32 v[130:131], v[66:67], v[194:195] op_sel:[0,0] op_sel_hi:[1,0]
    v_pk_mul_f32 v[146:147], v[82:83], v[194:195] op_sel:[0,0] op_sel_hi:[1,0] neg_lo:[1,0] neg_hi:[1,0]
    v_pk_fma_f32 v[130:131], v[82:83], v[194:195], v[130:131] op_sel:[0,1,0] op_sel_hi:[1,1,1] neg_lo:[1,0,0] neg_hi:[1,0,0]
    v_pk_fma_f32 v[146:147], v[66:67], v[194:195], v[146:147] op_sel:[0,1,0] op_sel_hi:[1,1,1] neg_lo:[1,0,0] neg_hi:[1,0,0]
    v_pk_mul_f32 v[132:133], v[68:69], v[194:195] op_sel:[0,0] op_sel_hi:[1,0]
    v_pk_mul_f32 v[148:149], v[84:85], v[194:195] op_sel:[0,0] op_sel_hi:[1,0] neg_lo:[1,0] neg_hi:[1,0]
    v_pk_fma_f32 v[132:133], v[84:85], v[194:195], v[132:133] op_sel:[0,1,0] op_sel_hi:[1,1,1] neg_lo:[1,0,0] neg_hi:[1,0,0]
    v_pk_fma_f32 v[148:149], v[68:69], v[194:195], v[148:149] op_sel:[0,1,0] op_sel_hi:[1,1,1] neg_lo:[1,0,0] neg_hi:[1,0,0]
    v_pk_mul_f32 v[134:135], v[70:71], v[194:195] op_sel:[0,0] op_sel_hi:[1,0]
    v_pk_mul_f32 v[150:151], v[86:87], v[194:195] op_sel:[0,0] op_sel_hi:[1,0] neg_lo:[1,0] neg_hi:[1,0]
    v_pk_fma_f32 v[134:135], v[86:87], v[194:195], v[134:135] op_sel:[0,1,0] op_sel_hi:[1,1,1] neg_lo:[1,0,0] neg_hi:[1,0,0]
    v_pk_fma_f32 v[150:151], v[70:71], v[194:195], v[150:151] op_sel:[0,1,0] op_sel_hi:[1,1,1] neg_lo:[1,0,0] neg_hi:[1,0,0]
    v_pk_mul_f32 v[136:137], v[72:73], v[194:195] op_sel:[0,0] op_sel_hi:[1,0]
    v_pk_mul_f32 v[152:153], v[88:89], v[194:195] op_sel:[0,0] op_sel_hi:[1,0] neg_lo:[1,0] neg_hi:[1,0]
    v_pk_fma_f32 v[136:137], v[88:89], v[194:195], v[136:137] op_sel:[0,1,0] op_sel_hi:[1,1,1] neg_lo:[1,0,0] neg_hi:[1,0,0]
    v_pk_fma_f32 v[152:153], v[72:73], v[194:195], v[152:153] op_sel:[0,1,0] op_sel_hi:[1,1,1] neg_lo:[1,0,0] neg_hi:[1,0,0]
    v_pk_mul_f32 v[138:139], v[74:75], v[194:195] op_sel:[0,0] op_sel_hi:[1,0]
    v_pk_mul_f32 v[154:155], v[90:91], v[194:195] op_sel:[0,0] op_sel_hi:[1,0] neg_lo:[1,0] neg_hi:[1,0]
    v_pk_fma_f32 v[138:139], v[90:91], v[194:195], v[138:139] op_sel:[0,1,0] op_sel_hi:[1,1,1] neg_lo:[1,0,0] neg_hi:[1,0,0]
    v_pk_fma_f32 v[154:155], v[74:75], v[194:195], v[154:155] op_sel:[0,1,0] op_sel_hi:[1,1,1] neg_lo:[1,0,0] neg_hi:[1,0,0]
    v_pk_mul_f32 v[140:141], v[76:77], v[194:195] op_sel:[0,0] op_sel_hi:[1,0]
    v_pk_mul_f32 v[156:157], v[92:93], v[194:195] op_sel:[0,0] op_sel_hi:[1,0] neg_lo:[1,0] neg_hi:[1,0]
    v_pk_fma_f32 v[140:141], v[92:93], v[194:195], v[140:141] op_sel:[0,1,0] op_sel_hi:[1,1,1] neg_lo:[1,0,0] neg_hi:[1,0,0]
    v_pk_fma_f32 v[156:157], v[76:77], v[194:195], v[156:157] op_sel:[0,1,0] op_sel_hi:[1,1,1] neg_lo:[1,0,0] neg_hi:[1,0,0]
    v_pk_mul_f32 v[142:143], v[78:79], v[194:195] op_sel:[0,0] op_sel_hi:[1,0]
    v_pk_mul_f32 v[158:159], v[94:95], v[194:195] op_sel:[0,0] op_sel_hi:[1,0] neg_lo:[1,0] neg_hi:[1,0]
    v_pk_fma_f32 v[142:143], v[94:95], v[194:195], v[142:143] op_sel:[0,1,0] op_sel_hi:[1,1,1] neg_lo:[1,0,0] neg_hi:[1,0,0]
    v_pk_fma_f32 v[158:159], v[78:79], v[194:195], v[158:159] op_sel:[0,1,0] op_sel_hi:[1,1,1] neg_lo:[1,0,0] neg_hi:[1,0,0]
    v_pk_mul_f32 v[160:161], v[96:97], v[194:195] op_sel:[0,0] op_sel_hi:[1,0]
    v_pk_mul_f32 v[176:177], v[112:113], v[194:195] op_sel:[0,0] op_sel_hi:[1,0] neg_lo:[1,0] neg_hi:[1,0]
    v_pk_fma_f32 v[160:161], v[112:113], v[194:195], v[160:161] op_sel:[0,1,0] op_sel_hi:[1,1,1] neg_lo:[1,0,0] neg_hi:[1,0,0]
    v_pk_fma_f32 v[176:177], v[96:97], v[194:195], v[176:177] op_sel:[0,1,0] op_sel_hi:[1,1,1] neg_lo:[1,0,0] neg_hi:[1,0,0]
    v_pk_mul_f32 v[162:163], v[98:99], v[194:195] op_sel:[0,0] op_sel_hi:[1,0]
    v_pk_mul_f32 v[178:179], v[114:115], v[194:195] op_sel:[0,0] op_sel_hi:[1,0] neg_lo:[1,0] neg_hi:[1,0]
    v_pk_fma_f32 v[162:163], v[114:115], v[194:195], v[162:163] op_sel:[0,1,0] op_sel_hi:[1,1,1] neg_lo:[1,0,0] neg_hi:[1,0,0]
    v_pk_fma_f32 v[178:179], v[98:99], v[194:195], v[178:179] op_sel:[0,1,0] op_sel_hi:[1,1,1] neg_lo:[1,0,0] neg_hi:[1,0,0]
    v_pk_mul_f32 v[164:165], v[100:101], v[194:195] op_sel:[0,0] op_sel_hi:[1,0]
    v_pk_mul_f32 v[180:181], v[116:117], v[194:195] op_sel:[0,0] op_sel_hi:[1,0] neg_lo:[1,0] neg_hi:[1,0]
    v_pk_fma_f32 v[164:165], v[116:117], v[194:195], v[164:165] op_sel:[0,1,0] op_sel_hi:[1,1,1] neg_lo:[1,0,0] neg_hi:[1,0,0]
    v_pk_fma_f32 v[180:181], v[100:101], v[194:195], v[180:181] op_sel:[0,1,0] op_sel_hi:[1,1,1] neg_lo:[1,0,0] neg_hi:[1,0,0]
    v_pk_mul_f32 v[166:167], v[102:103], v[194:195] op_sel:[0,0] op_sel_hi:[1,0]
    v_pk_mul_f32 v[182:183], v[118:119], v[194:195] op_sel:[0,0] op_sel_hi:[1,0] neg_lo:[1,0] neg_hi:[1,0]
    v_pk_fma_f32 v[166:167], v[118:119], v[194:195], v[166:167] op_sel:[0,1,0] op_sel_hi:[1,1,1] neg_lo:[1,0,0] neg_hi:[1,0,0]
    v_pk_fma_f32 v[182:183], v[102:103], v[194:195], v[182:183] op_sel:[0,1,0] op_sel_hi:[1,1,1] neg_lo:[1,0,0] neg_hi:[1,0,0]
    v_pk_mul_f32 v[168:169], v[104:105], v[194:195] op_sel:[0,0] op_sel_hi:[1,0]
    v_pk_mul_f32 v[184:185], v[120:121], v[194:195] op_sel:[0,0] op_sel_hi:[1,0] neg_lo:[1,0] neg_hi:[1,0]
    v_pk_fma_f32 v[168:169], v[120:121], v[194:195], v[168:169] op_sel:[0,1,0] op_sel_hi:[1,1,1] neg_lo:[1,0,0] neg_hi:[1,0,0]
    v_pk_fma_f32 v[184:185], v[104:105], v[194:195], v[184:185] op_sel:[0,1,0] op_sel_hi:[1,1,1] neg_lo:[1,0,0] neg_hi:[1,0,0]
    v_pk_mul_f32 v[170:171], v[106:107], v[194:195] op_sel:[0,0] op_sel_hi:[1,0]
    v_pk_mul_f32 v[186:187], v[122:123], v[194:195] op_sel:[0,0] op_sel_hi:[1,0] neg_lo:[1,0] neg_hi:[1,0]
    v_pk_fma_f32 v[170:171], v[122:123], v[194:195], v[170:171] op_sel:[0,1,0] op_sel_hi:[1,1,1] neg_lo:[1,0,0] neg_hi:[1,0,0]
    v_pk_fma_f32 v[186:187], v[106:107], v[194:195], v[186:187] op_sel:[0,1,0] op_sel_hi:[1,1,1] neg_lo:[1,0,0] neg_hi:[1,0,0]
    v_pk_mul_f32 v[172:173], v[108:109], v[194:195] op_sel:[0,0] op_sel_hi:[1,0]
    v_pk_mul_f32 v[188:189], v[124:125], v[194:195] op_sel:[0,0] op_sel_hi:[1,0] neg_lo:[1,0] neg_hi:[1,0]
    v_pk_fma_f32 v[172:173], v[124:125], v[194:195], v[172:173] op_sel:[0,1,0] op_sel_hi:[1,1,1] neg_lo:[1,0,0] neg_hi:[1,0,0]
    v_pk_fma_f32 v[188:189], v[108:109], v[194:195], v[188:189] op_sel:[0,1,0] op_sel_hi:[1,1,1] neg_lo:[1,0,0] neg_hi:[1,0,0]
    v_pk_mul_f32 v[174:175], v[110:111], v[194:195] op_sel:[0,0] op_sel_hi:[1,0]
    v_pk_mul_f32 v[190:191], v[126:127], v[194:195] op_sel:[0,0] op_sel_hi:[1,0] neg_lo:[1,0] neg_hi:[1,0]
    v_pk_fma_f32 v[174:175], v[126:127], v[194:195], v[174:175] op_sel:[0,1,0] op_sel_hi:[1,1,1] neg_lo:[1,0,0] neg_hi:[1,0,0]
    v_pk_fma_f32 v[190:191], v[110:111], v[194:195], v[190:191] op_sel:[0,1,0] op_sel_hi:[1,1,1] neg_lo:[1,0,0] neg_hi:[1,0,0]
    s_add_u32 s92, s74, 0
    s_addc_u32 s93, s75, 0
    s_and_b32 s93, s93, 0xffff
    s_mov_b32 s94, 163840
    s_mov_b32 s95, 0x00020000
    v_mul_f32 v206, v198, v198
    v_mul_f32 v207, v198, v199
    v_fma_f32 v206, -v199, v199, v206
    v_fma_f32 v215, v199, v198, v207
    v_mov_b32 v214, v206
    v_lshrrev_b32 v208, 5, v1
    s_sub_u32 s34, s30, 1
    v_sub_u32 v208, s34, v208
    v_mul_i32_i24 v208, 10240, v208
    v_add_u32 v228, v208, v226
    v_subrev_u32 v229, 20480, v228
    v_subrev_u32 v230, 40960, v228
    v_subrev_u32 v231, 61440, v228
    v_subrev_u32 v232, 81920, v228
    v_subrev_u32 v233, 102400, v228
    v_subrev_u32 v234, 122880, v228
    v_subrev_u32 v235, 143360, v228
    s_mov_b32 s82, 100000
EPOLL_30:
    buffer_load_dwordx4 v[16:19], v228, s[92:95], 0 offen sc1
    buffer_load_dwordx4 v[20:23], v229, s[92:95], 0 offen sc1
    buffer_load_dwordx4 v[24:27], v230, s[92:95], 0 offen sc1
    buffer_load_dwordx4 v[28:31], v231, s[92:95], 0 offen sc1
    buffer_load_dwordx4 v[32:35], v232, s[92:95], 0 offen sc1
    buffer_load_dwordx4 v[36:39], v233, s[92:95], 0 offen sc1
    buffer_load_dwordx4 v[40:43], v234, s[92:95], 0 offen sc1
    buffer_load_dwordx4 v[44:47], v235, s[92:95], 0 offen sc1
    s_mov_b64 s[84:85], 0
    s_waitcnt vmcnt(7)
    v_cmp_ne_u64 vcc, s[28:29], v[18:19]
    v_cmp_le_i32 s[86:87], 0, v228
    s_and_b64 vcc, vcc, s[86:87]
    s_or_b64 s[84:85], s[84:85], vcc
    s_waitcnt vmcnt(6)
    v_cmp_ne_u64 vcc, s[28:29], v[22:23]
    v_cmp_le_i32 s[86:87], 0, v229
    s_and_b64 vcc, vcc, s[86:87]
    s_or_b64 s[84:85], s[84:85], vcc
    s_waitcnt vmcnt(5)
    v_cmp_ne_u64 vcc, s[28:29], v[26:27]
    v_cmp_le_i32 s[86:87], 0, v230
    s_and_b64 vcc, vcc, s[86:87]
    s_or_b64 s[84:85], s[84:85], vcc
    s_waitcnt vmcnt(4)
    v_cmp_ne_u64 vcc, s[28:29], v[30:31]
    v_cmp_le_i32 s[86:87], 0, v231
    s_and_b64 vcc, vcc, s[86:87]
    s_or_b64 s[84:85], s[84:85], vcc
    s_waitcnt vmcnt(3)
    v_cmp_ne_u64 vcc, s[28:29], v[34:35]
    v_cmp_le_i32 s[86:87], 0, v232
    s_and_b64 vcc, vcc, s[86:87]
    s_or_b64 s[84:85], s[84:85], vcc
    s_waitcnt vmcnt(2)
    v_cmp_ne_u64 vcc, s[28:29], v[38:39]
    v_cmp_le_i32 s[86:87], 0, v233
    s_and_b64 vcc, vcc, s[86:87]
    s_or_b64 s[84:85], s[84:85], vcc
    s_waitcnt vmcnt(1)
    v_cmp_ne_u64 vcc, s[28:29], v[42:43]
    v_cmp_le_i32 s[86:87], 0, v234
    s_and_b64 vcc, vcc, s[86:87]
    s_or_b64 s[84:85], s[84:85], vcc
    s_waitcnt vmcnt(0)
    v_cmp_ne_u64 vcc, s[28:29], v[46:47]
    v_cmp_le_i32 s[86:87], 0, v235
    s_and_b64 vcc, vcc, s[86:87]
    s_or_b64 s[84:85], s[84:85], vcc
    s_cmp_eq_u64 s[84:85], 0
    s_cbranch_scc1 EOK_31
    s_sleep 2
    s_sub_u32 s82, s82, 1
    s_cbranch_scc0 EPOLL_30
    s_branch L_END
    v_readfirstlane_b32 s35, v226
    s_sub_u32 s34, s30, 1
    v_sub_u32 v218, s34, v1
    v_mul_i32_i24 v218, 10240, v218
    v_add_u32 v218, s35, v218
    v_cmp_le_i32 s[86:87], 0, v218
    s_and_b64 s[86:87], s[86:87], 0xffff
ECH_32:
    s_sleep 2
    buffer_load_dwordx4 v[16:19], v218, s[92:95], 0 offen sc1
    s_waitcnt vmcnt(0)
    v_cmp_ne_u64 vcc, s[28:29], v[18:19]
    s_and_b64 vcc, vcc, s[86:87]
    s_cmp_eq_u64 vcc, 0
    s_cbranch_scc1 EPOLL_30
    s_sub_u32 s82, s82, 1
    s_cbranch_scc0 ECH_32
    s_branch L_END
EOK_31:
    v_mov_b32 v202, v44
    v_mov_b32 v203, v45
    v_fma_f32 v206, v202, v214, v40
    v_fma_f32 v207, v203, v214, v41
    v_fma_f32 v206, -v203, v215, v206
    v_fma_f32 v207, v202, v215, v207
    v_fma_f32 v202, v206, v214, v36
    v_fma_f32 v203, v207, v214, v37
    v_fma_f32 v202, -v207, v215, v202
    v_fma_f32 v203, v206, v215, v203
    v_fma_f32 v206, v202, v214, v32
    v_fma_f32 v207, v203, v214, v33
    v_fma_f32 v206, -v203, v215, v206
    v_fma_f32 v207, v202, v215, v207
    v_fma_f32 v202, v206, v214, v28
    v_fma_f32 v203, v207, v214, v29
    v_fma_f32 v202, -v207, v215, v202
    v_fma_f32 v203, v206, v215, v203
    v_fma_f32 v206, v202, v214, v24
    v_fma_f32 v207, v203, v214, v25
    v_fma_f32 v206, -v203, v215, v206
    v_fma_f32 v207, v202, v215, v207
    v_fma_f32 v202, v206, v214, v20
    v_fma_f32 v203, v207, v214, v21
    v_fma_f32 v202, -v207, v215, v202
    v_fma_f32 v203, v206, v215, v203
    v_fma_f32 v206, v202, v214, v16
    v_fma_f32 v207, v203, v214, v17
    v_fma_f32 v206, -v203, v215, v206
    v_fma_f32 v207, v202, v215, v207
    v_mov_b32 v208, v206
    v_mov_b32 v209, v207
    s_nop 1
    v_permlane32_swap_b32 v206, v208
    v_permlane32_swap_b32 v207, v209
    s_nop 1
    v_fma_f32 v202, v208, v198, v206
    v_fma_f32 v203, v209, v198, v207
    v_fma_f32 v202, -v209, v199, v202
    v_fma_f32 v203, v208, v199, v203
    v_mov_b32 v210, 148496
    v_mov_b32 v211, 1
    s_mov_b64 s[88:89], exec
    s_mov_b64 exec, 1
    ds_add_u32 v210, v211
    s_mov_b64 exec, s[88:89]
    s_cmp_lg_u32 s32, 0
    s_cbranch_scc1 WM1_33
    v_mov_b32 v252, v202
    v_mov_b32 v253, v203
    v_fma_f32 v206, v202, v196, v240
    v_fma_f32 v207, v203, v196, v241
    v_fma_f32 v206, -v203, v197, v206
    v_fma_f32 v203, v202, v197, v207
    v_mov_b32 v202, v206
    s_branch WMD_34
WM1_33:
    v_fma_f32 v206, v202, v196, v240
    v_fma_f32 v207, v203, v196, v241
    v_fma_f32 v206, -v203, v197, v206
    v_fma_f32 v203, v202, v197, v207
    v_mov_b32 v202, v206
    v_fma_f32 v206, v202, v196, v242
    v_fma_f32 v207, v203, v196, v243
    v_fma_f32 v206, -v203, v197, v206
    v_fma_f32 v203, v202, v197, v207
    v_mov_b32 v202, v206
    v_mov_b32 v252, v202
    v_mov_b32 v253, v203
    v_fma_f32 v206, v202, v196, v244
    v_fma_f32 v207, v203, v196, v245
    v_fma_f32 v206, -v203, v197, v206
    v_fma_f32 v203, v202, v197, v207
    v_mov_b32 v202, v206
WMD_34:
    v_cmp_gt_u32 vcc, 32, v1
    s_nop 1
    v_cndmask_b32 v202, v202, v252, vcc
    v_cndmask_b32 v203, v203, v253, vcc
    v_mul_f32 v206, v202, v194
    v_mul_f32 v207, -v203, v194
    v_fma_f32 v206, -v203, v195, v206
    v_fma_f32 v203, -v202, v195, v207
    v_mov_b32 v202, v206
    s_mul_i32 s34, s30, 20
    s_add_u32 s34, s34, s31
    s_lshl_b32 s34, s34, 14
    s_lshl_b32 s35, s3, 12
    s_add_u32 s34, s34, s35
    s_add_u32 s79, s34, 1048576
    s_add_u32 s80, s79, 163840
    v_fma_f32 v128, v192, v202, v128
    v_fma_f32 v144, v192, v203, v144
    v_fma_f32 v128, v193, v203, v128
    v_fma_f32 v144, -v193, v202, v144
    v_fma_f32 v129, v192, v128, v129
    v_fma_f32 v145, v192, v144, v145
    v_fma_f32 v129, v193, v144, v129
    v_fma_f32 v145, -v193, v128, v145
    v_cvt_pk_bf16_f32 v16, v128, v129
    v_cvt_pk_bf16_f32 v32, v144, v145
    v_fma_f32 v130, v192, v129, v130
    v_fma_f32 v146, v192, v145, v146
    v_fma_f32 v130, v193, v145, v130
    v_fma_f32 v146, -v193, v129, v146
    v_fma_f32 v131, v192, v130, v131
    v_fma_f32 v147, v192, v146, v147
    v_fma_f32 v131, v193, v146, v131
    v_fma_f32 v147, -v193, v130, v147
    v_cvt_pk_bf16_f32 v17, v130, v131
    v_cvt_pk_bf16_f32 v33, v146, v147
    v_fma_f32 v132, v192, v131, v132
    v_fma_f32 v148, v192, v147, v148
    v_fma_f32 v132, v193, v147, v132
    v_fma_f32 v148, -v193, v131, v148
    v_fma_f32 v133, v192, v132, v133
    v_fma_f32 v149, v192, v148, v149
    v_fma_f32 v133, v193, v148, v133
    v_fma_f32 v149, -v193, v132, v149
    v_cvt_pk_bf16_f32 v18, v132, v133
    v_cvt_pk_bf16_f32 v34, v148, v149
    v_fma_f32 v134, v192, v133, v134
    v_fma_f32 v150, v192, v149, v150
    v_fma_f32 v134, v193, v149, v134
    v_fma_f32 v150, -v193, v133, v150
    v_fma_f32 v135, v192, v134, v135
    v_fma_f32 v151, v192, v150, v151
    v_fma_f32 v135, v193, v150, v135
    v_fma_f32 v151, -v193, v134, v151
    v_cvt_pk_bf16_f32 v19, v134, v135
    v_cvt_pk_bf16_f32 v35, v150, v151
    buffer_store_dwordx4 v[16:19], v225, s[8:11], s79 offen offset:0 sc1
    buffer_store_dwordx4 v[32:35], v225, s[8:11], s80 offen offset:0 sc1
    v_fma_f32 v136, v192, v135, v136
    v_fma_f32 v152, v192, v151, v152
    v_fma_f32 v136, v193, v151, v136
    v_fma_f32 v152, -v193, v135, v152
    v_fma_f32 v137, v192, v136, v137
    v_fma_f32 v153, v192, v152, v153
    v_fma_f32 v137, v193, v152, v137
    v_fma_f32 v153, -v193, v136, v153
    v_cvt_pk_bf16_f32 v20, v136, v137
    v_cvt_pk_bf16_f32 v36, v152, v153
    v_fma_f32 v138, v192, v137, v138
    v_fma_f32 v154, v192, v153, v154
    v_fma_f32 v138, v193, v153, v138
    v_fma_f32 v154, -v193, v137, v154
    v_fma_f32 v139, v192, v138, v139
    v_fma_f32 v155, v192, v154, v155
    v_fma_f32 v139, v193, v154, v139
    v_fma_f32 v155, -v193, v138, v155
    v_cvt_pk_bf16_f32 v21, v138, v139
    v_cvt_pk_bf16_f32 v37, v154, v155
    v_fma_f32 v140, v192, v139, v140
    v_fma_f32 v156, v192, v155, v156
    v_fma_f32 v140, v193, v155, v140
    v_fma_f32 v156, -v193, v139, v156
    v_fma_f32 v141, v192, v140, v141
    v_fma_f32 v157, v192, v156, v157
    v_fma_f32 v141, v193, v156, v141
    v_fma_f32 v157, -v193, v140, v157
    v_cvt_pk_bf16_f32 v22, v140, v141
    v_cvt_pk_bf16_f32 v38, v156, v157
    v_fma_f32 v142, v192, v141, v142
    v_fma_f32 v158, v192, v157, v158
    v_fma_f32 v142, v193, v157, v142
    v_fma_f32 v158, -v193, v141, v158
    v_fma_f32 v143, v192, v142, v143
    v_fma_f32 v159, v192, v158, v159
    v_fma_f32 v143, v193, v158, v143
    v_fma_f32 v159, -v193, v142, v159
    v_cvt_pk_bf16_f32 v23, v142, v143
    v_cvt_pk_bf16_f32 v39, v158, v159
    buffer_store_dwordx4 v[20:23], v225, s[8:11], s79 offen offset:1024 sc1
    buffer_store_dwordx4 v[36:39], v225, s[8:11], s80 offen offset:1024 sc1
    v_fma_f32 v160, v192, v143, v160
    v_fma_f32 v176, v192, v159, v176
    v_fma_f32 v160, v193, v159, v160
    v_fma_f32 v176, -v193, v143, v176
    v_fma_f32 v161, v192, v160, v161
    v_fma_f32 v177, v192, v176, v177
    v_fma_f32 v161, v193, v176, v161
    v_fma_f32 v177, -v193, v160, v177
    v_cvt_pk_bf16_f32 v24, v160, v161
    v_cvt_pk_bf16_f32 v40, v176, v177
    v_fma_f32 v162, v192, v161, v162
    v_fma_f32 v178, v192, v177, v178
    v_fma_f32 v162, v193, v177, v162
    v_fma_f32 v178, -v193, v161, v178
    v_fma_f32 v163, v192, v162, v163
    v_fma_f32 v179, v192, v178, v179
    v_fma_f32 v163, v193, v178, v163
    v_fma_f32 v179, -v193, v162, v179
    v_cvt_pk_bf16_f32 v25, v162, v163
    v_cvt_pk_bf16_f32 v41, v178, v179
    v_fma_f32 v164, v192, v163, v164
    v_fma_f32 v180, v192, v179, v180
    v_fma_f32 v164, v193, v179, v164
    v_fma_f32 v180, -v193, v163, v180
    v_fma_f32 v165, v192, v164, v165
    v_fma_f32 v181, v192, v180, v181
    v_fma_f32 v165, v193, v180, v165
    v_fma_f32 v181, -v193, v164, v181
    v_cvt_pk_bf16_f32 v26, v164, v165
    v_cvt_pk_bf16_f32 v42, v180, v181
    v_fma_f32 v166, v192, v165, v166
    v_fma_f32 v182, v192, v181, v182
    v_fma_f32 v166, v193, v181, v166
    v_fma_f32 v182, -v193, v165, v182
    v_fma_f32 v167, v192, v166, v167
    v_fma_f32 v183, v192, v182, v183
    v_fma_f32 v167, v193, v182, v167
    v_fma_f32 v183, -v193, v166, v183
    v_cvt_pk_bf16_f32 v27, v166, v167
    v_cvt_pk_bf16_f32 v43, v182, v183
    buffer_store_dwordx4 v[24:27], v225, s[8:11], s79 offen offset:2048 sc1
    buffer_store_dwordx4 v[40:43], v225, s[8:11], s80 offen offset:2048 sc1
    v_fma_f32 v168, v192, v167, v168
    v_fma_f32 v184, v192, v183, v184
    v_fma_f32 v168, v193, v183, v168
    v_fma_f32 v184, -v193, v167, v184
    v_fma_f32 v169, v192, v168, v169
    v_fma_f32 v185, v192, v184, v185
    v_fma_f32 v169, v193, v184, v169
    v_fma_f32 v185, -v193, v168, v185
    v_cvt_pk_bf16_f32 v28, v168, v169
    v_cvt_pk_bf16_f32 v44, v184, v185
    v_fma_f32 v170, v192, v169, v170
    v_fma_f32 v186, v192, v185, v186
    v_fma_f32 v170, v193, v185, v170
    v_fma_f32 v186, -v193, v169, v186
    v_fma_f32 v171, v192, v170, v171
    v_fma_f32 v187, v192, v186, v187
    v_fma_f32 v171, v193, v186, v171
    v_fma_f32 v187, -v193, v170, v187
    v_cvt_pk_bf16_f32 v29, v170, v171
    v_cvt_pk_bf16_f32 v45, v186, v187
    v_fma_f32 v172, v192, v171, v172
    v_fma_f32 v188, v192, v187, v188
    v_fma_f32 v172, v193, v187, v172
    v_fma_f32 v188, -v193, v171, v188
    v_fma_f32 v173, v192, v172, v173
    v_fma_f32 v189, v192, v188, v189
    v_fma_f32 v173, v193, v188, v173
    v_fma_f32 v189, -v193, v172, v189
    v_cvt_pk_bf16_f32 v30, v172, v173
    v_cvt_pk_bf16_f32 v46, v188, v189
    v_fma_f32 v174, v192, v173, v174
    v_fma_f32 v190, v192, v189, v190
    v_fma_f32 v174, v193, v189, v174
    v_fma_f32 v190, -v193, v173, v190
    v_fma_f32 v175, v192, v174, v175
    v_fma_f32 v191, v192, v190, v191
    v_fma_f32 v175, v193, v190, v175
    v_fma_f32 v191, -v193, v174, v191
    v_cvt_pk_bf16_f32 v31, v174, v175
    v_cvt_pk_bf16_f32 v47, v190, v191
    buffer_store_dwordx4 v[28:31], v225, s[8:11], s79 offen offset:3072 sc1
    buffer_store_dwordx4 v[44:47], v225, s[8:11], s80 offen offset:3072 sc1
    v_mov_b32 v210, 148488
    s_mov_b32 s82, 2000000
SPIN_35:
    ds_read_b32 v212, v210
    s_waitcnt lgkmcnt(0)
    v_readfirstlane_b32 s87, v212
    s_nop 0
    s_cmp_ge_u32 s87, 4
    s_cbranch_scc1 SPOK_36
    s_sleep 1
    s_sub_u32 s82, s82, 1
    s_cbranch_scc0 SPIN_35
SPOK_36:
    v_lshrrev_b32 v214, 5, v1
    v_bfe_u32 v215, v1, 2, 2
    v_lshl_add_u32 v214, v214, 2, v215
    s_lshl_b32 s34, s32, 6
    v_add_u32 v214, s34, v214
    v_lshlrev_b32 v213, 7, v214
    v_bfe_u32 v214, v1, 4, 1
    v_lshlrev_b32 v214, 5, v214
    v_and_b32 v215, 3, v1
    v_lshl_add_u32 v214, v215, 3, v214
    s_lshl_b32 s34, s33, 6
    s_add_u32 s34, s34, 73728
    v_add_u32 v214, s34, v214
    v_add_u32 v213, v213, v214
    ds_read_b64_tr_b16 v[96:97], v213 offset:0
    ds_read_b64_tr_b16 v[98:99], v213 offset:1024
    ds_read_b64_tr_b16 v[100:101], v213 offset:2048
    ds_read_b64_tr_b16 v[102:103], v213 offset:3072
    ds_read_b64_tr_b16 v[104:105], v213 offset:4096
    ds_read_b64_tr_b16 v[106:107], v213 offset:5120
    ds_read_b64_tr_b16 v[108:109], v213 offset:6144
    ds_read_b64_tr_b16 v[110:111], v213 offset:7168
    s_waitcnt lgkmcnt(0)
    v_lshlrev_b32 v64, 16, v96
    v_and_b32 v65, 0xffff0000, v96
    v_mul_f32 v64, v64, v227
    v_mul_f32 v65, v65, v227
    v_cvt_pk_bf16_f32 v64, v64, v65
    v_and_b32 v65, 0xffff0000, v64
    v_lshlrev_b32 v64, 16, v64
    v_lshlrev_b32 v66, 16, v97
    v_and_b32 v67, 0xffff0000, v97
    v_mul_f32 v66, v66, v227
    v_mul_f32 v67, v67, v227
    v_cvt_pk_bf16_f32 v66, v66, v67
    v_and_b32 v67, 0xffff0000, v66
    v_lshlrev_b32 v66, 16, v66
    v_lshlrev_b32 v68, 16, v98
    v_and_b32 v69, 0xffff0000, v98
    v_mul_f32 v68, v68, v227
    v_mul_f32 v69, v69, v227
    v_cvt_pk_bf16_f32 v68, v68, v69
    v_and_b32 v69, 0xffff0000, v68
    v_lshlrev_b32 v68, 16, v68
    v_lshlrev_b32 v70, 16, v99
    v_and_b32 v71, 0xffff0000, v99
    v_mul_f32 v70, v70, v227
    v_mul_f32 v71, v71, v227
    v_cvt_pk_bf16_f32 v70, v70, v71
    v_and_b32 v71, 0xffff0000, v70
    v_lshlrev_b32 v70, 16, v70
    v_lshlrev_b32 v72, 16, v100
    v_and_b32 v73, 0xffff0000, v100
    v_mul_f32 v72, v72, v227
    v_mul_f32 v73, v73, v227
    v_cvt_pk_bf16_f32 v72, v72, v73
    v_and_b32 v73, 0xffff0000, v72
    v_lshlrev_b32 v72, 16, v72
    v_lshlrev_b32 v74, 16, v101
    v_and_b32 v75, 0xffff0000, v101
    v_mul_f32 v74, v74, v227
    v_mul_f32 v75, v75, v227
    v_cvt_pk_bf16_f32 v74, v74, v75
    v_and_b32 v75, 0xffff0000, v74
    v_lshlrev_b32 v74, 16, v74
    v_lshlrev_b32 v76, 16, v102
    v_and_b32 v77, 0xffff0000, v102
    v_mul_f32 v76, v76, v227
    v_mul_f32 v77, v77, v227
    v_cvt_pk_bf16_f32 v76, v76, v77
    v_and_b32 v77, 0xffff0000, v76
    v_lshlrev_b32 v76, 16, v76
    v_lshlrev_b32 v78, 16, v103
    v_and_b32 v79, 0xffff0000, v103
    v_mul_f32 v78, v78, v227
    v_mul_f32 v79, v79, v227
    v_cvt_pk_bf16_f32 v78, v78, v79
    v_and_b32 v79, 0xffff0000, v78
    v_lshlrev_b32 v78, 16, v78
    v_lshlrev_b32 v80, 16, v104
    v_and_b32 v81, 0xffff0000, v104
    v_mul_f32 v80, v80, v227
    v_mul_f32 v81, v81, v227
    v_cvt_pk_bf16_f32 v80, v80, v81
    v_and_b32 v81, 0xffff0000, v80
    v_lshlrev_b32 v80, 16, v80
    v_lshlrev_b32 v82, 16, v105
    v_and_b32 v83, 0xffff0000, v105
    v_mul_f32 v82, v82, v227
    v_mul_f32 v83, v83, v227
    v_cvt_pk_bf16_f32 v82, v82, v83
    v_and_b32 v83, 0xffff0000, v82
    v_lshlrev_b32 v82, 16, v82
    v_lshlrev_b32 v84, 16, v106
    v_and_b32 v85, 0xffff0000, v106
    v_mul_f32 v84, v84, v227
    v_mul_f32 v85, v85, v227
    v_cvt_pk_bf16_f32 v84, v84, v85
    v_and_b32 v85, 0xffff0000, v84
    v_lshlrev_b32 v84, 16, v84
    v_lshlrev_b32 v86, 16, v107
    v_and_b32 v87, 0xffff0000, v107
    v_mul_f32 v86, v86, v227
    v_mul_f32 v87, v87, v227
    v_cvt_pk_bf16_f32 v86, v86, v87
    v_and_b32 v87, 0xffff0000, v86
    v_lshlrev_b32 v86, 16, v86
    v_lshlrev_b32 v88, 16, v108
    v_and_b32 v89, 0xffff0000, v108
    v_mul_f32 v88, v88, v227
    v_mul_f32 v89, v89, v227
    v_cvt_pk_bf16_f32 v88, v88, v89
    v_and_b32 v89, 0xffff0000, v88
    v_lshlrev_b32 v88, 16, v88
    v_lshlrev_b32 v90, 16, v109
    v_and_b32 v91, 0xffff0000, v109
    v_mul_f32 v90, v90, v227
    v_mul_f32 v91, v91, v227
    v_cvt_pk_bf16_f32 v90, v90, v91
    v_and_b32 v91, 0xffff0000, v90
    v_lshlrev_b32 v90, 16, v90
    v_lshlrev_b32 v92, 16, v110
    v_and_b32 v93, 0xffff0000, v110
    v_mul_f32 v92, v92, v227
    v_mul_f32 v93, v93, v227
    v_cvt_pk_bf16_f32 v92, v92, v93
    v_and_b32 v93, 0xffff0000, v92
    v_lshlrev_b32 v92, 16, v92
    v_lshlrev_b32 v94, 16, v111
    v_and_b32 v95, 0xffff0000, v111
    v_mul_f32 v94, v94, v227
    v_mul_f32 v95, v95, v227
    v_cvt_pk_bf16_f32 v94, v94, v95
    v_and_b32 v95, 0xffff0000, v94
    v_lshlrev_b32 v94, 16, v94
    v_lshrrev_b32 v206, 4, v1
    v_bfe_u32 v207, v1, 2, 2
    v_and_b32 v208, 3, v1
    v_and_b32 v209, 1, v206
    v_lshlrev_b32 v209, 1, v209
    v_lshrrev_b32 v210, 1, v208
    v_add_u32 v209, v209, v210
    v_mul_u32_u24 v209, 1088, v209
    v_lshrrev_b32 v210, 1, v206
    v_lshl_add_u32 v210, v210, 3, v207
    v_lshl_add_u32 v209, v210, 4, v209
    v_and_b32 v210, 1, v208
    v_lshl_add_u32 v209, v210, 3, v209
    s_mul_i32 s34, s32, 8704
    v_add_u32 v6, s34, v209
    v_add_u32 v7, 52224, v6
    v_xor_b32 v2, 0, v221
    v_add_u32 v10, 104448, v2
    v_xor_b32 v3, 32, v221
    v_add_u32 v11, 104448, v3
    v_xor_b32 v4, 64, v221
    v_add_u32 v12, 104448, v4
    v_xor_b32 v5, 96, v221
    v_add_u32 v13, 104448, v5
    s_waitcnt vmcnt(0)
    v_mov_b32 v210, 148484
    v_mov_b32 v211, 1
    s_mov_b64 s[88:89], exec
    s_mov_b64 exec, 1
    ds_add_rtn_u32 v212, v210, v211
    s_waitcnt lgkmcnt(0)
    v_readfirstlane_b32 s87, v212
    s_nop 0
    s_cmp_lg_u32 s87, 3
    s_cbranch_scc1 NOHF_37
    s_lshl_b32 s34, s30, 7
    s_lshl_b32 s35, s31, 3
    s_add_u32 s34, s34, s35
    s_add_u32 s34, s34, 262144
    v_mov_b32 v248, s28
    v_mov_b32 v249, s29
    buffer_store_dwordx2 v[248:249], v224, s[8:11], s34 offen sc1
NOHF_37:
    s_mov_b64 exec, s[88:89]
    v_mov_b32 v244, 148500
    s_mov_b32 s82, 2000000
SPIN_38:
    ds_read_b32 v245, v244
    s_waitcnt lgkmcnt(0)
    v_readfirstlane_b32 s87, v245
    s_nop 0
    s_cmp_ge_u32 s87, 4
    s_cbranch_scc1 SPOK_39
    s_sleep 1
    s_sub_u32 s82, s82, 1
    s_cbranch_scc0 SPIN_38
SPOK_39:
    ds_read_b128 v[96:99], v2 offset:0
    ds_read_b128 v[100:103], v3 offset:0
    ds_read_b128 v[104:107], v4 offset:0
    ds_read_b128 v[108:111], v5 offset:0
    ds_read_b128 v[112:115], v2 offset:8192
    ds_read_b128 v[116:119], v3 offset:8192
    ds_read_b128 v[120:123], v4 offset:8192
    ds_read_b128 v[124:127], v5 offset:8192
    ds_read_b128 v[128:131], v2 offset:16384
    ds_read_b128 v[132:135], v3 offset:16384
    ds_read_b128 v[136:139], v4 offset:16384
    ds_read_b128 v[140:143], v5 offset:16384
    s_waitcnt lgkmcnt(4)
    ds_read_b128 v[144:147], v2 offset:24576
    ds_read_b128 v[148:151], v3 offset:24576
    ds_read_b128 v[152:155], v4 offset:24576
    ds_read_b128 v[156:159], v5 offset:24576
    ds_read_b128 v[160:163], v2 offset:32768
    ds_read_b128 v[164:167], v3 offset:32768
    ds_read_b128 v[168:171], v4 offset:32768
    ds_read_b128 v[172:175], v5 offset:32768
    ds_read_b128 v[176:179], v2 offset:40960
    ds_read_b128 v[180:183], v3 offset:40960
    ds_read_b128 v[184:187], v4 offset:40960
    ds_read_b128 v[188:191], v5 offset:40960
    s_waitcnt lgkmcnt(4)
    ds_read_b128 v[192:195], v2 offset:49152
    ds_read_b128 v[196:199], v3 offset:49152
    ds_read_b128 v[200:203], v4 offset:49152
    ds_read_b128 v[204:207], v5 offset:49152
    ds_read_b128 v[208:211], v2 offset:57344
    ds_read_b128 v[212:215], v3 offset:57344
    ds_read_b128 v[216:219], v4 offset:57344
    ds_read_b128 v[220:223], v5 offset:57344
    v_add_u32 v246, 65536, v2
    ds_read_b128 v[224:227], v246
    v_add_u32 v246, 65536, v3
    ds_read_b128 v[228:231], v246
    v_add_u32 v246, 65536, v4
    ds_read_b128 v[232:235], v246
    v_add_u32 v246, 65536, v5
    ds_read_b128 v[236:239], v246
    s_waitcnt lgkmcnt(4)
    s_waitcnt lgkmcnt(0)
    v_mov_b32 v244, 148504
    v_mov_b32 v245, 1
    s_mov_b64 s[88:89], exec
    s_mov_b64 exec, 1
    ds_add_u32 v244, v245
    s_mov_b64 exec, s[88:89]
    s_barrier
    ds_read_b64_tr_b16 v[16:17], v6 offset:0
    ds_read_b64_tr_b16 v[18:19], v6 offset:64
    ds_read_b64_tr_b16 v[20:21], v6 offset:512
    ds_read_b64_tr_b16 v[22:23], v6 offset:576
    ds_read_b64_tr_b16 v[28:29], v6 offset:256
    ds_read_b64_tr_b16 v[30:31], v6 offset:320
    ds_read_b64_tr_b16 v[32:33], v6 offset:768
    ds_read_b64_tr_b16 v[34:35], v6 offset:832
    ds_read_b64_tr_b16 v[40:41], v6 offset:4352
    ds_read_b64_tr_b16 v[42:43], v6 offset:4416
    ds_read_b64_tr_b16 v[44:45], v6 offset:4864
    ds_read_b64_tr_b16 v[46:47], v6 offset:4928
    s_waitcnt lgkmcnt(8)
    v_mfma_f32_32x32x16_bf16 v[64:79], v[16:19], v[96:99], v[64:79]
    ds_read_b64_tr_b16 v[52:53], v6 offset:4608
    ds_read_b64_tr_b16 v[54:55], v6 offset:4672
    v_mfma_f32_32x32x16_bf16 v[80:95], v[20:23], v[96:99], v[80:95]
    ds_read_b64_tr_b16 v[56:57], v6 offset:5120
    ds_read_b64_tr_b16 v[58:59], v6 offset:5184
    s_waitcnt lgkmcnt(8)
    s_barrier
    v_mfma_f32_32x32x16_bf16 v[64:79], v[28:31], v[100:103], v[64:79]
    ds_read_b64_tr_b16 v[16:17], v6 offset:17408
    ds_read_b64_tr_b16 v[18:19], v6 offset:17472
    v_mfma_f32_32x32x16_bf16 v[80:95], v[32:35], v[100:103], v[80:95]
    ds_read_b64_tr_b16 v[20:21], v6 offset:17920
    ds_read_b64_tr_b16 v[22:23], v6 offset:17984
    s_waitcnt lgkmcnt(8)
    v_mfma_f32_32x32x16_bf16 v[64:79], v[40:43], v[104:107], v[64:79]
    ds_read_b64_tr_b16 v[28:29], v6 offset:17664
    ds_read_b64_tr_b16 v[30:31], v6 offset:17728
    v_mfma_f32_32x32x16_bf16 v[80:95], v[44:47], v[104:107], v[80:95]
    ds_read_b64_tr_b16 v[32:33], v6 offset:18176
    ds_read_b64_tr_b16 v[34:35], v6 offset:18240
    s_waitcnt lgkmcnt(8)
    v_mfma_f32_32x32x16_bf16 v[64:79], v[52:55], v[108:111], v[64:79]
    ds_read_b64_tr_b16 v[40:41], v6 offset:21760
    ds_read_b64_tr_b16 v[42:43], v6 offset:21824
    v_mfma_f32_32x32x16_bf16 v[80:95], v[56:59], v[108:111], v[80:95]
    ds_read_b64_tr_b16 v[44:45], v6 offset:22272
    ds_read_b64_tr_b16 v[46:47], v6 offset:22336
    s_waitcnt lgkmcnt(8)
    v_mfma_f32_32x32x16_bf16 v[64:79], v[16:19], v[112:115], v[64:79]
    ds_read_b64_tr_b16 v[52:53], v6 offset:22016
    ds_read_b64_tr_b16 v[54:55], v6 offset:22080
    v_mfma_f32_32x32x16_bf16 v[80:95], v[20:23], v[112:115], v[80:95]
    ds_read_b64_tr_b16 v[56:57], v6 offset:22528
    ds_read_b64_tr_b16 v[58:59], v6 offset:22592
    s_waitcnt lgkmcnt(8)
    s_barrier
    v_mfma_f32_32x32x16_bf16 v[64:79], v[28:31], v[116:119], v[64:79]
    ds_read_b64_tr_b16 v[16:17], v6 offset:34816
    ds_read_b64_tr_b16 v[18:19], v6 offset:34880
    v_mfma_f32_32x32x16_bf16 v[80:95], v[32:35], v[116:119], v[80:95]
    ds_read_b64_tr_b16 v[20:21], v6 offset:35328
    ds_read_b64_tr_b16 v[22:23], v6 offset:35392
    s_waitcnt lgkmcnt(8)
    v_mfma_f32_32x32x16_bf16 v[64:79], v[40:43], v[120:123], v[64:79]
    ds_read_b64_tr_b16 v[28:29], v6 offset:35072
    ds_read_b64_tr_b16 v[30:31], v6 offset:35136
    v_mfma_f32_32x32x16_bf16 v[80:95], v[44:47], v[120:123], v[80:95]
    ds_read_b64_tr_b16 v[32:33], v6 offset:35584
    ds_read_b64_tr_b16 v[34:35], v6 offset:35648
    s_waitcnt lgkmcnt(8)
    v_mfma_f32_32x32x16_bf16 v[64:79], v[52:55], v[124:127], v[64:79]
    ds_read_b64_tr_b16 v[40:41], v6 offset:39168
    ds_read_b64_tr_b16 v[42:43], v6 offset:39232
    v_mfma_f32_32x32x16_bf16 v[80:95], v[56:59], v[124:127], v[80:95]
    ds_read_b64_tr_b16 v[44:45], v6 offset:39680
    ds_read_b64_tr_b16 v[46:47], v6 offset:39744
    s_waitcnt lgkmcnt(8)
    v_mfma_f32_32x32x16_bf16 v[64:79], v[16:19], v[128:131], v[64:79]
    ds_read_b64_tr_b16 v[52:53], v6 offset:39424
    ds_read_b64_tr_b16 v[54:55], v6 offset:39488
    v_mfma_f32_32x32x16_bf16 v[80:95], v[20:23], v[128:131], v[80:95]
    ds_read_b64_tr_b16 v[56:57], v6 offset:39936
    ds_read_b64_tr_b16 v[58:59], v6 offset:40000
    s_waitcnt lgkmcnt(8)
    s_barrier
    v_mfma_f32_32x32x16_bf16 v[64:79], v[28:31], v[132:135], v[64:79]
    ds_read_b64_tr_b16 v[16:17], v6 offset:52224
    ds_read_b64_tr_b16 v[18:19], v6 offset:52288
    v_mfma_f32_32x32x16_bf16 v[80:95], v[32:35], v[132:135], v[80:95]
    ds_read_b64_tr_b16 v[20:21], v6 offset:52736
    ds_read_b64_tr_b16 v[22:23], v6 offset:52800
    s_waitcnt lgkmcnt(8)
    v_mfma_f32_32x32x16_bf16 v[64:79], v[40:43], v[136:139], v[64:79]
    ds_read_b64_tr_b16 v[28:29], v6 offset:52480
    ds_read_b64_tr_b16 v[30:31], v6 offset:52544
    v_mfma_f32_32x32x16_bf16 v[80:95], v[44:47], v[136:139], v[80:95]
    ds_read_b64_tr_b16 v[32:33], v6 offset:52992
    ds_read_b64_tr_b16 v[34:35], v6 offset:53056
    s_waitcnt lgkmcnt(8)
    v_mfma_f32_32x32x16_bf16 v[64:79], v[52:55], v[140:143], v[64:79]
    ds_read_b64_tr_b16 v[40:41], v6 offset:56576
    ds_read_b64_tr_b16 v[42:43], v6 offset:56640
    v_mfma_f32_32x32x16_bf16 v[80:95], v[56:59], v[140:143], v[80:95]
    ds_read_b64_tr_b16 v[44:45], v6 offset:57088
    ds_read_b64_tr_b16 v[46:47], v6 offset:57152
    s_waitcnt lgkmcnt(8)
    v_mfma_f32_32x32x16_bf16 v[64:79], v[16:19], v[144:147], v[64:79]
    ds_read_b64_tr_b16 v[52:53], v6 offset:56832
    ds_read_b64_tr_b16 v[54:55], v6 offset:56896
    v_mfma_f32_32x32x16_bf16 v[80:95], v[20:23], v[144:147], v[80:95]
    ds_read_b64_tr_b16 v[56:57], v6 offset:57344
    ds_read_b64_tr_b16 v[58:59], v6 offset:57408
    s_waitcnt lgkmcnt(8)
    s_barrier
    v_mfma_f32_32x32x16_bf16 v[64:79], v[28:31], v[148:151], v[64:79]
    ds_read_b64_tr_b16 v[16:17], v7 offset:17408
    ds_read_b64_tr_b16 v[18:19], v7 offset:17472
    v_mfma_f32_32x32x16_bf16 v[80:95], v[32:35], v[148:151], v[80:95]
    ds_read_b64_tr_b16 v[20:21], v7 offset:17920
    ds_read_b64_tr_b16 v[22:23], v7 offset:17984
    s_waitcnt lgkmcnt(8)
    v_mfma_f32_32x32x16_bf16 v[64:79], v[40:43], v[152:155], v[64:79]
    ds_read_b64_tr_b16 v[28:29], v7 offset:17664
    ds_read_b64_tr_b16 v[30:31], v7 offset:17728
    v_mfma_f32_32x32x16_bf16 v[80:95], v[44:47], v[152:155], v[80:95]
    ds_read_b64_tr_b16 v[32:33], v7 offset:18176
    ds_read_b64_tr_b16 v[34:35], v7 offset:18240
    s_waitcnt lgkmcnt(8)
    v_mfma_f32_32x32x16_bf16 v[64:79], v[52:55], v[156:159], v[64:79]
    ds_read_b64_tr_b16 v[40:41], v7 offset:21760
    ds_read_b64_tr_b16 v[42:43], v7 offset:21824
    v_mfma_f32_32x32x16_bf16 v[80:95], v[56:59], v[156:159], v[80:95]
    ds_read_b64_tr_b16 v[44:45], v7 offset:22272
    ds_read_b64_tr_b16 v[46:47], v7 offset:22336
    s_waitcnt lgkmcnt(8)
    v_mfma_f32_32x32x16_bf16 v[64:79], v[16:19], v[160:163], v[64:79]
    ds_read_b64_tr_b16 v[52:53], v7 offset:22016
    ds_read_b64_tr_b16 v[54:55], v7 offset:22080
    v_mfma_f32_32x32x16_bf16 v[80:95], v[20:23], v[160:163], v[80:95]
    ds_read_b64_tr_b16 v[56:57], v7 offset:22528
    ds_read_b64_tr_b16 v[58:59], v7 offset:22592
    s_waitcnt lgkmcnt(8)
    s_barrier
    v_mfma_f32_32x32x16_bf16 v[64:79], v[28:31], v[164:167], v[64:79]
    ds_read_b64_tr_b16 v[16:17], v7 offset:34816
    ds_read_b64_tr_b16 v[18:19], v7 offset:34880
    v_mfma_f32_32x32x16_bf16 v[80:95], v[32:35], v[164:167], v[80:95]
    ds_read_b64_tr_b16 v[20:21], v7 offset:35328
    ds_read_b64_tr_b16 v[22:23], v7 offset:35392
    s_waitcnt lgkmcnt(8)
    v_mfma_f32_32x32x16_bf16 v[64:79], v[40:43], v[168:171], v[64:79]
    ds_read_b64_tr_b16 v[28:29], v7 offset:35072
    ds_read_b64_tr_b16 v[30:31], v7 offset:35136
    v_mfma_f32_32x32x16_bf16 v[80:95], v[44:47], v[168:171], v[80:95]
    ds_read_b64_tr_b16 v[32:33], v7 offset:35584
    ds_read_b64_tr_b16 v[34:35], v7 offset:35648
    s_waitcnt lgkmcnt(8)
    v_mfma_f32_32x32x16_bf16 v[64:79], v[52:55], v[172:175], v[64:79]
    ds_read_b64_tr_b16 v[40:41], v7 offset:39168
    ds_read_b64_tr_b16 v[42:43], v7 offset:39232
    v_mfma_f32_32x32x16_bf16 v[80:95], v[56:59], v[172:175], v[80:95]
    ds_read_b64_tr_b16 v[44:45], v7 offset:39680
    ds_read_b64_tr_b16 v[46:47], v7 offset:39744
    s_waitcnt lgkmcnt(8)
    v_mfma_f32_32x32x16_bf16 v[64:79], v[16:19], v[176:179], v[64:79]
    ds_read_b64_tr_b16 v[52:53], v7 offset:39424
    ds_read_b64_tr_b16 v[54:55], v7 offset:39488
    v_mfma_f32_32x32x16_bf16 v[80:95], v[20:23], v[176:179], v[80:95]
    ds_read_b64_tr_b16 v[56:57], v7 offset:39936
    ds_read_b64_tr_b16 v[58:59], v7 offset:40000
    s_waitcnt lgkmcnt(8)
    s_barrier
    v_mfma_f32_32x32x16_bf16 v[64:79], v[28:31], v[180:183], v[64:79]
    ds_read_b64_tr_b16 v[16:17], v6 offset:0
    ds_read_b64_tr_b16 v[18:19], v6 offset:64
    v_mfma_f32_32x32x16_bf16 v[80:95], v[32:35], v[180:183], v[80:95]
    ds_read_b64_tr_b16 v[20:21], v6 offset:512
    ds_read_b64_tr_b16 v[22:23], v6 offset:576
    s_waitcnt lgkmcnt(8)
    v_mfma_f32_32x32x16_bf16 v[64:79], v[40:43], v[184:187], v[64:79]
    ds_read_b64_tr_b16 v[28:29], v6 offset:256
    ds_read_b64_tr_b16 v[30:31], v6 offset:320
    v_mfma_f32_32x32x16_bf16 v[80:95], v[44:47], v[184:187], v[80:95]
    ds_read_b64_tr_b16 v[32:33], v6 offset:768
    ds_read_b64_tr_b16 v[34:35], v6 offset:832
    s_waitcnt lgkmcnt(8)
    v_mfma_f32_32x32x16_bf16 v[64:79], v[52:55], v[188:191], v[64:79]
    ds_read_b64_tr_b16 v[40:41], v6 offset:4352
    ds_read_b64_tr_b16 v[42:43], v6 offset:4416
    v_mfma_f32_32x32x16_bf16 v[80:95], v[56:59], v[188:191], v[80:95]
    ds_read_b64_tr_b16 v[44:45], v6 offset:4864
    ds_read_b64_tr_b16 v[46:47], v6 offset:4928
    s_waitcnt lgkmcnt(8)
    v_mfma_f32_32x32x16_bf16 v[64:79], v[16:19], v[192:195], v[64:79]
    ds_read_b64_tr_b16 v[52:53], v6 offset:4608
    ds_read_b64_tr_b16 v[54:55], v6 offset:4672
    v_mfma_f32_32x32x16_bf16 v[80:95], v[20:23], v[192:195], v[80:95]
    ds_read_b64_tr_b16 v[56:57], v6 offset:5120
    ds_read_b64_tr_b16 v[58:59], v6 offset:5184
    s_waitcnt lgkmcnt(8)
    s_barrier
    v_mfma_f32_32x32x16_bf16 v[64:79], v[28:31], v[196:199], v[64:79]
    ds_read_b64_tr_b16 v[16:17], v6 offset:17408
    ds_read_b64_tr_b16 v[18:19], v6 offset:17472
    v_mfma_f32_32x32x16_bf16 v[80:95], v[32:35], v[196:199], v[80:95]
    ds_read_b64_tr_b16 v[20:21], v6 offset:17920
    ds_read_b64_tr_b16 v[22:23], v6 offset:17984
    s_waitcnt lgkmcnt(8)
    v_mfma_f32_32x32x16_bf16 v[64:79], v[40:43], v[200:203], v[64:79]
    ds_read_b64_tr_b16 v[28:29], v6 offset:17664
    ds_read_b64_tr_b16 v[30:31], v6 offset:17728
    v_mfma_f32_32x32x16_bf16 v[80:95], v[44:47], v[200:203], v[80:95]
    ds_read_b64_tr_b16 v[32:33], v6 offset:18176
    ds_read_b64_tr_b16 v[34:35], v6 offset:18240
    s_waitcnt lgkmcnt(8)
    v_mfma_f32_32x32x16_bf16 v[64:79], v[52:55], v[204:207], v[64:79]
    ds_read_b64_tr_b16 v[40:41], v6 offset:21760
    ds_read_b64_tr_b16 v[42:43], v6 offset:21824
    v_mfma_f32_32x32x16_bf16 v[80:95], v[56:59], v[204:207], v[80:95]
    ds_read_b64_tr_b16 v[44:45], v6 offset:22272
    ds_read_b64_tr_b16 v[46:47], v6 offset:22336
    s_waitcnt lgkmcnt(8)
    v_mfma_f32_32x32x16_bf16 v[64:79], v[16:19], v[208:211], v[64:79]
    ds_read_b64_tr_b16 v[52:53], v6 offset:22016
    ds_read_b64_tr_b16 v[54:55], v6 offset:22080
    v_mfma_f32_32x32x16_bf16 v[80:95], v[20:23], v[208:211], v[80:95]
    ds_read_b64_tr_b16 v[56:57], v6 offset:22528
    ds_read_b64_tr_b16 v[58:59], v6 offset:22592
    s_waitcnt lgkmcnt(8)
    s_barrier
    v_mfma_f32_32x32x16_bf16 v[64:79], v[28:31], v[212:215], v[64:79]
    ds_read_b64_tr_b16 v[16:17], v6 offset:34816
    ds_read_b64_tr_b16 v[18:19], v6 offset:34880
    v_mfma_f32_32x32x16_bf16 v[80:95], v[32:35], v[212:215], v[80:95]
    ds_read_b64_tr_b16 v[20:21], v6 offset:35328
    ds_read_b64_tr_b16 v[22:23], v6 offset:35392
    s_waitcnt lgkmcnt(8)
    v_mfma_f32_32x32x16_bf16 v[64:79], v[40:43], v[216:219], v[64:79]
    ds_read_b64_tr_b16 v[28:29], v6 offset:35072
    ds_read_b64_tr_b16 v[30:31], v6 offset:35136
    v_mfma_f32_32x32x16_bf16 v[80:95], v[44:47], v[216:219], v[80:95]
    ds_read_b64_tr_b16 v[32:33], v6 offset:35584
    ds_read_b64_tr_b16 v[34:35], v6 offset:35648
    s_waitcnt lgkmcnt(8)
    v_mfma_f32_32x32x16_bf16 v[64:79], v[52:55], v[220:223], v[64:79]
    ds_read_b64_tr_b16 v[40:41], v6 offset:39168
    ds_read_b64_tr_b16 v[42:43], v6 offset:39232
    v_mfma_f32_32x32x16_bf16 v[80:95], v[56:59], v[220:223], v[80:95]
    ds_read_b64_tr_b16 v[44:45], v6 offset:39680
    ds_read_b64_tr_b16 v[46:47], v6 offset:39744
    s_waitcnt lgkmcnt(8)
    v_mfma_f32_32x32x16_bf16 v[64:79], v[16:19], v[224:227], v[64:79]
    ds_read_b64_tr_b16 v[52:53], v6 offset:39424
    ds_read_b64_tr_b16 v[54:55], v6 offset:39488
    v_mfma_f32_32x32x16_bf16 v[80:95], v[20:23], v[224:227], v[80:95]
    ds_read_b64_tr_b16 v[56:57], v6 offset:39936
    ds_read_b64_tr_b16 v[58:59], v6 offset:40000
    s_waitcnt lgkmcnt(8)
    s_barrier
    v_mfma_f32_32x32x16_bf16 v[64:79], v[28:31], v[228:231], v[64:79]
    ds_read_b64_tr_b16 v[16:17], v6 offset:52224
    ds_read_b64_tr_b16 v[18:19], v6 offset:52288
    ds_read_b64_tr_b16 v[20:21], v6 offset:52736
    v_mfma_f32_32x32x16_bf16 v[80:95], v[32:35], v[228:231], v[80:95]
    ds_read_b64_tr_b16 v[22:23], v6 offset:52800
    ds_read_b128 v[24:27], v10 offset:0
    s_waitcnt lgkmcnt(9)
    v_mfma_f32_32x32x16_bf16 v[64:79], v[40:43], v[232:235], v[64:79]
    ds_read_b64_tr_b16 v[28:29], v6 offset:52480
    ds_read_b64_tr_b16 v[30:31], v6 offset:52544
    ds_read_b64_tr_b16 v[32:33], v6 offset:52992
    v_mfma_f32_32x32x16_bf16 v[80:95], v[44:47], v[232:235], v[80:95]
    ds_read_b64_tr_b16 v[34:35], v6 offset:53056
    ds_read_b128 v[36:39], v11 offset:0
    s_waitcnt lgkmcnt(10)
    v_mfma_f32_32x32x16_bf16 v[64:79], v[52:55], v[236:239], v[64:79]
    ds_read_b64_tr_b16 v[40:41], v6 offset:56576
    ds_read_b64_tr_b16 v[42:43], v6 offset:56640
    ds_read_b64_tr_b16 v[44:45], v6 offset:57088
    v_mfma_f32_32x32x16_bf16 v[80:95], v[56:59], v[236:239], v[80:95]
    ds_read_b64_tr_b16 v[46:47], v6 offset:57152
    ds_read_b128 v[48:51], v12 offset:0
    s_waitcnt lgkmcnt(10)
    v_mfma_f32_32x32x16_bf16 v[64:79], v[16:19], v[24:27], v[64:79]
    ds_read_b64_tr_b16 v[52:53], v6 offset:56832
    ds_read_b64_tr_b16 v[54:55], v6 offset:56896
    ds_read_b64_tr_b16 v[56:57], v6 offset:57344
    v_mfma_f32_32x32x16_bf16 v[80:95], v[20:23], v[24:27], v[80:95]
    ds_read_b64_tr_b16 v[58:59], v6 offset:57408
    ds_read_b128 v[60:63], v13 offset:0
    s_waitcnt lgkmcnt(10)
    s_barrier
    v_mfma_f32_32x32x16_bf16 v[64:79], v[28:31], v[36:39], v[64:79]
    ds_read_b64_tr_b16 v[16:17], v7 offset:17408
    ds_read_b64_tr_b16 v[18:19], v7 offset:17472
    ds_read_b64_tr_b16 v[20:21], v7 offset:17920
    v_mfma_f32_32x32x16_bf16 v[80:95], v[32:35], v[36:39], v[80:95]
    ds_read_b64_tr_b16 v[22:23], v7 offset:17984
    ds_read_b128 v[24:27], v10 offset:8192
    s_waitcnt lgkmcnt(10)
    v_mfma_f32_32x32x16_bf16 v[64:79], v[40:43], v[48:51], v[64:79]
    ds_read_b64_tr_b16 v[28:29], v7 offset:17664
    ds_read_b64_tr_b16 v[30:31], v7 offset:17728
    ds_read_b64_tr_b16 v[32:33], v7 offset:18176
    v_mfma_f32_32x32x16_bf16 v[80:95], v[44:47], v[48:51], v[80:95]
    ds_read_b64_tr_b16 v[34:35], v7 offset:18240
    ds_read_b128 v[36:39], v11 offset:8192
    s_waitcnt lgkmcnt(10)
    v_mfma_f32_32x32x16_bf16 v[64:79], v[52:55], v[60:63], v[64:79]
    ds_read_b64_tr_b16 v[40:41], v7 offset:21760
    ds_read_b64_tr_b16 v[42:43], v7 offset:21824
    ds_read_b64_tr_b16 v[44:45], v7 offset:22272
    v_mfma_f32_32x32x16_bf16 v[80:95], v[56:59], v[60:63], v[80:95]
    ds_read_b64_tr_b16 v[46:47], v7 offset:22336
    ds_read_b128 v[48:51], v12 offset:8192
    s_waitcnt lgkmcnt(10)
    v_mfma_f32_32x32x16_bf16 v[64:79], v[16:19], v[24:27], v[64:79]
    ds_read_b64_tr_b16 v[52:53], v7 offset:22016
    ds_read_b64_tr_b16 v[54:55], v7 offset:22080
    ds_read_b64_tr_b16 v[56:57], v7 offset:22528
    v_mfma_f32_32x32x16_bf16 v[80:95], v[20:23], v[24:27], v[80:95]
    ds_read_b64_tr_b16 v[58:59], v7 offset:22592
    ds_read_b128 v[60:63], v13 offset:8192
    s_waitcnt lgkmcnt(10)
    s_barrier
    v_mfma_f32_32x32x16_bf16 v[64:79], v[28:31], v[36:39], v[64:79]
    ds_read_b64_tr_b16 v[16:17], v7 offset:34816
    ds_read_b64_tr_b16 v[18:19], v7 offset:34880
    ds_read_b64_tr_b16 v[20:21], v7 offset:35328
    v_mfma_f32_32x32x16_bf16 v[80:95], v[32:35], v[36:39], v[80:95]
    ds_read_b64_tr_b16 v[22:23], v7 offset:35392
    ds_read_b128 v[24:27], v10 offset:16384
    s_waitcnt lgkmcnt(10)
    v_mfma_f32_32x32x16_bf16 v[64:79], v[40:43], v[48:51], v[64:79]
    ds_read_b64_tr_b16 v[28:29], v7 offset:35072
    ds_read_b64_tr_b16 v[30:31], v7 offset:35136
    ds_read_b64_tr_b16 v[32:33], v7 offset:35584
    v_mfma_f32_32x32x16_bf16 v[80:95], v[44:47], v[48:51], v[80:95]
    ds_read_b64_tr_b16 v[34:35], v7 offset:35648
    ds_read_b128 v[36:39], v11 offset:16384
    s_waitcnt lgkmcnt(10)
    v_mfma_f32_32x32x16_bf16 v[64:79], v[52:55], v[60:63], v[64:79]
    ds_read_b64_tr_b16 v[40:41], v7 offset:39168
    ds_read_b64_tr_b16 v[42:43], v7 offset:39232
    ds_read_b64_tr_b16 v[44:45], v7 offset:39680
    v_mfma_f32_32x32x16_bf16 v[80:95], v[56:59], v[60:63], v[80:95]
    ds_read_b64_tr_b16 v[46:47], v7 offset:39744
    ds_read_b128 v[48:51], v12 offset:16384
    s_waitcnt lgkmcnt(10)
    v_mfma_f32_32x32x16_bf16 v[64:79], v[16:19], v[24:27], v[64:79]
    ds_read_b64_tr_b16 v[52:53], v7 offset:39424
    ds_read_b64_tr_b16 v[54:55], v7 offset:39488
    ds_read_b64_tr_b16 v[56:57], v7 offset:39936
    v_mfma_f32_32x32x16_bf16 v[80:95], v[20:23], v[24:27], v[80:95]
    ds_read_b64_tr_b16 v[58:59], v7 offset:40000
    ds_read_b128 v[60:63], v13 offset:16384
    s_waitcnt lgkmcnt(10)
    s_barrier
    v_mfma_f32_32x32x16_bf16 v[64:79], v[28:31], v[36:39], v[64:79]
    ds_read_b64_tr_b16 v[16:17], v6 offset:0
    ds_read_b64_tr_b16 v[18:19], v6 offset:64
    ds_read_b64_tr_b16 v[20:21], v6 offset:512
    v_mfma_f32_32x32x16_bf16 v[80:95], v[32:35], v[36:39], v[80:95]
    ds_read_b64_tr_b16 v[22:23], v6 offset:576
    ds_read_b128 v[24:27], v10 offset:24576
    s_waitcnt lgkmcnt(10)
    v_mfma_f32_32x32x16_bf16 v[64:79], v[40:43], v[48:51], v[64:79]
    ds_read_b64_tr_b16 v[28:29], v6 offset:256
    ds_read_b64_tr_b16 v[30:31], v6 offset:320
    ds_read_b64_tr_b16 v[32:33], v6 offset:768
    v_mfma_f32_32x32x16_bf16 v[80:95], v[44:47], v[48:51], v[80:95]
    ds_read_b64_tr_b16 v[34:35], v6 offset:832
    ds_read_b128 v[36:39], v11 offset:24576
    s_waitcnt lgkmcnt(10)
    v_mfma_f32_32x32x16_bf16 v[64:79], v[52:55], v[60:63], v[64:79]
    ds_read_b64_tr_b16 v[40:41], v6 offset:4352
    ds_read_b64_tr_b16 v[42:43], v6 offset:4416
    ds_read_b64_tr_b16 v[44:45], v6 offset:4864
    v_mfma_f32_32x32x16_bf16 v[80:95], v[56:59], v[60:63], v[80:95]
    ds_read_b64_tr_b16 v[46:47], v6 offset:4928
    ds_read_b128 v[48:51], v12 offset:24576
    s_waitcnt lgkmcnt(10)
    v_mfma_f32_32x32x16_bf16 v[64:79], v[16:19], v[24:27], v[64:79]
    ds_read_b64_tr_b16 v[52:53], v6 offset:4608
    ds_read_b64_tr_b16 v[54:55], v6 offset:4672
    ds_read_b64_tr_b16 v[56:57], v6 offset:5120
    v_mfma_f32_32x32x16_bf16 v[80:95], v[20:23], v[24:27], v[80:95]
    ds_read_b64_tr_b16 v[58:59], v6 offset:5184
    ds_read_b128 v[60:63], v13 offset:24576
    s_waitcnt lgkmcnt(10)
    s_barrier
    v_mfma_f32_32x32x16_bf16 v[64:79], v[28:31], v[36:39], v[64:79]
    ds_read_b64_tr_b16 v[16:17], v6 offset:17408
    ds_read_b64_tr_b16 v[18:19], v6 offset:17472
    ds_read_b64_tr_b16 v[20:21], v6 offset:17920
    v_mfma_f32_32x32x16_bf16 v[80:95], v[32:35], v[36:39], v[80:95]
    ds_read_b64_tr_b16 v[22:23], v6 offset:17984
    ds_read_b128 v[24:27], v10 offset:32768
    s_waitcnt lgkmcnt(10)
    v_mfma_f32_32x32x16_bf16 v[64:79], v[40:43], v[48:51], v[64:79]
    ds_read_b64_tr_b16 v[28:29], v6 offset:17664
    ds_read_b64_tr_b16 v[30:31], v6 offset:17728
    ds_read_b64_tr_b16 v[32:33], v6 offset:18176
    v_mfma_f32_32x32x16_bf16 v[80:95], v[44:47], v[48:51], v[80:95]
    ds_read_b64_tr_b16 v[34:35], v6 offset:18240
    ds_read_b128 v[36:39], v11 offset:32768
    s_waitcnt lgkmcnt(10)
    v_mfma_f32_32x32x16_bf16 v[64:79], v[52:55], v[60:63], v[64:79]
    ds_read_b64_tr_b16 v[40:41], v6 offset:21760
    ds_read_b64_tr_b16 v[42:43], v6 offset:21824
    ds_read_b64_tr_b16 v[44:45], v6 offset:22272
    v_mfma_f32_32x32x16_bf16 v[80:95], v[56:59], v[60:63], v[80:95]
    ds_read_b64_tr_b16 v[46:47], v6 offset:22336
    ds_read_b128 v[48:51], v12 offset:32768
    s_waitcnt lgkmcnt(10)
    v_mfma_f32_32x32x16_bf16 v[64:79], v[16:19], v[24:27], v[64:79]
    ds_read_b64_tr_b16 v[52:53], v6 offset:22016
    ds_read_b64_tr_b16 v[54:55], v6 offset:22080
    ds_read_b64_tr_b16 v[56:57], v6 offset:22528
    v_mfma_f32_32x32x16_bf16 v[80:95], v[20:23], v[24:27], v[80:95]
    ds_read_b64_tr_b16 v[58:59], v6 offset:22592
    ds_read_b128 v[60:63], v13 offset:32768
    s_waitcnt lgkmcnt(10)
    s_barrier
    v_mfma_f32_32x32x16_bf16 v[64:79], v[28:31], v[36:39], v[64:79]
    ds_read_b64_tr_b16 v[16:17], v6 offset:34816
    ds_read_b64_tr_b16 v[18:19], v6 offset:34880
    ds_read_b64_tr_b16 v[20:21], v6 offset:35328
    v_mfma_f32_32x32x16_bf16 v[80:95], v[32:35], v[36:39], v[80:95]
    ds_read_b64_tr_b16 v[22:23], v6 offset:35392
    ds_read_b128 v[24:27], v10 offset:0
    s_waitcnt lgkmcnt(10)
    v_mfma_f32_32x32x16_bf16 v[64:79], v[40:43], v[48:51], v[64:79]
    ds_read_b64_tr_b16 v[28:29], v6 offset:35072
    ds_read_b64_tr_b16 v[30:31], v6 offset:35136
    ds_read_b64_tr_b16 v[32:33], v6 offset:35584
    v_mfma_f32_32x32x16_bf16 v[80:95], v[44:47], v[48:51], v[80:95]
    ds_read_b64_tr_b16 v[34:35], v6 offset:35648
    ds_read_b128 v[36:39], v11 offset:0
    s_waitcnt lgkmcnt(10)
    v_mfma_f32_32x32x16_bf16 v[64:79], v[52:55], v[60:63], v[64:79]
    ds_read_b64_tr_b16 v[40:41], v6 offset:39168
    ds_read_b64_tr_b16 v[42:43], v6 offset:39232
    ds_read_b64_tr_b16 v[44:45], v6 offset:39680
    v_mfma_f32_32x32x16_bf16 v[80:95], v[56:59], v[60:63], v[80:95]
    ds_read_b64_tr_b16 v[46:47], v6 offset:39744
    ds_read_b128 v[48:51], v12 offset:0
    s_waitcnt lgkmcnt(10)
    v_mfma_f32_32x32x16_bf16 v[64:79], v[16:19], v[24:27], v[64:79]
    ds_read_b64_tr_b16 v[52:53], v6 offset:39424
    ds_read_b64_tr_b16 v[54:55], v6 offset:39488
    ds_read_b64_tr_b16 v[56:57], v6 offset:39936
    v_mfma_f32_32x32x16_bf16 v[80:95], v[20:23], v[24:27], v[80:95]
    ds_read_b64_tr_b16 v[58:59], v6 offset:40000
    ds_read_b128 v[60:63], v13 offset:0
    s_waitcnt lgkmcnt(10)
    s_barrier
    v_mfma_f32_32x32x16_bf16 v[64:79], v[28:31], v[36:39], v[64:79]
    ds_read_b64_tr_b16 v[16:17], v6 offset:52224
    ds_read_b64_tr_b16 v[18:19], v6 offset:52288
    ds_read_b64_tr_b16 v[20:21], v6 offset:52736
    v_mfma_f32_32x32x16_bf16 v[80:95], v[32:35], v[36:39], v[80:95]
    ds_read_b64_tr_b16 v[22:23], v6 offset:52800
    ds_read_b128 v[24:27], v10 offset:8192
    s_waitcnt lgkmcnt(10)
    v_mfma_f32_32x32x16_bf16 v[64:79], v[40:43], v[48:51], v[64:79]
    ds_read_b64_tr_b16 v[28:29], v6 offset:52480
    ds_read_b64_tr_b16 v[30:31], v6 offset:52544
    ds_read_b64_tr_b16 v[32:33], v6 offset:52992
    v_mfma_f32_32x32x16_bf16 v[80:95], v[44:47], v[48:51], v[80:95]
    ds_read_b64_tr_b16 v[34:35], v6 offset:53056
    ds_read_b128 v[36:39], v11 offset:8192
    s_waitcnt lgkmcnt(10)
    v_mfma_f32_32x32x16_bf16 v[64:79], v[52:55], v[60:63], v[64:79]
    ds_read_b64_tr_b16 v[40:41], v6 offset:56576
    ds_read_b64_tr_b16 v[42:43], v6 offset:56640
    ds_read_b64_tr_b16 v[44:45], v6 offset:57088
    v_mfma_f32_32x32x16_bf16 v[80:95], v[56:59], v[60:63], v[80:95]
    ds_read_b64_tr_b16 v[46:47], v6 offset:57152
    ds_read_b128 v[48:51], v12 offset:8192
    s_waitcnt lgkmcnt(10)
    v_mfma_f32_32x32x16_bf16 v[64:79], v[16:19], v[24:27], v[64:79]
    ds_read_b64_tr_b16 v[52:53], v6 offset:56832
    ds_read_b64_tr_b16 v[54:55], v6 offset:56896
    ds_read_b64_tr_b16 v[56:57], v6 offset:57344
    v_mfma_f32_32x32x16_bf16 v[80:95], v[20:23], v[24:27], v[80:95]
    ds_read_b64_tr_b16 v[58:59], v6 offset:57408
    ds_read_b128 v[60:63], v13 offset:8192
    s_waitcnt lgkmcnt(10)
    s_barrier
    v_mfma_f32_32x32x16_bf16 v[64:79], v[28:31], v[36:39], v[64:79]
    ds_read_b64_tr_b16 v[16:17], v7 offset:17408
    ds_read_b64_tr_b16 v[18:19], v7 offset:17472
    ds_read_b64_tr_b16 v[20:21], v7 offset:17920
    v_mfma_f32_32x32x16_bf16 v[80:95], v[32:35], v[36:39], v[80:95]
    ds_read_b64_tr_b16 v[22:23], v7 offset:17984
    ds_read_b128 v[24:27], v10 offset:16384
    s_waitcnt lgkmcnt(10)
    v_mfma_f32_32x32x16_bf16 v[64:79], v[40:43], v[48:51], v[64:79]
    ds_read_b64_tr_b16 v[28:29], v7 offset:17664
    ds_read_b64_tr_b16 v[30:31], v7 offset:17728
    ds_read_b64_tr_b16 v[32:33], v7 offset:18176
    v_mfma_f32_32x32x16_bf16 v[80:95], v[44:47], v[48:51], v[80:95]
    ds_read_b64_tr_b16 v[34:35], v7 offset:18240
    ds_read_b128 v[36:39], v11 offset:16384
    s_waitcnt lgkmcnt(10)
    v_mfma_f32_32x32x16_bf16 v[64:79], v[52:55], v[60:63], v[64:79]
    ds_read_b64_tr_b16 v[40:41], v7 offset:21760
    ds_read_b64_tr_b16 v[42:43], v7 offset:21824
    ds_read_b64_tr_b16 v[44:45], v7 offset:22272
    v_mfma_f32_32x32x16_bf16 v[80:95], v[56:59], v[60:63], v[80:95]
    ds_read_b64_tr_b16 v[46:47], v7 offset:22336
    ds_read_b128 v[48:51], v12 offset:16384
    s_waitcnt lgkmcnt(10)
    v_mfma_f32_32x32x16_bf16 v[64:79], v[16:19], v[24:27], v[64:79]
    ds_read_b64_tr_b16 v[52:53], v7 offset:22016
    ds_read_b64_tr_b16 v[54:55], v7 offset:22080
    ds_read_b64_tr_b16 v[56:57], v7 offset:22528
    v_mfma_f32_32x32x16_bf16 v[80:95], v[20:23], v[24:27], v[80:95]
    ds_read_b64_tr_b16 v[58:59], v7 offset:22592
    ds_read_b128 v[60:63], v13 offset:16384
    s_waitcnt lgkmcnt(10)
    s_barrier
    v_mfma_f32_32x32x16_bf16 v[64:79], v[28:31], v[36:39], v[64:79]
    ds_read_b64_tr_b16 v[16:17], v7 offset:34816
    ds_read_b64_tr_b16 v[18:19], v7 offset:34880
    ds_read_b64_tr_b16 v[20:21], v7 offset:35328
    v_mfma_f32_32x32x16_bf16 v[80:95], v[32:35], v[36:39], v[80:95]
    ds_read_b64_tr_b16 v[22:23], v7 offset:35392
    ds_read_b128 v[24:27], v10 offset:24576
    s_waitcnt lgkmcnt(10)
    v_mfma_f32_32x32x16_bf16 v[64:79], v[40:43], v[48:51], v[64:79]
    ds_read_b64_tr_b16 v[28:29], v7 offset:35072
    ds_read_b64_tr_b16 v[30:31], v7 offset:35136
    ds_read_b64_tr_b16 v[32:33], v7 offset:35584
    v_mfma_f32_32x32x16_bf16 v[80:95], v[44:47], v[48:51], v[80:95]
    ds_read_b64_tr_b16 v[34:35], v7 offset:35648
    ds_read_b128 v[36:39], v11 offset:24576
    s_waitcnt lgkmcnt(10)
    v_mfma_f32_32x32x16_bf16 v[64:79], v[52:55], v[60:63], v[64:79]
    ds_read_b64_tr_b16 v[40:41], v7 offset:39168
    ds_read_b64_tr_b16 v[42:43], v7 offset:39232
    ds_read_b64_tr_b16 v[44:45], v7 offset:39680
    v_mfma_f32_32x32x16_bf16 v[80:95], v[56:59], v[60:63], v[80:95]
    ds_read_b64_tr_b16 v[46:47], v7 offset:39744
    ds_read_b128 v[48:51], v12 offset:24576
    s_waitcnt lgkmcnt(10)
    v_mfma_f32_32x32x16_bf16 v[64:79], v[16:19], v[24:27], v[64:79]
    ds_read_b64_tr_b16 v[52:53], v7 offset:39424
    ds_read_b64_tr_b16 v[54:55], v7 offset:39488
    ds_read_b64_tr_b16 v[56:57], v7 offset:39936
    v_mfma_f32_32x32x16_bf16 v[80:95], v[20:23], v[24:27], v[80:95]
    ds_read_b64_tr_b16 v[58:59], v7 offset:40000
    ds_read_b128 v[60:63], v13 offset:24576
    s_waitcnt lgkmcnt(10)
    s_barrier
    v_mfma_f32_32x32x16_bf16 v[64:79], v[28:31], v[36:39], v[64:79]
    ds_read_b64_tr_b16 v[16:17], v6 offset:0
    ds_read_b64_tr_b16 v[18:19], v6 offset:64
    ds_read_b64_tr_b16 v[20:21], v6 offset:512
    v_mfma_f32_32x32x16_bf16 v[80:95], v[32:35], v[36:39], v[80:95]
    ds_read_b64_tr_b16 v[22:23], v6 offset:576
    ds_read_b128 v[24:27], v10 offset:32768
    s_waitcnt lgkmcnt(10)
    v_mfma_f32_32x32x16_bf16 v[64:79], v[40:43], v[48:51], v[64:79]
    ds_read_b64_tr_b16 v[28:29], v6 offset:256
    ds_read_b64_tr_b16 v[30:31], v6 offset:320
    ds_read_b64_tr_b16 v[32:33], v6 offset:768
    v_mfma_f32_32x32x16_bf16 v[80:95], v[44:47], v[48:51], v[80:95]
    ds_read_b64_tr_b16 v[34:35], v6 offset:832
    ds_read_b128 v[36:39], v11 offset:32768
    s_waitcnt lgkmcnt(10)
    v_mfma_f32_32x32x16_bf16 v[64:79], v[52:55], v[60:63], v[64:79]
    ds_read_b64_tr_b16 v[40:41], v6 offset:4352
    ds_read_b64_tr_b16 v[42:43], v6 offset:4416
    ds_read_b64_tr_b16 v[44:45], v6 offset:4864
    v_mfma_f32_32x32x16_bf16 v[80:95], v[56:59], v[60:63], v[80:95]
    ds_read_b64_tr_b16 v[46:47], v6 offset:4928
    ds_read_b128 v[48:51], v12 offset:32768
    s_waitcnt lgkmcnt(10)
    v_mfma_f32_32x32x16_bf16 v[64:79], v[16:19], v[24:27], v[64:79]
    ds_read_b64_tr_b16 v[52:53], v6 offset:4608
    ds_read_b64_tr_b16 v[54:55], v6 offset:4672
    ds_read_b64_tr_b16 v[56:57], v6 offset:5120
    v_mfma_f32_32x32x16_bf16 v[80:95], v[20:23], v[24:27], v[80:95]
    ds_read_b64_tr_b16 v[58:59], v6 offset:5184
    ds_read_b128 v[60:63], v13 offset:32768
    s_waitcnt lgkmcnt(10)
    s_barrier
    v_mfma_f32_32x32x16_bf16 v[64:79], v[28:31], v[36:39], v[64:79]
    ds_read_b64_tr_b16 v[16:17], v6 offset:17408
    ds_read_b64_tr_b16 v[18:19], v6 offset:17472
    ds_read_b64_tr_b16 v[20:21], v6 offset:17920
    v_mfma_f32_32x32x16_bf16 v[80:95], v[32:35], v[36:39], v[80:95]
    ds_read_b64_tr_b16 v[22:23], v6 offset:17984
    ds_read_b128 v[24:27], v10 offset:0
    s_waitcnt lgkmcnt(10)
    v_mfma_f32_32x32x16_bf16 v[64:79], v[40:43], v[48:51], v[64:79]
    ds_read_b64_tr_b16 v[28:29], v6 offset:17664
    ds_read_b64_tr_b16 v[30:31], v6 offset:17728
    ds_read_b64_tr_b16 v[32:33], v6 offset:18176
    v_mfma_f32_32x32x16_bf16 v[80:95], v[44:47], v[48:51], v[80:95]
    ds_read_b64_tr_b16 v[34:35], v6 offset:18240
    ds_read_b128 v[36:39], v11 offset:0
    s_waitcnt lgkmcnt(10)
    v_mfma_f32_32x32x16_bf16 v[64:79], v[52:55], v[60:63], v[64:79]
    ds_read_b64_tr_b16 v[40:41], v6 offset:21760
    ds_read_b64_tr_b16 v[42:43], v6 offset:21824
    ds_read_b64_tr_b16 v[44:45], v6 offset:22272
    v_mfma_f32_32x32x16_bf16 v[80:95], v[56:59], v[60:63], v[80:95]
    ds_read_b64_tr_b16 v[46:47], v6 offset:22336
    ds_read_b128 v[48:51], v12 offset:0
    s_waitcnt lgkmcnt(10)
    v_mfma_f32_32x32x16_bf16 v[64:79], v[16:19], v[24:27], v[64:79]
    ds_read_b64_tr_b16 v[52:53], v6 offset:22016
    ds_read_b64_tr_b16 v[54:55], v6 offset:22080
    ds_read_b64_tr_b16 v[56:57], v6 offset:22528
    v_mfma_f32_32x32x16_bf16 v[80:95], v[20:23], v[24:27], v[80:95]
    ds_read_b64_tr_b16 v[58:59], v6 offset:22592
    ds_read_b128 v[60:63], v13 offset:0
    s_waitcnt lgkmcnt(10)
    v_mfma_f32_32x32x16_bf16 v[64:79], v[28:31], v[36:39], v[64:79]
    v_mfma_f32_32x32x16_bf16 v[80:95], v[32:35], v[36:39], v[80:95]
    s_waitcnt lgkmcnt(5)
    v_mfma_f32_32x32x16_bf16 v[64:79], v[40:43], v[48:51], v[64:79]
    v_mfma_f32_32x32x16_bf16 v[80:95], v[44:47], v[48:51], v[80:95]
    s_waitcnt lgkmcnt(0)
    v_mfma_f32_32x32x16_bf16 v[64:79], v[52:55], v[60:63], v[64:79]
    v_mfma_f32_32x32x16_bf16 v[80:95], v[56:59], v[60:63], v[80:95]
    v_and_b32 v206, 31, v1
    s_lshl_b32 s34, s33, 5
    v_add_u32 v206, s34, v206
    v_lshrrev_b32 v209, 5, v1
    v_and_b32 v207, 15, v206
    s_lshl_b32 s34, s32, 3
    v_xor_b32 v207, s34, v207
    v_lshlrev_b32 v208, 8, v206
    v_lshl_add_u32 v208, v209, 3, v208
    v_add_u32 v208, 34816, v208
    s_lshl_b32 s34, s32, 9
    s_add_u32 s34, s34, 147456
    v_lshlrev_b32 v211, 5, v209
    v_add_u32 v211, s34, v211
    ds_read_b128 v[112:115], v211 offset:0
    ds_read_b128 v[116:119], v211 offset:16
    ds_read_b128 v[120:123], v211 offset:64
    ds_read_b128 v[124:127], v211 offset:80
    ds_read_b128 v[128:131], v211 offset:128
    ds_read_b128 v[132:135], v211 offset:144
    s_waitcnt lgkmcnt(6)
    ds_read_b128 v[136:139], v211 offset:192
    ds_read_b128 v[140:143], v211 offset:208
    ds_read_b128 v[144:147], v211 offset:256
    ds_read_b128 v[148:151], v211 offset:272
    ds_read_b128 v[152:155], v211 offset:320
    ds_read_b128 v[156:159], v211 offset:336
    s_waitcnt lgkmcnt(6)
    ds_read_b128 v[160:163], v211 offset:384
    ds_read_b128 v[164:167], v211 offset:400
    ds_read_b128 v[168:171], v211 offset:448
    ds_read_b128 v[172:175], v211 offset:464
    v_mul_u32_u24 v212, 2560, v209
    s_lshl_b32 s34, s31, 6
    v_add_u32 v212, v212, v206
    v_add_u32 v212, s34, v212
    v_lshlrev_b32 v212, 2, v212
    s_lshl_b32 s34, s30, 7
    s_lshl_b32 s35, s32, 6
    s_add_u32 s34, s34, s35
    s_mul_i32 s86, s34, 2560
    v_xor_b32 v210, 0, v207
    v_lshl_add_u32 v240, v210, 4, v208
    v_xor_b32 v210, 1, v207
    v_lshl_add_u32 v241, v210, 4, v208
    v_xor_b32 v210, 2, v207
    v_lshl_add_u32 v242, v210, 4, v208
    v_xor_b32 v210, 3, v207
    v_lshl_add_u32 v243, v210, 4, v208
    v_xor_b32 v210, 4, v207
    v_lshl_add_u32 v244, v210, 4, v208
    v_xor_b32 v210, 5, v207
    v_lshl_add_u32 v245, v210, 4, v208
    v_xor_b32 v210, 6, v207
    v_lshl_add_u32 v246, v210, 4, v208
    v_xor_b32 v210, 7, v207
    v_lshl_add_u32 v247, v210, 4, v208
    s_barrier
    ds_read_b64 v[96:97], v240
    ds_read_b64 v[98:99], v241
    ds_read_b64 v[100:101], v242
    ds_read_b64 v[102:103], v243
    ds_read_b64 v[104:105], v244
    ds_read_b64 v[106:107], v245
    ds_read_b64 v[108:109], v246
    ds_read_b64 v[110:111], v247
    s_waitcnt lgkmcnt(0)
    v_lshlrev_b32 v180, 16, v96
    v_and_b32 v181, 0xffff0000, v96
    v_mul_f32 v180, v180, v112
    v_mul_f32 v181, v181, v114
    v_cvt_pk_bf16_f32 v180, v180, v181
    v_and_b32 v181, 0xffff0000, v180
    v_lshlrev_b32 v180, 16, v180
    v_fma_f32 v64, v113, v64, v180
    v_fma_f32 v65, v115, v65, v181
    s_add_u32 s35, s86, 0
    buffer_store_dword v64, v212, s[20:23], s35 offen sc0 sc1
    s_add_u32 s35, s86, 2560
    buffer_store_dword v65, v212, s[20:23], s35 offen sc0 sc1
    v_lshlrev_b32 v182, 16, v97
    v_and_b32 v183, 0xffff0000, v97
    v_mul_f32 v182, v182, v116
    v_mul_f32 v183, v183, v118
    v_cvt_pk_bf16_f32 v182, v182, v183
    v_and_b32 v183, 0xffff0000, v182
    v_lshlrev_b32 v182, 16, v182
    v_fma_f32 v66, v117, v66, v182
    v_fma_f32 v67, v119, v67, v183
    s_add_u32 s35, s86, 5120
    buffer_store_dword v66, v212, s[20:23], s35 offen sc0 sc1
    s_add_u32 s35, s86, 7680
    buffer_store_dword v67, v212, s[20:23], s35 offen sc0 sc1
    v_lshlrev_b32 v180, 16, v98
    v_and_b32 v181, 0xffff0000, v98
    v_mul_f32 v180, v180, v120
    v_mul_f32 v181, v181, v122
    v_cvt_pk_bf16_f32 v180, v180, v181
    v_and_b32 v181, 0xffff0000, v180
    v_lshlrev_b32 v180, 16, v180
    v_fma_f32 v68, v121, v68, v180
    v_fma_f32 v69, v123, v69, v181
    s_add_u32 s35, s86, 20480
    buffer_store_dword v68, v212, s[20:23], s35 offen sc0 sc1
    s_add_u32 s35, s86, 23040
    buffer_store_dword v69, v212, s[20:23], s35 offen sc0 sc1
    v_lshlrev_b32 v182, 16, v99
    v_and_b32 v183, 0xffff0000, v99
    v_mul_f32 v182, v182, v124
    v_mul_f32 v183, v183, v126
    v_cvt_pk_bf16_f32 v182, v182, v183
    v_and_b32 v183, 0xffff0000, v182
    v_lshlrev_b32 v182, 16, v182
    v_fma_f32 v70, v125, v70, v182
    v_fma_f32 v71, v127, v71, v183
    s_add_u32 s35, s86, 25600
    buffer_store_dword v70, v212, s[20:23], s35 offen sc0 sc1
    s_add_u32 s35, s86, 28160
    buffer_store_dword v71, v212, s[20:23], s35 offen sc0 sc1
    v_lshlrev_b32 v180, 16, v100
    v_and_b32 v181, 0xffff0000, v100
    v_mul_f32 v180, v180, v128
    v_mul_f32 v181, v181, v130
    v_cvt_pk_bf16_f32 v180, v180, v181
    v_and_b32 v181, 0xffff0000, v180
    v_lshlrev_b32 v180, 16, v180
    v_fma_f32 v72, v129, v72, v180
    v_fma_f32 v73, v131, v73, v181
    s_add_u32 s35, s86, 40960
    buffer_store_dword v72, v212, s[20:23], s35 offen sc0 sc1
    s_add_u32 s35, s86, 43520
    buffer_store_dword v73, v212, s[20:23], s35 offen sc0 sc1
    v_lshlrev_b32 v182, 16, v101
    v_and_b32 v183, 0xffff0000, v101
    v_mul_f32 v182, v182, v132
    v_mul_f32 v183, v183, v134
    v_cvt_pk_bf16_f32 v182, v182, v183
    v_and_b32 v183, 0xffff0000, v182
    v_lshlrev_b32 v182, 16, v182
    v_fma_f32 v74, v133, v74, v182
    v_fma_f32 v75, v135, v75, v183
    s_add_u32 s35, s86, 46080
    buffer_store_dword v74, v212, s[20:23], s35 offen sc0 sc1
    s_add_u32 s35, s86, 48640
    buffer_store_dword v75, v212, s[20:23], s35 offen sc0 sc1
    v_lshlrev_b32 v180, 16, v102
    v_and_b32 v181, 0xffff0000, v102
    v_mul_f32 v180, v180, v136
    v_mul_f32 v181, v181, v138
    v_cvt_pk_bf16_f32 v180, v180, v181
    v_and_b32 v181, 0xffff0000, v180
    v_lshlrev_b32 v180, 16, v180
    v_fma_f32 v76, v137, v76, v180
    v_fma_f32 v77, v139, v77, v181
    s_add_u32 s35, s86, 61440
    buffer_store_dword v76, v212, s[20:23], s35 offen sc0 sc1
    s_add_u32 s35, s86, 64000
    buffer_store_dword v77, v212, s[20:23], s35 offen sc0 sc1
    v_lshlrev_b32 v182, 16, v103
    v_and_b32 v183, 0xffff0000, v103
    v_mul_f32 v182, v182, v140
    v_mul_f32 v183, v183, v142
    v_cvt_pk_bf16_f32 v182, v182, v183
    v_and_b32 v183, 0xffff0000, v182
    v_lshlrev_b32 v182, 16, v182
    v_fma_f32 v78, v141, v78, v182
    v_fma_f32 v79, v143, v79, v183
    s_add_u32 s35, s86, 66560
    buffer_store_dword v78, v212, s[20:23], s35 offen sc0 sc1
    s_add_u32 s35, s86, 69120
    buffer_store_dword v79, v212, s[20:23], s35 offen sc0 sc1
    v_lshlrev_b32 v180, 16, v104
    v_and_b32 v181, 0xffff0000, v104
    v_mul_f32 v180, v180, v144
    v_mul_f32 v181, v181, v146
    v_cvt_pk_bf16_f32 v180, v180, v181
    v_and_b32 v181, 0xffff0000, v180
    v_lshlrev_b32 v180, 16, v180
    v_fma_f32 v80, v145, v80, v180
    v_fma_f32 v81, v147, v81, v181
    s_add_u32 s35, s86, 81920
    buffer_store_dword v80, v212, s[20:23], s35 offen sc0 sc1
    s_add_u32 s35, s86, 84480
    buffer_store_dword v81, v212, s[20:23], s35 offen sc0 sc1
    v_lshlrev_b32 v182, 16, v105
    v_and_b32 v183, 0xffff0000, v105
    v_mul_f32 v182, v182, v148
    v_mul_f32 v183, v183, v150
    v_cvt_pk_bf16_f32 v182, v182, v183
    v_and_b32 v183, 0xffff0000, v182
    v_lshlrev_b32 v182, 16, v182
    v_fma_f32 v82, v149, v82, v182
    v_fma_f32 v83, v151, v83, v183
    s_add_u32 s35, s86, 87040
    buffer_store_dword v82, v212, s[20:23], s35 offen sc0 sc1
    s_add_u32 s35, s86, 89600
    buffer_store_dword v83, v212, s[20:23], s35 offen sc0 sc1
    v_lshlrev_b32 v180, 16, v106
    v_and_b32 v181, 0xffff0000, v106
    v_mul_f32 v180, v180, v152
    v_mul_f32 v181, v181, v154
    v_cvt_pk_bf16_f32 v180, v180, v181
    v_and_b32 v181, 0xffff0000, v180
    v_lshlrev_b32 v180, 16, v180
    v_fma_f32 v84, v153, v84, v180
    v_fma_f32 v85, v155, v85, v181
    s_add_u32 s35, s86, 102400
    buffer_store_dword v84, v212, s[20:23], s35 offen sc0 sc1
    s_add_u32 s35, s86, 104960
    buffer_store_dword v85, v212, s[20:23], s35 offen sc0 sc1
    v_lshlrev_b32 v182, 16, v107
    v_and_b32 v183, 0xffff0000, v107
    v_mul_f32 v182, v182, v156
    v_mul_f32 v183, v183, v158
    v_cvt_pk_bf16_f32 v182, v182, v183
    v_and_b32 v183, 0xffff0000, v182
    v_lshlrev_b32 v182, 16, v182
    v_fma_f32 v86, v157, v86, v182
    v_fma_f32 v87, v159, v87, v183
    s_add_u32 s35, s86, 107520
    buffer_store_dword v86, v212, s[20:23], s35 offen sc0 sc1
    s_add_u32 s35, s86, 110080
    buffer_store_dword v87, v212, s[20:23], s35 offen sc0 sc1
    v_lshlrev_b32 v180, 16, v108
    v_and_b32 v181, 0xffff0000, v108
    v_mul_f32 v180, v180, v160
    v_mul_f32 v181, v181, v162
    v_cvt_pk_bf16_f32 v180, v180, v181
    v_and_b32 v181, 0xffff0000, v180
    v_lshlrev_b32 v180, 16, v180
    v_fma_f32 v88, v161, v88, v180
    v_fma_f32 v89, v163, v89, v181
    s_add_u32 s35, s86, 122880
    buffer_store_dword v88, v212, s[20:23], s35 offen sc0 sc1
    s_add_u32 s35, s86, 125440
    buffer_store_dword v89, v212, s[20:23], s35 offen sc0 sc1
    v_lshlrev_b32 v182, 16, v109
    v_and_b32 v183, 0xffff0000, v109
    v_mul_f32 v182, v182, v164
    v_mul_f32 v183, v183, v166
    v_cvt_pk_bf16_f32 v182, v182, v183
    v_and_b32 v183, 0xffff0000, v182
    v_lshlrev_b32 v182, 16, v182
    v_fma_f32 v90, v165, v90, v182
    v_fma_f32 v91, v167, v91, v183
    s_add_u32 s35, s86, 128000
    buffer_store_dword v90, v212, s[20:23], s35 offen sc0 sc1
    s_add_u32 s35, s86, 130560
    buffer_store_dword v91, v212, s[20:23], s35 offen sc0 sc1
    v_lshlrev_b32 v180, 16, v110
    v_and_b32 v181, 0xffff0000, v110
    v_mul_f32 v180, v180, v168
    v_mul_f32 v181, v181, v170
    v_cvt_pk_bf16_f32 v180, v180, v181
    v_and_b32 v181, 0xffff0000, v180
    v_lshlrev_b32 v180, 16, v180
    v_fma_f32 v92, v169, v92, v180
    v_fma_f32 v93, v171, v93, v181
    s_add_u32 s35, s86, 143360
    buffer_store_dword v92, v212, s[20:23], s35 offen sc0 sc1
    s_add_u32 s35, s86, 145920
    buffer_store_dword v93, v212, s[20:23], s35 offen sc0 sc1
    v_lshlrev_b32 v182, 16, v111
    v_and_b32 v183, 0xffff0000, v111
    v_mul_f32 v182, v182, v172
    v_mul_f32 v183, v183, v174
    v_cvt_pk_bf16_f32 v182, v182, v183
    v_and_b32 v183, 0xffff0000, v182
    v_lshlrev_b32 v182, 16, v182
    v_fma_f32 v94, v173, v94, v182
    v_fma_f32 v95, v175, v95, v183
    s_add_u32 s35, s86, 148480
    buffer_store_dword v94, v212, s[20:23], s35 offen sc0 sc1
    s_add_u32 s35, s86, 151040
    buffer_store_dword v95, v212, s[20:23], s35 offen sc0 sc1
    s_branch L_END
L_CONV:
    s_waitcnt lgkmcnt(0)
    s_mov_b32 s4, s36
    s_and_b32 s5, s37, 0xffff
    s_mov_b32 s6, 2621440
    s_mov_b32 s7, 0x00020000
    s_mov_b32 s8, s74
    s_and_b32 s9, s75, 0xffff
    s_mov_b32 s10, 12582912
    s_mov_b32 s11, 0x00020000
    s_mov_b32 s24, s72
    s_and_b32 s25, s73, 0xffff
    s_mov_b32 s26, 256
    s_mov_b32 s27, 0x00020000
    s_mul_i32 s30, s30, 10
    s_add_u32 s30, s30, s31
    s_sub_u32 s30, s30, 20
    s_lshl_b32 s31, s30, 3
    s_add_u32 s31, s31, s3
    s_mul_i32 s32, s3, 20480
    v_lshlrev_b32 v5, 2, v1
    s_add_u32 s33, s32, 20416
    v_add_u32 v5, s33, v5
    v_mov_b32 v3, 0
    s_mov_b64 exec, 15
    ds_write_b32 v5, v3
    s_mov_b64 exec, -1
    s_waitcnt lgkmcnt(0)
    s_barrier
    v_lshlrev_b32 v2, 2, v1
    s_mov_b32 s35, s31
    s_lshl_b32 s33, s35, 8
    s_mov_b32 s12, s38
    s_and_b32 s13, s39, 0xffff
    s_mov_b32 s14, 163840
    s_mov_b32 s15, 0x00020000
    buffer_load_dword v32, v2, s[12:15], s33 offen
    s_mov_b32 s12, s40
    s_and_b32 s13, s41, 0xffff
    s_mov_b32 s14, 163840
    s_mov_b32 s15, 0x00020000
    buffer_load_dword v33, v2, s[12:15], s33 offen
    s_mov_b32 s12, s42
    s_and_b32 s13, s43, 0xffff
    s_mov_b32 s14, 163840
    s_mov_b32 s15, 0x00020000
    buffer_load_dword v34, v2, s[12:15], s33 offen
    s_mov_b32 s12, s44
    s_and_b32 s13, s45, 0xffff
    s_mov_b32 s14, 163840
    s_mov_b32 s15, 0x00020000
    buffer_load_dword v35, v2, s[12:15], s33 offen
    s_lshl_b32 s33, s35, 1
    v_mov_b32 v3, 0
    s_mov_b32 s12, s46
    s_and_b32 s13, s47, 0xffff
    s_mov_b32 s14, 1280
    s_mov_b32 s15, 0x00020000
    buffer_load_ushort v36, v3, s[12:15], s33 offen
    s_lshl_b32 s33, s31, 1
    s_mov_b32 s16, s48
    s_and_b32 s17, s49, 0xffff
    s_mov_b32 s18, 1280
    s_mov_b32 s19, 0x00020000
    buffer_load_ushort v37, v3, s[16:19], s33 offen
    v_mul_u32_u24 v15, 1280, v1
    s_and_b32 s35, s3, 3
    s_mul_i32 s33, s35, 655360
    s_lshl_b32 s34, s30, 4
    s_add_u32 s33, s33, s34
    s_lshl_b32 s34, s30, 1
    s_add_u32 s34, s34, 0
    s_and_b32 s34, s34, 7
    s_mul_i32 s34, s34, 81920
    s_add_u32 s76, s34, s33
    s_lshl_b32 s34, s30, 1
    s_add_u32 s34, s34, 1
    s_and_b32 s34, s34, 7
    s_mul_i32 s34, s34, 81920
    s_add_u32 s77, s34, s33
    s_lshl_b32 s34, s30, 1
    s_add_u32 s34, s34, 2
    s_and_b32 s34, s34, 7
    s_mul_i32 s34, s34, 81920
    s_add_u32 s78, s34, s33
    s_lshl_b32 s34, s30, 1
    s_add_u32 s34, s34, 3
    s_and_b32 s34, s34, 7
    s_mul_i32 s34, s34, 81920
    s_add_u32 s79, s34, s33
    s_lshl_b32 s34, s30, 1
    s_add_u32 s34, s34, 4
    s_and_b32 s34, s34, 7
    s_mul_i32 s34, s34, 81920
    s_add_u32 s80, s34, s33
    s_lshl_b32 s34, s30, 1
    s_add_u32 s34, s34, 5
    s_and_b32 s34, s34, 7
    s_mul_i32 s34, s34, 81920
    s_add_u32 s81, s34, s33
    s_lshl_b32 s34, s30, 1
    s_add_u32 s34, s34, 6
    s_and_b32 s34, s34, 7
    s_mul_i32 s34, s34, 81920
    s_add_u32 s82, s34, s33
    s_lshl_b32 s34, s30, 1
    s_add_u32 s34, s34, 7
    s_and_b32 s34, s34, 7
    s_mul_i32 s34, s34, 81920
    s_add_u32 s83, s34, s33
    s_cmp_lt_u32 s3, 4
    s_cbranch_scc1 UIMM_40
    buffer_load_dwordx4 v[16:19], v15, s[4:7], s76 offen
    buffer_load_dwordx4 v[20:23], v15, s[4:7], s77 offen
    buffer_load_dwordx4 v[24:27], v15, s[4:7], s78 offen
    buffer_load_dwordx4 v[28:31], v15, s[4:7], s79 offen
    buffer_load_dwordx4 v[194:197], v15, s[4:7], s80 offen
    buffer_load_dwordx4 v[198:201], v15, s[4:7], s81 offen
    buffer_load_dwordx4 v[202:205], v15, s[4:7], s82 offen
    buffer_load_dwordx4 v[206:209], v15, s[4:7], s83 offen
UIMM_40:
    v_lshlrev_b32 v2, 2, v1
    s_add_u32 s33, s32, 5200
    s_mov_b32 m0, s33
    v_and_b32 v5, 31, v1
    v_lshrrev_b32 v6, 5, v1
    v_lshlrev_b32 v6, 4, v6
    v_add_u32 v6, s33, v6
    v_mov_b32 v7, 26
    v_cmp_eq_u32 vcc, 28, v5
    v_mov_b32 v9, 0x130f0e0b
    s_nop 0
    v_cndmask_b32 v7, v5, v7, vcc
    v_mov_b32 v10, 0x1f1c1b17
    v_mul_u32_u24 v7, 272, v7
    v_add_u32 v56, v7, v6
    v_and_b32 v8, 7, v5
    v_or_b32 v8, 0x0c0c0c00, v8
    v_perm_b32 v8, v10, v9, v8
    v_add_u32 v7, 32, v5
    v_cmp_lt_u32 vcc, 23, v5
    s_nop 1
    v_cndmask_b32 v7, v7, v8, vcc
    v_mul_u32_u24 v7, 272, v7
    v_add_u32 v96, v7, v6
    s_cmp_lt_u32 s3, 4
    s_cbranch_scc1 PW_41
    s_waitcnt vmcnt(8)
    s_branch PW2_42
PW_41:
    s_waitcnt vmcnt(0)
PW2_42:
    v_lshlrev_b32 v184, 16, v36
    v_mul_f32 v134, 0x3fb8aa3b, v184
    s_mov_b32 s34, 0x3fb8aa3b
    v_fma_f32 v135, v184, s34, -v134
    v_fmac_f32 v135, 0x32a57060, v184
    v_exp_f32 v136, v134
    v_mul_f32 v135, 0x3f317218, v135
    s_nop 0
    v_fma_f32 v184, v136, v135, v136
    v_cvt_pk_bf16_f32 v184, v184, v184
    v_and_b32 v184, 0xffff0000, v184
    v_lshlrev_b32 v185, 16, v37
    s_cmp_ge_u32 s3, 4
    s_cbranch_scc1 YK_43
    v_lshlrev_b32 v134, 16, v32
    v_lshlrev_b32 v135, 16, v33
    v_lshlrev_b32 v136, 16, v34
    v_lshlrev_b32 v137, 16, v35
    v_mul_f32 v138, 0x3fb8aa3b, v134
    s_mov_b32 s34, 0x3fb8aa3b
    v_fma_f32 v139, v134, s34, -v138
    v_fmac_f32 v139, 0x32a57060, v134
    v_exp_f32 v140, v138
    v_mul_f32 v139, 0x3f317218, v139
    s_nop 0
    v_fma_f32 v134, v140, v139, v140
    v_cvt_pk_bf16_f32 v134, v134, v134
    v_and_b32 v134, 0xffff0000, v134
    v_mul_f32 v134, -v134, v184
    v_mul_f32 v135, v135, v184
    v_mul_f32 v134, 0x3fb8aa3b, v134
    v_mul_f32 v135, 0x3e22f983, v135
    v_mul_f32 v136, v136, v184
    v_mul_f32 v137, v137, v184
    v_add_f32 v122, v136, v136
    v_add_f32 v123, v137, v137
    v_exp_f32 v138, v134
    v_mul_f32 v142, 0x43800000, v134
    v_fract_f32 v139, v135
    v_mul_f32 v143, 0x43800000, v135
    v_exp_f32 v142, v142
    v_cos_f32 v140, v139
    v_fract_f32 v143, v143
    v_sin_f32 v141, v139
    v_cos_f32 v144, v143
    v_mul_f32 v104, v138, v140
    v_sin_f32 v145, v143
    v_mul_f32 v105, v138, v141
    v_mul_f32 v120, v142, v144
    v_mul_f32 v121, v142, v145
    v_cvt_pk_bf16_f32 v186, v122, -v123
    v_mov_b32 v180, 0x00003f80
    ds_write_addtid_b32 v180 offset:8704
    v_pk_mul_f32 v[106:107], v[104:105], v[104:105] op_sel:[0,0] op_sel_hi:[0,1]
    v_pk_mul_f32 v[152:153], v[122:123], v[120:121] op_sel:[0,0] op_sel_hi:[0,1]
    v_pk_fma_f32 v[106:107], v[104:105], v[104:105], v[106:107] op_sel:[1,1,0] op_sel_hi:[1,0,1] neg_lo:[1,0,0]
    v_pk_fma_f32 v[152:153], v[122:123], v[120:121], v[152:153] op_sel:[1,1,0] op_sel_hi:[1,0,1] neg_lo:[1,0,0]
    v_pk_mul_f32 v[110:111], v[106:107], v[106:107] op_sel:[0,0] op_sel_hi:[0,1]
    v_pk_mul_f32 v[108:109], v[106:107], v[104:105] op_sel:[0,0] op_sel_hi:[0,1]
    v_cvt_pk_bf16_f32 v187, v152, -v153
    v_pk_fma_f32 v[110:111], v[106:107], v[106:107], v[110:111] op_sel:[1,1,0] op_sel_hi:[1,0,1] neg_lo:[1,0,0]
    v_pk_fma_f32 v[108:109], v[106:107], v[104:105], v[108:109] op_sel:[1,1,0] op_sel_hi:[1,0,1] neg_lo:[1,0,0]
    v_pk_mul_f32 v[118:119], v[110:111], v[110:111] op_sel:[0,0] op_sel_hi:[0,1]
    v_pk_mul_f32 v[112:113], v[110:111], v[104:105] op_sel:[0,0] op_sel_hi:[0,1]
    v_pk_fma_f32 v[118:119], v[110:111], v[110:111], v[118:119] op_sel:[1,1,0] op_sel_hi:[1,0,1] neg_lo:[1,0,0]
    v_pk_fma_f32 v[112:113], v[110:111], v[104:105], v[112:113] op_sel:[1,1,0] op_sel_hi:[1,0,1] neg_lo:[1,0,0]
    v_pk_mul_f32 v[114:115], v[110:111], v[106:107] op_sel:[0,0] op_sel_hi:[0,1]
    v_pk_mul_f32 v[116:117], v[110:111], v[108:109] op_sel:[0,0] op_sel_hi:[0,1]
    v_cvt_pk_bf16_f32 v188, v118, v119
    ds_write_addtid_b32 v186 offset:0
    v_pk_fma_f32 v[114:115], v[110:111], v[106:107], v[114:115] op_sel:[1,1,0] op_sel_hi:[1,0,1] neg_lo:[1,0,0]
    v_pk_fma_f32 v[116:117], v[110:111], v[108:109], v[116:117] op_sel:[1,1,0] op_sel_hi:[1,0,1] neg_lo:[1,0,0]
    v_pk_mul_f32 v[150:151], v[118:119], v[118:119] op_sel:[0,0] op_sel_hi:[0,1]
    v_pk_mul_f32 v[154:155], v[152:153], v[120:121] op_sel:[0,0] op_sel_hi:[0,1]
    v_pk_fma_f32 v[150:151], v[118:119], v[118:119], v[150:151] op_sel:[1,1,0] op_sel_hi:[1,0,1] neg_lo:[1,0,0]
    v_pk_fma_f32 v[154:155], v[152:153], v[120:121], v[154:155] op_sel:[1,1,0] op_sel_hi:[1,0,1] neg_lo:[1,0,0]
    v_pk_mul_f32 v[174:175], v[118:119], v[150:151] op_sel:[0,0] op_sel_hi:[0,1]
    v_pk_mul_f32 v[156:157], v[154:155], v[120:121] op_sel:[0,0] op_sel_hi:[0,1]
    v_cvt_pk_bf16_f32 v189, v150, v151
    ds_write_addtid_b32 v187 offset:6528
    v_cvt_pk_bf16_f32 v190, v154, -v155
    ds_write_addtid_b32 v188 offset:8976
    v_pk_fma_f32 v[174:175], v[118:119], v[150:151], v[174:175] op_sel:[1,1,0] op_sel_hi:[1,0,1] neg_lo:[1,0,0]
    v_pk_fma_f32 v[156:157], v[154:155], v[120:121], v[156:157] op_sel:[1,1,0] op_sel_hi:[1,0,1] neg_lo:[1,0,0]
    v_pk_mul_f32 v[168:169], v[150:151], v[150:151] op_sel:[0,0] op_sel_hi:[0,1]
    v_pk_mul_f32 v[158:159], v[156:157], v[120:121] op_sel:[0,0] op_sel_hi:[0,1]
    v_cvt_pk_bf16_f32 v191, v174, v175
    ds_write_addtid_b32 v189 offset:9248
    v_cvt_pk_bf16_f32 v192, v156, -v157
    ds_write_addtid_b32 v190 offset:4352
    v_pk_fma_f32 v[168:169], v[150:151], v[150:151], v[168:169] op_sel:[1,1,0] op_sel_hi:[1,0,1] neg_lo:[1,0,0]
    v_pk_fma_f32 v[158:159], v[156:157], v[120:121], v[158:159] op_sel:[1,1,0] op_sel_hi:[1,0,1] neg_lo:[1,0,0]
    v_pk_mul_f32 v[170:171], v[174:175], v[150:151] op_sel:[0,0] op_sel_hi:[0,1]
    v_pk_mul_f32 v[160:161], v[158:159], v[120:121] op_sel:[0,0] op_sel_hi:[0,1]
    v_cvt_pk_bf16_f32 v193, v168, v169
    ds_write_addtid_b32 v191 offset:9520
    v_cvt_pk_bf16_f32 v186, v158, -v159
    ds_write_addtid_b32 v192 offset:5440
    v_pk_fma_f32 v[170:171], v[174:175], v[150:151], v[170:171] op_sel:[1,1,0] op_sel_hi:[1,0,1] neg_lo:[1,0,0]
    v_pk_fma_f32 v[160:161], v[158:159], v[120:121], v[160:161] op_sel:[1,1,0] op_sel_hi:[1,0,1] neg_lo:[1,0,0]
    v_pk_mul_f32 v[172:173], v[168:169], v[150:151] op_sel:[0,0] op_sel_hi:[0,1]
    v_pk_mul_f32 v[162:163], v[160:161], v[120:121] op_sel:[0,0] op_sel_hi:[0,1]
    v_cvt_pk_bf16_f32 v187, v170, v171
    ds_write_addtid_b32 v193 offset:9792
    v_cvt_pk_bf16_f32 v188, v160, -v161
    ds_write_addtid_b32 v186 offset:2176
    v_pk_fma_f32 v[172:173], v[168:169], v[150:151], v[172:173] op_sel:[1,1,0] op_sel_hi:[1,0,1] neg_lo:[1,0,0]
    v_pk_fma_f32 v[162:163], v[160:161], v[120:121], v[162:163] op_sel:[1,1,0] op_sel_hi:[1,0,1] neg_lo:[1,0,0]
    v_pk_mul_f32 v[174:175], v[170:171], v[150:151] op_sel:[0,0] op_sel_hi:[0,1]
    v_pk_mul_f32 v[164:165], v[162:163], v[120:121] op_sel:[0,0] op_sel_hi:[0,1]
    v_cvt_pk_bf16_f32 v189, v172, v173
    ds_write_addtid_b32 v187 offset:10064
    v_cvt_pk_bf16_f32 v190, v162, -v163
    ds_write_addtid_b32 v188 offset:2448
    v_pk_fma_f32 v[174:175], v[170:171], v[150:151], v[174:175] op_sel:[1,1,0] op_sel_hi:[1,0,1] neg_lo:[1,0,0]
    v_pk_fma_f32 v[164:165], v[162:163], v[120:121], v[164:165] op_sel:[1,1,0] op_sel_hi:[1,0,1] neg_lo:[1,0,0]
    v_pk_mul_f32 v[168:169], v[172:173], v[150:151] op_sel:[0,0] op_sel_hi:[0,1]
    v_pk_mul_f32 v[166:167], v[164:165], v[120:121] op_sel:[0,0] op_sel_hi:[0,1]
    v_cvt_pk_bf16_f32 v191, v174, v175
    ds_write_addtid_b32 v189 offset:10336
    v_cvt_pk_bf16_f32 v192, v164, -v165
    ds_write_addtid_b32 v190 offset:3264
    v_pk_fma_f32 v[168:169], v[172:173], v[150:151], v[168:169] op_sel:[1,1,0] op_sel_hi:[1,0,1] neg_lo:[1,0,0]
    v_pk_fma_f32 v[166:167], v[164:165], v[120:121], v[166:167] op_sel:[1,1,0] op_sel_hi:[1,0,1] neg_lo:[1,0,0]
    v_pk_mul_f32 v[170:171], v[174:175], v[150:151] op_sel:[0,0] op_sel_hi:[0,1]
    v_pk_mul_f32 v[130:131], v[122:123], v[104:105] op_sel:[0,0] op_sel_hi:[0,1]
    v_cvt_pk_bf16_f32 v193, v168, v169
    ds_write_addtid_b32 v191 offset:10608
    v_cvt_pk_bf16_f32 v186, v166, -v167
    ds_write_addtid_b32 v192 offset:3536
    v_pk_fma_f32 v[170:171], v[174:175], v[150:151], v[170:171] op_sel:[1,1,0] op_sel_hi:[1,0,1] neg_lo:[1,0,0]
    v_pk_fma_f32 v[130:131], v[122:123], v[104:105], v[130:131] op_sel:[1,1,0] op_sel_hi:[1,0,1] neg_lo:[1,0,0]
    v_pk_mul_f32 v[172:173], v[168:169], v[150:151] op_sel:[0,0] op_sel_hi:[0,1]
    v_pk_mul_f32 v[132:133], v[122:123], v[106:107] op_sel:[0,0] op_sel_hi:[0,1]
    v_cvt_pk_bf16_f32 v187, v170, v171
    ds_write_addtid_b32 v193 offset:10880
    v_cvt_pk_bf16_f32 v188, v130, -v131
    ds_write_addtid_b32 v186 offset:2720
    v_pk_fma_f32 v[172:173], v[168:169], v[150:151], v[172:173] op_sel:[1,1,0] op_sel_hi:[1,0,1] neg_lo:[1,0,0]
    v_pk_fma_f32 v[132:133], v[122:123], v[106:107], v[132:133] op_sel:[1,1,0] op_sel_hi:[1,0,1] neg_lo:[1,0,0]
    v_pk_mul_f32 v[174:175], v[170:171], v[150:151] op_sel:[0,0] op_sel_hi:[0,1]
    v_pk_mul_f32 v[176:177], v[122:123], v[108:109] op_sel:[0,0] op_sel_hi:[0,1]
    v_cvt_pk_bf16_f32 v189, v172, v173
    ds_write_addtid_b32 v187 offset:11152
    v_cvt_pk_bf16_f32 v190, v132, -v133
    ds_write_addtid_b32 v188 offset:272
    v_pk_fma_f32 v[174:175], v[170:171], v[150:151], v[174:175] op_sel:[1,1,0] op_sel_hi:[1,0,1] neg_lo:[1,0,0]
    v_pk_fma_f32 v[176:177], v[122:123], v[108:109], v[176:177] op_sel:[1,1,0] op_sel_hi:[1,0,1] neg_lo:[1,0,0]
    v_pk_mul_f32 v[168:169], v[172:173], v[150:151] op_sel:[0,0] op_sel_hi:[0,1]
    v_pk_mul_f32 v[178:179], v[122:123], v[110:111] op_sel:[0,0] op_sel_hi:[0,1]
    v_cvt_pk_bf16_f32 v191, v174, v175
    ds_write_addtid_b32 v189 offset:11424
    v_cvt_pk_bf16_f32 v192, v176, -v177
    ds_write_addtid_b32 v190 offset:544
    v_pk_fma_f32 v[168:169], v[172:173], v[150:151], v[168:169] op_sel:[1,1,0] op_sel_hi:[1,0,1] neg_lo:[1,0,0]
    v_pk_fma_f32 v[178:179], v[122:123], v[110:111], v[178:179] op_sel:[1,1,0] op_sel_hi:[1,0,1] neg_lo:[1,0,0]
    v_pk_mul_f32 v[170:171], v[174:175], v[150:151] op_sel:[0,0] op_sel_hi:[0,1]
    v_pk_mul_f32 v[130:131], v[122:123], v[112:113] op_sel:[0,0] op_sel_hi:[0,1]
    v_cvt_pk_bf16_f32 v193, v168, v169
    ds_write_addtid_b32 v191 offset:11696
    v_cvt_pk_bf16_f32 v186, v178, -v179
    ds_write_addtid_b32 v192 offset:816
    v_pk_fma_f32 v[170:171], v[174:175], v[150:151], v[170:171] op_sel:[1,1,0] op_sel_hi:[1,0,1] neg_lo:[1,0,0]
    v_pk_fma_f32 v[130:131], v[122:123], v[112:113], v[130:131] op_sel:[1,1,0] op_sel_hi:[1,0,1] neg_lo:[1,0,0]
    v_pk_mul_f32 v[172:173], v[168:169], v[150:151] op_sel:[0,0] op_sel_hi:[0,1]
    v_pk_mul_f32 v[132:133], v[122:123], v[114:115] op_sel:[0,0] op_sel_hi:[0,1]
    v_cvt_pk_bf16_f32 v187, v170, v171
    ds_write_addtid_b32 v193 offset:11968
    v_cvt_pk_bf16_f32 v188, v130, -v131
    ds_write_addtid_b32 v186 offset:1088
    v_pk_fma_f32 v[172:173], v[168:169], v[150:151], v[172:173] op_sel:[1,1,0] op_sel_hi:[1,0,1] neg_lo:[1,0,0]
    v_pk_fma_f32 v[132:133], v[122:123], v[114:115], v[132:133] op_sel:[1,1,0] op_sel_hi:[1,0,1] neg_lo:[1,0,0]
    v_pk_mul_f32 v[174:175], v[170:171], v[150:151] op_sel:[0,0] op_sel_hi:[0,1]
    v_pk_mul_f32 v[176:177], v[122:123], v[116:117] op_sel:[0,0] op_sel_hi:[0,1]
    v_cvt_pk_bf16_f32 v189, v172, v173
    ds_write_addtid_b32 v187 offset:12240
    v_cvt_pk_bf16_f32 v190, v132, -v133
    ds_write_addtid_b32 v188 offset:1360
    v_pk_fma_f32 v[174:175], v[170:171], v[150:151], v[174:175] op_sel:[1,1,0] op_sel_hi:[1,0,1] neg_lo:[1,0,0]
    v_pk_fma_f32 v[176:177], v[122:123], v[116:117], v[176:177] op_sel:[1,1,0] op_sel_hi:[1,0,1] neg_lo:[1,0,0]
    v_pk_mul_f32 v[168:169], v[172:173], v[150:151] op_sel:[0,0] op_sel_hi:[0,1]
    v_pk_mul_f32 v[178:179], v[152:153], v[106:107] op_sel:[0,0] op_sel_hi:[0,1]
    v_cvt_pk_bf16_f32 v191, v174, v175
    ds_write_addtid_b32 v189 offset:12512
    v_cvt_pk_bf16_f32 v192, v176, -v177
    ds_write_addtid_b32 v190 offset:1632
    v_pk_fma_f32 v[168:169], v[172:173], v[150:151], v[168:169] op_sel:[1,1,0] op_sel_hi:[1,0,1] neg_lo:[1,0,0]
    v_pk_fma_f32 v[178:179], v[152:153], v[106:107], v[178:179] op_sel:[1,1,0] op_sel_hi:[1,0,1] neg_lo:[1,0,0]
    v_pk_mul_f32 v[170:171], v[174:175], v[150:151] op_sel:[0,0] op_sel_hi:[0,1]
    v_pk_mul_f32 v[130:131], v[152:153], v[110:111] op_sel:[0,0] op_sel_hi:[0,1]
    v_cvt_pk_bf16_f32 v193, v168, v169
    ds_write_addtid_b32 v191 offset:12784
    v_cvt_pk_bf16_f32 v186, v178, -v179
    ds_write_addtid_b32 v192 offset:1904
    v_pk_fma_f32 v[170:171], v[174:175], v[150:151], v[170:171] op_sel:[1,1,0] op_sel_hi:[1,0,1] neg_lo:[1,0,0]
    v_pk_fma_f32 v[130:131], v[152:153], v[110:111], v[130:131] op_sel:[1,1,0] op_sel_hi:[1,0,1] neg_lo:[1,0,0]
    v_pk_mul_f32 v[172:173], v[168:169], v[150:151] op_sel:[0,0] op_sel_hi:[0,1]
    v_pk_mul_f32 v[132:133], v[152:153], v[114:115] op_sel:[0,0] op_sel_hi:[0,1]
    v_cvt_pk_bf16_f32 v187, v170, v171
    ds_write_addtid_b32 v193 offset:13056
    v_cvt_pk_bf16_f32 v188, v130, -v131
    ds_write_addtid_b32 v186 offset:6800
    v_pk_fma_f32 v[172:173], v[168:169], v[150:151], v[172:173] op_sel:[1,1,0] op_sel_hi:[1,0,1] neg_lo:[1,0,0]
    v_pk_fma_f32 v[132:133], v[152:153], v[114:115], v[132:133] op_sel:[1,1,0] op_sel_hi:[1,0,1] neg_lo:[1,0,0]
    v_pk_mul_f32 v[174:175], v[170:171], v[150:151] op_sel:[0,0] op_sel_hi:[0,1]
    v_pk_mul_f32 v[176:177], v[152:153], v[118:119] op_sel:[0,0] op_sel_hi:[0,1]
    v_cvt_pk_bf16_f32 v189, v172, v173
    ds_write_addtid_b32 v187 offset:13328
    v_cvt_pk_bf16_f32 v190, v132, -v133
    ds_write_addtid_b32 v188 offset:7072
    v_pk_fma_f32 v[174:175], v[170:171], v[150:151], v[174:175] op_sel:[1,1,0] op_sel_hi:[1,0,1] neg_lo:[1,0,0]
    v_pk_fma_f32 v[176:177], v[152:153], v[118:119], v[176:177] op_sel:[1,1,0] op_sel_hi:[1,0,1] neg_lo:[1,0,0]
    v_pk_mul_f32 v[168:169], v[172:173], v[150:151] op_sel:[0,0] op_sel_hi:[0,1]
    v_pk_mul_f32 v[178:179], v[154:155], v[110:111] op_sel:[0,0] op_sel_hi:[0,1]
    v_cvt_pk_bf16_f32 v191, v174, v175
    ds_write_addtid_b32 v189 offset:13600
    v_cvt_pk_bf16_f32 v192, v176, -v177
    ds_write_addtid_b32 v190 offset:7888
    v_pk_fma_f32 v[168:169], v[172:173], v[150:151], v[168:169] op_sel:[1,1,0] op_sel_hi:[1,0,1] neg_lo:[1,0,0]
    v_pk_fma_f32 v[178:179], v[154:155], v[110:111], v[178:179] op_sel:[1,1,0] op_sel_hi:[1,0,1] neg_lo:[1,0,0]
    v_pk_mul_f32 v[170:171], v[174:175], v[150:151] op_sel:[0,0] op_sel_hi:[0,1]
    v_pk_mul_f32 v[130:131], v[154:155], v[118:119] op_sel:[0,0] op_sel_hi:[0,1]
    v_cvt_pk_bf16_f32 v193, v168, v169
    ds_write_addtid_b32 v191 offset:13872
    v_cvt_pk_bf16_f32 v186, v178, -v179
    ds_write_addtid_b32 v192 offset:8160
    v_pk_fma_f32 v[170:171], v[174:175], v[150:151], v[170:171] op_sel:[1,1,0] op_sel_hi:[1,0,1] neg_lo:[1,0,0]
    v_pk_fma_f32 v[130:131], v[154:155], v[118:119], v[130:131] op_sel:[1,1,0] op_sel_hi:[1,0,1] neg_lo:[1,0,0]
    v_pk_mul_f32 v[172:173], v[168:169], v[150:151] op_sel:[0,0] op_sel_hi:[0,1]
    v_pk_mul_f32 v[132:133], v[156:157], v[110:111] op_sel:[0,0] op_sel_hi:[0,1]
    v_cvt_pk_bf16_f32 v187, v170, v171
    ds_write_addtid_b32 v193 offset:14144
    v_cvt_pk_bf16_f32 v188, v130, -v131
    ds_write_addtid_b32 v186 offset:4624
    v_pk_fma_f32 v[172:173], v[168:169], v[150:151], v[172:173] op_sel:[1,1,0] op_sel_hi:[1,0,1] neg_lo:[1,0,0]
    v_pk_fma_f32 v[132:133], v[156:157], v[110:111], v[132:133] op_sel:[1,1,0] op_sel_hi:[1,0,1] neg_lo:[1,0,0]
    v_pk_mul_f32 v[174:175], v[170:171], v[150:151] op_sel:[0,0] op_sel_hi:[0,1]
    v_pk_mul_f32 v[176:177], v[156:157], v[118:119] op_sel:[0,0] op_sel_hi:[0,1]
    v_cvt_pk_bf16_f32 v189, v172, v173
    ds_write_addtid_b32 v187 offset:14416
    v_cvt_pk_bf16_f32 v190, v132, -v133
    ds_write_addtid_b32 v188 offset:4896
    v_pk_fma_f32 v[174:175], v[170:171], v[150:151], v[174:175] op_sel:[1,1,0] op_sel_hi:[1,0,1] neg_lo:[1,0,0]
    v_pk_fma_f32 v[176:177], v[156:157], v[118:119], v[176:177] op_sel:[1,1,0] op_sel_hi:[1,0,1] neg_lo:[1,0,0]
    v_pk_mul_f32 v[168:169], v[172:173], v[150:151] op_sel:[0,0] op_sel_hi:[0,1]
    v_pk_mul_f32 v[170:171], v[174:175], v[150:151] op_sel:[0,0] op_sel_hi:[0,1]
    v_cvt_pk_bf16_f32 v191, v174, v175
    ds_write_addtid_b32 v189 offset:14688
    v_cvt_pk_bf16_f32 v192, v176, -v177
    ds_write_addtid_b32 v190 offset:5712
    v_pk_fma_f32 v[168:169], v[172:173], v[150:151], v[168:169] op_sel:[1,1,0] op_sel_hi:[1,0,1] neg_lo:[1,0,0]
    v_pk_fma_f32 v[170:171], v[174:175], v[150:151], v[170:171] op_sel:[1,1,0] op_sel_hi:[1,0,1] neg_lo:[1,0,0]
    v_pk_mul_f32 v[172:173], v[168:169], v[150:151] op_sel:[0,0] op_sel_hi:[0,1]
    v_pk_mul_f32 v[174:175], v[170:171], v[150:151] op_sel:[0,0] op_sel_hi:[0,1]
    v_cvt_pk_bf16_f32 v193, v168, v169
    ds_write_addtid_b32 v191 offset:14960
    v_cvt_pk_bf16_f32 v186, v170, v171
    ds_write_addtid_b32 v192 offset:5984
    v_pk_fma_f32 v[172:173], v[168:169], v[150:151], v[172:173] op_sel:[1,1,0] op_sel_hi:[1,0,1] neg_lo:[1,0,0]
    v_pk_fma_f32 v[174:175], v[170:171], v[150:151], v[174:175] op_sel:[1,1,0] op_sel_hi:[1,0,1] neg_lo:[1,0,0]
    v_pk_mul_f32 v[168:169], v[172:173], v[150:151] op_sel:[0,0] op_sel_hi:[0,1]
    v_pk_mul_f32 v[170:171], v[174:175], v[150:151] op_sel:[0,0] op_sel_hi:[0,1]
    v_cvt_pk_bf16_f32 v187, v172, v173
    ds_write_addtid_b32 v193 offset:2992
    v_cvt_pk_bf16_f32 v188, v174, v175
    ds_write_addtid_b32 v186 offset:3808
    v_pk_fma_f32 v[168:169], v[172:173], v[150:151], v[168:169] op_sel:[1,1,0] op_sel_hi:[1,0,1] neg_lo:[1,0,0]
    v_pk_fma_f32 v[170:171], v[174:175], v[150:151], v[170:171] op_sel:[1,1,0] op_sel_hi:[1,0,1] neg_lo:[1,0,0]
    v_pk_mul_f32 v[172:173], v[168:169], v[150:151] op_sel:[0,0] op_sel_hi:[0,1]
    v_pk_mul_f32 v[174:175], v[170:171], v[150:151] op_sel:[0,0] op_sel_hi:[0,1]
    v_cvt_pk_bf16_f32 v189, v168, v169
    ds_write_addtid_b32 v187 offset:4080
    v_cvt_pk_bf16_f32 v190, v170, v171
    ds_write_addtid_b32 v188 offset:5168
    v_pk_fma_f32 v[172:173], v[168:169], v[150:151], v[172:173] op_sel:[1,1,0] op_sel_hi:[1,0,1] neg_lo:[1,0,0]
    v_pk_fma_f32 v[174:175], v[170:171], v[150:151], v[174:175] op_sel:[1,1,0] op_sel_hi:[1,0,1] neg_lo:[1,0,0]
    v_cvt_pk_bf16_f32 v191, v172, v173
    ds_write_addtid_b32 v189 offset:6256
    v_cvt_pk_bf16_f32 v192, v174, v175
    ds_write_addtid_b32 v190 offset:7344
    ds_write_addtid_b32 v191 offset:7616
    ds_write_addtid_b32 v192 offset:8432
    s_waitcnt lgkmcnt(0)
    ds_read_b128 v[104:107], v56 offset:0
    ds_read_b128 v[108:111], v96 offset:0
    ds_read_b128 v[112:115], v56 offset:32
    ds_read_b128 v[116:119], v96 offset:32
    ds_read_b128 v[120:123], v56 offset:64
    ds_read_b128 v[124:127], v96 offset:64
    ds_read_b128 v[128:131], v56 offset:96
    ds_read_b128 v[132:135], v96 offset:96
    ds_read_b128 v[136:139], v56 offset:128
    ds_read_b128 v[140:143], v96 offset:128
    ds_read_b128 v[144:147], v56 offset:160
    ds_read_b128 v[148:151], v96 offset:160
    ds_read_b128 v[152:155], v56 offset:192
    ds_read_b128 v[156:159], v96 offset:192
    s_waitcnt lgkmcnt(12)
    v_mfma_f32_32x32x16_bf16 v[64:79], v[104:107], v[108:111], 0
    ds_read_b128 v[160:163], v56 offset:224
    ds_read_b128 v[164:167], v96 offset:224
    s_waitcnt lgkmcnt(12)
    v_mfma_f32_32x32x16_bf16 v[64:79], v[112:115], v[116:119], v[64:79]
    s_waitcnt lgkmcnt(10)
    v_mfma_f32_32x32x16_bf16 v[64:79], v[120:123], v[124:127], v[64:79]
    s_waitcnt lgkmcnt(8)
    v_mfma_f32_32x32x16_bf16 v[64:79], v[128:131], v[132:135], v[64:79]
    s_waitcnt lgkmcnt(6)
    v_mfma_f32_32x32x16_bf16 v[64:79], v[136:139], v[140:143], v[64:79]
    s_waitcnt lgkmcnt(4)
    v_mfma_f32_32x32x16_bf16 v[64:79], v[144:147], v[148:151], v[64:79]
    s_waitcnt lgkmcnt(2)
    v_mfma_f32_32x32x16_bf16 v[64:79], v[152:155], v[156:159], v[64:79]
    s_waitcnt lgkmcnt(0)
    v_mfma_f32_32x32x16_bf16 v[64:79], v[160:163], v[164:167], v[64:79]
    v_and_b32 v134, 0xffff0000, v32
    v_and_b32 v135, 0xffff0000, v33
    v_and_b32 v136, 0xffff0000, v34
    v_and_b32 v137, 0xffff0000, v35
    v_mul_f32 v138, 0x3fb8aa3b, v134
    s_mov_b32 s34, 0x3fb8aa3b
    v_fma_f32 v139, v134, s34, -v138
    v_fmac_f32 v139, 0x32a57060, v134
    v_exp_f32 v140, v138
    v_mul_f32 v139, 0x3f317218, v139
    s_nop 0
    v_fma_f32 v134, v140, v139, v140
    v_cvt_pk_bf16_f32 v134, v134, v134
    v_and_b32 v134, 0xffff0000, v134
    v_mul_f32 v134, -v134, v184
    v_mul_f32 v135, v135, v184
    v_mul_f32 v134, 0x3fb8aa3b, v134
    v_mul_f32 v135, 0x3e22f983, v135
    v_mul_f32 v136, v136, v184
    v_mul_f32 v137, v137, v184
    v_add_f32 v122, v136, v136
    v_add_f32 v123, v137, v137
    v_exp_f32 v138, v134
    v_mul_f32 v142, 0x43800000, v134
    v_fract_f32 v139, v135
    v_mul_f32 v143, 0x43800000, v135
    v_exp_f32 v142, v142
    v_cos_f32 v140, v139
    v_fract_f32 v143, v143
    v_sin_f32 v141, v139
    v_cos_f32 v144, v143
    v_mul_f32 v104, v138, v140
    v_sin_f32 v145, v143
    v_mul_f32 v105, v138, v141
    v_mul_f32 v120, v142, v144
    v_mul_f32 v121, v142, v145
    v_cvt_pk_bf16_f32 v186, v122, -v123
    v_mov_b32 v180, 0x00003f80
    ds_write_addtid_b32 v180 offset:8704
    v_pk_mul_f32 v[106:107], v[104:105], v[104:105] op_sel:[0,0] op_sel_hi:[0,1]
    v_pk_mul_f32 v[152:153], v[122:123], v[120:121] op_sel:[0,0] op_sel_hi:[0,1]
    v_pk_fma_f32 v[106:107], v[104:105], v[104:105], v[106:107] op_sel:[1,1,0] op_sel_hi:[1,0,1] neg_lo:[1,0,0]
    v_pk_fma_f32 v[152:153], v[122:123], v[120:121], v[152:153] op_sel:[1,1,0] op_sel_hi:[1,0,1] neg_lo:[1,0,0]
    v_pk_mul_f32 v[110:111], v[106:107], v[106:107] op_sel:[0,0] op_sel_hi:[0,1]
    v_pk_mul_f32 v[108:109], v[106:107], v[104:105] op_sel:[0,0] op_sel_hi:[0,1]
    v_cvt_pk_bf16_f32 v187, v152, -v153
    v_pk_fma_f32 v[110:111], v[106:107], v[106:107], v[110:111] op_sel:[1,1,0] op_sel_hi:[1,0,1] neg_lo:[1,0,0]
    v_pk_fma_f32 v[108:109], v[106:107], v[104:105], v[108:109] op_sel:[1,1,0] op_sel_hi:[1,0,1] neg_lo:[1,0,0]
    v_pk_mul_f32 v[118:119], v[110:111], v[110:111] op_sel:[0,0] op_sel_hi:[0,1]
    v_pk_mul_f32 v[112:113], v[110:111], v[104:105] op_sel:[0,0] op_sel_hi:[0,1]
    v_pk_fma_f32 v[118:119], v[110:111], v[110:111], v[118:119] op_sel:[1,1,0] op_sel_hi:[1,0,1] neg_lo:[1,0,0]
    v_pk_fma_f32 v[112:113], v[110:111], v[104:105], v[112:113] op_sel:[1,1,0] op_sel_hi:[1,0,1] neg_lo:[1,0,0]
    v_pk_mul_f32 v[114:115], v[110:111], v[106:107] op_sel:[0,0] op_sel_hi:[0,1]
    v_pk_mul_f32 v[116:117], v[110:111], v[108:109] op_sel:[0,0] op_sel_hi:[0,1]
    v_cvt_pk_bf16_f32 v188, v118, v119
    ds_write_addtid_b32 v186 offset:0
    v_pk_fma_f32 v[114:115], v[110:111], v[106:107], v[114:115] op_sel:[1,1,0] op_sel_hi:[1,0,1] neg_lo:[1,0,0]
    v_pk_fma_f32 v[116:117], v[110:111], v[108:109], v[116:117] op_sel:[1,1,0] op_sel_hi:[1,0,1] neg_lo:[1,0,0]
    v_pk_mul_f32 v[150:151], v[118:119], v[118:119] op_sel:[0,0] op_sel_hi:[0,1]
    v_pk_mul_f32 v[154:155], v[152:153], v[120:121] op_sel:[0,0] op_sel_hi:[0,1]
    v_pk_fma_f32 v[150:151], v[118:119], v[118:119], v[150:151] op_sel:[1,1,0] op_sel_hi:[1,0,1] neg_lo:[1,0,0]
    v_pk_fma_f32 v[154:155], v[152:153], v[120:121], v[154:155] op_sel:[1,1,0] op_sel_hi:[1,0,1] neg_lo:[1,0,0]
    v_pk_mul_f32 v[174:175], v[118:119], v[150:151] op_sel:[0,0] op_sel_hi:[0,1]
    v_pk_mul_f32 v[156:157], v[154:155], v[120:121] op_sel:[0,0] op_sel_hi:[0,1]
    v_cvt_pk_bf16_f32 v189, v150, v151
    ds_write_addtid_b32 v187 offset:6528
    v_cvt_pk_bf16_f32 v190, v154, -v155
    ds_write_addtid_b32 v188 offset:8976
    v_pk_fma_f32 v[174:175], v[118:119], v[150:151], v[174:175] op_sel:[1,1,0] op_sel_hi:[1,0,1] neg_lo:[1,0,0]
    v_pk_fma_f32 v[156:157], v[154:155], v[120:121], v[156:157] op_sel:[1,1,0] op_sel_hi:[1,0,1] neg_lo:[1,0,0]
    v_pk_mul_f32 v[168:169], v[150:151], v[150:151] op_sel:[0,0] op_sel_hi:[0,1]
    v_pk_mul_f32 v[158:159], v[156:157], v[120:121] op_sel:[0,0] op_sel_hi:[0,1]
    v_cvt_pk_bf16_f32 v191, v174, v175
    ds_write_addtid_b32 v189 offset:9248
    v_cvt_pk_bf16_f32 v192, v156, -v157
    ds_write_addtid_b32 v190 offset:4352
    v_pk_fma_f32 v[168:169], v[150:151], v[150:151], v[168:169] op_sel:[1,1,0] op_sel_hi:[1,0,1] neg_lo:[1,0,0]
    v_pk_fma_f32 v[158:159], v[156:157], v[120:121], v[158:159] op_sel:[1,1,0] op_sel_hi:[1,0,1] neg_lo:[1,0,0]
    v_pk_mul_f32 v[170:171], v[174:175], v[150:151] op_sel:[0,0] op_sel_hi:[0,1]
    v_pk_mul_f32 v[160:161], v[158:159], v[120:121] op_sel:[0,0] op_sel_hi:[0,1]
    v_cvt_pk_bf16_f32 v193, v168, v169
    ds_write_addtid_b32 v191 offset:9520
    v_cvt_pk_bf16_f32 v186, v158, -v159
    ds_write_addtid_b32 v192 offset:5440
    v_pk_fma_f32 v[170:171], v[174:175], v[150:151], v[170:171] op_sel:[1,1,0] op_sel_hi:[1,0,1] neg_lo:[1,0,0]
    v_pk_fma_f32 v[160:161], v[158:159], v[120:121], v[160:161] op_sel:[1,1,0] op_sel_hi:[1,0,1] neg_lo:[1,0,0]
    v_pk_mul_f32 v[172:173], v[168:169], v[150:151] op_sel:[0,0] op_sel_hi:[0,1]
    v_pk_mul_f32 v[162:163], v[160:161], v[120:121] op_sel:[0,0] op_sel_hi:[0,1]
    v_cvt_pk_bf16_f32 v187, v170, v171
    ds_write_addtid_b32 v193 offset:9792
    v_cvt_pk_bf16_f32 v188, v160, -v161
    ds_write_addtid_b32 v186 offset:2176
    v_pk_fma_f32 v[172:173], v[168:169], v[150:151], v[172:173] op_sel:[1,1,0] op_sel_hi:[1,0,1] neg_lo:[1,0,0]
    v_pk_fma_f32 v[162:163], v[160:161], v[120:121], v[162:163] op_sel:[1,1,0] op_sel_hi:[1,0,1] neg_lo:[1,0,0]
    v_pk_mul_f32 v[174:175], v[170:171], v[150:151] op_sel:[0,0] op_sel_hi:[0,1]
    v_pk_mul_f32 v[164:165], v[162:163], v[120:121] op_sel:[0,0] op_sel_hi:[0,1]
    v_cvt_pk_bf16_f32 v189, v172, v173
    ds_write_addtid_b32 v187 offset:10064
    v_cvt_pk_bf16_f32 v190, v162, -v163
    ds_write_addtid_b32 v188 offset:2448
    v_pk_fma_f32 v[174:175], v[170:171], v[150:151], v[174:175] op_sel:[1,1,0] op_sel_hi:[1,0,1] neg_lo:[1,0,0]
    v_pk_fma_f32 v[164:165], v[162:163], v[120:121], v[164:165] op_sel:[1,1,0] op_sel_hi:[1,0,1] neg_lo:[1,0,0]
    v_pk_mul_f32 v[168:169], v[172:173], v[150:151] op_sel:[0,0] op_sel_hi:[0,1]
    v_pk_mul_f32 v[166:167], v[164:165], v[120:121] op_sel:[0,0] op_sel_hi:[0,1]
    v_cvt_pk_bf16_f32 v191, v174, v175
    ds_write_addtid_b32 v189 offset:10336
    v_cvt_pk_bf16_f32 v192, v164, -v165
    ds_write_addtid_b32 v190 offset:3264
    v_pk_fma_f32 v[168:169], v[172:173], v[150:151], v[168:169] op_sel:[1,1,0] op_sel_hi:[1,0,1] neg_lo:[1,0,0]
    v_pk_fma_f32 v[166:167], v[164:165], v[120:121], v[166:167] op_sel:[1,1,0] op_sel_hi:[1,0,1] neg_lo:[1,0,0]
    v_pk_mul_f32 v[170:171], v[174:175], v[150:151] op_sel:[0,0] op_sel_hi:[0,1]
    v_pk_mul_f32 v[130:131], v[122:123], v[104:105] op_sel:[0,0] op_sel_hi:[0,1]
    v_cvt_pk_bf16_f32 v193, v168, v169
    ds_write_addtid_b32 v191 offset:10608
    v_cvt_pk_bf16_f32 v186, v166, -v167
    ds_write_addtid_b32 v192 offset:3536
    v_pk_fma_f32 v[170:171], v[174:175], v[150:151], v[170:171] op_sel:[1,1,0] op_sel_hi:[1,0,1] neg_lo:[1,0,0]
    v_pk_fma_f32 v[130:131], v[122:123], v[104:105], v[130:131] op_sel:[1,1,0] op_sel_hi:[1,0,1] neg_lo:[1,0,0]
    v_pk_mul_f32 v[172:173], v[168:169], v[150:151] op_sel:[0,0] op_sel_hi:[0,1]
    v_pk_mul_f32 v[132:133], v[122:123], v[106:107] op_sel:[0,0] op_sel_hi:[0,1]
    v_cvt_pk_bf16_f32 v187, v170, v171
    ds_write_addtid_b32 v193 offset:10880
    v_cvt_pk_bf16_f32 v188, v130, -v131
    ds_write_addtid_b32 v186 offset:2720
    v_pk_fma_f32 v[172:173], v[168:169], v[150:151], v[172:173] op_sel:[1,1,0] op_sel_hi:[1,0,1] neg_lo:[1,0,0]
    v_pk_fma_f32 v[132:133], v[122:123], v[106:107], v[132:133] op_sel:[1,1,0] op_sel_hi:[1,0,1] neg_lo:[1,0,0]
    v_pk_mul_f32 v[174:175], v[170:171], v[150:151] op_sel:[0,0] op_sel_hi:[0,1]
    v_pk_mul_f32 v[176:177], v[122:123], v[108:109] op_sel:[0,0] op_sel_hi:[0,1]
    v_cvt_pk_bf16_f32 v189, v172, v173
    ds_write_addtid_b32 v187 offset:11152
    v_cvt_pk_bf16_f32 v190, v132, -v133
    ds_write_addtid_b32 v188 offset:272
    v_pk_fma_f32 v[174:175], v[170:171], v[150:151], v[174:175] op_sel:[1,1,0] op_sel_hi:[1,0,1] neg_lo:[1,0,0]
    v_pk_fma_f32 v[176:177], v[122:123], v[108:109], v[176:177] op_sel:[1,1,0] op_sel_hi:[1,0,1] neg_lo:[1,0,0]
    v_pk_mul_f32 v[168:169], v[172:173], v[150:151] op_sel:[0,0] op_sel_hi:[0,1]
    v_pk_mul_f32 v[178:179], v[122:123], v[110:111] op_sel:[0,0] op_sel_hi:[0,1]
    v_cvt_pk_bf16_f32 v191, v174, v175
    ds_write_addtid_b32 v189 offset:11424
    v_cvt_pk_bf16_f32 v192, v176, -v177
    ds_write_addtid_b32 v190 offset:544
    v_pk_fma_f32 v[168:169], v[172:173], v[150:151], v[168:169] op_sel:[1,1,0] op_sel_hi:[1,0,1] neg_lo:[1,0,0]
    v_pk_fma_f32 v[178:179], v[122:123], v[110:111], v[178:179] op_sel:[1,1,0] op_sel_hi:[1,0,1] neg_lo:[1,0,0]
    v_pk_mul_f32 v[170:171], v[174:175], v[150:151] op_sel:[0,0] op_sel_hi:[0,1]
    v_pk_mul_f32 v[130:131], v[122:123], v[112:113] op_sel:[0,0] op_sel_hi:[0,1]
    v_cvt_pk_bf16_f32 v193, v168, v169
    ds_write_addtid_b32 v191 offset:11696
    v_cvt_pk_bf16_f32 v186, v178, -v179
    ds_write_addtid_b32 v192 offset:816
    v_pk_fma_f32 v[170:171], v[174:175], v[150:151], v[170:171] op_sel:[1,1,0] op_sel_hi:[1,0,1] neg_lo:[1,0,0]
    v_pk_fma_f32 v[130:131], v[122:123], v[112:113], v[130:131] op_sel:[1,1,0] op_sel_hi:[1,0,1] neg_lo:[1,0,0]
    v_pk_mul_f32 v[172:173], v[168:169], v[150:151] op_sel:[0,0] op_sel_hi:[0,1]
    v_pk_mul_f32 v[132:133], v[122:123], v[114:115] op_sel:[0,0] op_sel_hi:[0,1]
    v_cvt_pk_bf16_f32 v187, v170, v171
    ds_write_addtid_b32 v193 offset:11968
    v_cvt_pk_bf16_f32 v188, v130, -v131
    ds_write_addtid_b32 v186 offset:1088
    v_pk_fma_f32 v[172:173], v[168:169], v[150:151], v[172:173] op_sel:[1,1,0] op_sel_hi:[1,0,1] neg_lo:[1,0,0]
    v_pk_fma_f32 v[132:133], v[122:123], v[114:115], v[132:133] op_sel:[1,1,0] op_sel_hi:[1,0,1] neg_lo:[1,0,0]
    v_pk_mul_f32 v[174:175], v[170:171], v[150:151] op_sel:[0,0] op_sel_hi:[0,1]
    v_pk_mul_f32 v[176:177], v[122:123], v[116:117] op_sel:[0,0] op_sel_hi:[0,1]
    v_cvt_pk_bf16_f32 v189, v172, v173
    ds_write_addtid_b32 v187 offset:12240
    v_cvt_pk_bf16_f32 v190, v132, -v133
    ds_write_addtid_b32 v188 offset:1360
    v_pk_fma_f32 v[174:175], v[170:171], v[150:151], v[174:175] op_sel:[1,1,0] op_sel_hi:[1,0,1] neg_lo:[1,0,0]
    v_pk_fma_f32 v[176:177], v[122:123], v[116:117], v[176:177] op_sel:[1,1,0] op_sel_hi:[1,0,1] neg_lo:[1,0,0]
    v_pk_mul_f32 v[168:169], v[172:173], v[150:151] op_sel:[0,0] op_sel_hi:[0,1]
    v_pk_mul_f32 v[178:179], v[152:153], v[106:107] op_sel:[0,0] op_sel_hi:[0,1]
    v_cvt_pk_bf16_f32 v191, v174, v175
    ds_write_addtid_b32 v189 offset:12512
    v_cvt_pk_bf16_f32 v192, v176, -v177
    ds_write_addtid_b32 v190 offset:1632
    v_pk_fma_f32 v[168:169], v[172:173], v[150:151], v[168:169] op_sel:[1,1,0] op_sel_hi:[1,0,1] neg_lo:[1,0,0]
    v_pk_fma_f32 v[178:179], v[152:153], v[106:107], v[178:179] op_sel:[1,1,0] op_sel_hi:[1,0,1] neg_lo:[1,0,0]
    v_pk_mul_f32 v[170:171], v[174:175], v[150:151] op_sel:[0,0] op_sel_hi:[0,1]
    v_pk_mul_f32 v[130:131], v[152:153], v[110:111] op_sel:[0,0] op_sel_hi:[0,1]
    v_cvt_pk_bf16_f32 v193, v168, v169
    ds_write_addtid_b32 v191 offset:12784
    v_cvt_pk_bf16_f32 v186, v178, -v179
    ds_write_addtid_b32 v192 offset:1904
    v_pk_fma_f32 v[170:171], v[174:175], v[150:151], v[170:171] op_sel:[1,1,0] op_sel_hi:[1,0,1] neg_lo:[1,0,0]
    v_pk_fma_f32 v[130:131], v[152:153], v[110:111], v[130:131] op_sel:[1,1,0] op_sel_hi:[1,0,1] neg_lo:[1,0,0]
    v_pk_mul_f32 v[172:173], v[168:169], v[150:151] op_sel:[0,0] op_sel_hi:[0,1]
    v_pk_mul_f32 v[132:133], v[152:153], v[114:115] op_sel:[0,0] op_sel_hi:[0,1]
    v_cvt_pk_bf16_f32 v187, v170, v171
    ds_write_addtid_b32 v193 offset:13056
    v_cvt_pk_bf16_f32 v188, v130, -v131
    ds_write_addtid_b32 v186 offset:6800
    v_pk_fma_f32 v[172:173], v[168:169], v[150:151], v[172:173] op_sel:[1,1,0] op_sel_hi:[1,0,1] neg_lo:[1,0,0]
    v_pk_fma_f32 v[132:133], v[152:153], v[114:115], v[132:133] op_sel:[1,1,0] op_sel_hi:[1,0,1] neg_lo:[1,0,0]
    v_pk_mul_f32 v[174:175], v[170:171], v[150:151] op_sel:[0,0] op_sel_hi:[0,1]
    v_pk_mul_f32 v[176:177], v[152:153], v[118:119] op_sel:[0,0] op_sel_hi:[0,1]
    v_cvt_pk_bf16_f32 v189, v172, v173
    ds_write_addtid_b32 v187 offset:13328
    v_cvt_pk_bf16_f32 v190, v132, -v133
    ds_write_addtid_b32 v188 offset:7072
    v_pk_fma_f32 v[174:175], v[170:171], v[150:151], v[174:175] op_sel:[1,1,0] op_sel_hi:[1,0,1] neg_lo:[1,0,0]
    v_pk_fma_f32 v[176:177], v[152:153], v[118:119], v[176:177] op_sel:[1,1,0] op_sel_hi:[1,0,1] neg_lo:[1,0,0]
    v_pk_mul_f32 v[168:169], v[172:173], v[150:151] op_sel:[0,0] op_sel_hi:[0,1]
    v_pk_mul_f32 v[178:179], v[154:155], v[110:111] op_sel:[0,0] op_sel_hi:[0,1]
    v_cvt_pk_bf16_f32 v191, v174, v175
    ds_write_addtid_b32 v189 offset:13600
    v_cvt_pk_bf16_f32 v192, v176, -v177
    ds_write_addtid_b32 v190 offset:7888
    v_pk_fma_f32 v[168:169], v[172:173], v[150:151], v[168:169] op_sel:[1,1,0] op_sel_hi:[1,0,1] neg_lo:[1,0,0]
    v_pk_fma_f32 v[178:179], v[154:155], v[110:111], v[178:179] op_sel:[1,1,0] op_sel_hi:[1,0,1] neg_lo:[1,0,0]
    v_pk_mul_f32 v[170:171], v[174:175], v[150:151] op_sel:[0,0] op_sel_hi:[0,1]
    v_pk_mul_f32 v[130:131], v[154:155], v[118:119] op_sel:[0,0] op_sel_hi:[0,1]
    v_cvt_pk_bf16_f32 v193, v168, v169
    ds_write_addtid_b32 v191 offset:13872
    v_cvt_pk_bf16_f32 v186, v178, -v179
    ds_write_addtid_b32 v192 offset:8160
    v_pk_fma_f32 v[170:171], v[174:175], v[150:151], v[170:171] op_sel:[1,1,0] op_sel_hi:[1,0,1] neg_lo:[1,0,0]
    v_pk_fma_f32 v[130:131], v[154:155], v[118:119], v[130:131] op_sel:[1,1,0] op_sel_hi:[1,0,1] neg_lo:[1,0,0]
    v_pk_mul_f32 v[172:173], v[168:169], v[150:151] op_sel:[0,0] op_sel_hi:[0,1]
    v_pk_mul_f32 v[132:133], v[156:157], v[110:111] op_sel:[0,0] op_sel_hi:[0,1]
    v_cvt_pk_bf16_f32 v187, v170, v171
    ds_write_addtid_b32 v193 offset:14144
    v_cvt_pk_bf16_f32 v188, v130, -v131
    ds_write_addtid_b32 v186 offset:4624
    v_pk_fma_f32 v[172:173], v[168:169], v[150:151], v[172:173] op_sel:[1,1,0] op_sel_hi:[1,0,1] neg_lo:[1,0,0]
    v_pk_fma_f32 v[132:133], v[156:157], v[110:111], v[132:133] op_sel:[1,1,0] op_sel_hi:[1,0,1] neg_lo:[1,0,0]
    v_pk_mul_f32 v[174:175], v[170:171], v[150:151] op_sel:[0,0] op_sel_hi:[0,1]
    v_pk_mul_f32 v[176:177], v[156:157], v[118:119] op_sel:[0,0] op_sel_hi:[0,1]
    v_cvt_pk_bf16_f32 v189, v172, v173
    ds_write_addtid_b32 v187 offset:14416
    v_cvt_pk_bf16_f32 v190, v132, -v133
    ds_write_addtid_b32 v188 offset:4896
    v_pk_fma_f32 v[174:175], v[170:171], v[150:151], v[174:175] op_sel:[1,1,0] op_sel_hi:[1,0,1] neg_lo:[1,0,0]
    v_pk_fma_f32 v[176:177], v[156:157], v[118:119], v[176:177] op_sel:[1,1,0] op_sel_hi:[1,0,1] neg_lo:[1,0,0]
    v_pk_mul_f32 v[168:169], v[172:173], v[150:151] op_sel:[0,0] op_sel_hi:[0,1]
    v_pk_mul_f32 v[170:171], v[174:175], v[150:151] op_sel:[0,0] op_sel_hi:[0,1]
    v_cvt_pk_bf16_f32 v191, v174, v175
    ds_write_addtid_b32 v189 offset:14688
    v_cvt_pk_bf16_f32 v192, v176, -v177
    ds_write_addtid_b32 v190 offset:5712
    v_pk_fma_f32 v[168:169], v[172:173], v[150:151], v[168:169] op_sel:[1,1,0] op_sel_hi:[1,0,1] neg_lo:[1,0,0]
    v_pk_fma_f32 v[170:171], v[174:175], v[150:151], v[170:171] op_sel:[1,1,0] op_sel_hi:[1,0,1] neg_lo:[1,0,0]
    v_pk_mul_f32 v[172:173], v[168:169], v[150:151] op_sel:[0,0] op_sel_hi:[0,1]
    v_pk_mul_f32 v[174:175], v[170:171], v[150:151] op_sel:[0,0] op_sel_hi:[0,1]
    v_cvt_pk_bf16_f32 v193, v168, v169
    ds_write_addtid_b32 v191 offset:14960
    v_cvt_pk_bf16_f32 v186, v170, v171
    ds_write_addtid_b32 v192 offset:5984
    v_pk_fma_f32 v[172:173], v[168:169], v[150:151], v[172:173] op_sel:[1,1,0] op_sel_hi:[1,0,1] neg_lo:[1,0,0]
    v_pk_fma_f32 v[174:175], v[170:171], v[150:151], v[174:175] op_sel:[1,1,0] op_sel_hi:[1,0,1] neg_lo:[1,0,0]
    v_pk_mul_f32 v[168:169], v[172:173], v[150:151] op_sel:[0,0] op_sel_hi:[0,1]
    v_pk_mul_f32 v[170:171], v[174:175], v[150:151] op_sel:[0,0] op_sel_hi:[0,1]
    v_cvt_pk_bf16_f32 v187, v172, v173
    ds_write_addtid_b32 v193 offset:2992
    v_cvt_pk_bf16_f32 v188, v174, v175
    ds_write_addtid_b32 v186 offset:3808
    v_pk_fma_f32 v[168:169], v[172:173], v[150:151], v[168:169] op_sel:[1,1,0] op_sel_hi:[1,0,1] neg_lo:[1,0,0]
    v_pk_fma_f32 v[170:171], v[174:175], v[150:151], v[170:171] op_sel:[1,1,0] op_sel_hi:[1,0,1] neg_lo:[1,0,0]
    v_pk_mul_f32 v[172:173], v[168:169], v[150:151] op_sel:[0,0] op_sel_hi:[0,1]
    v_pk_mul_f32 v[174:175], v[170:171], v[150:151] op_sel:[0,0] op_sel_hi:[0,1]
    v_cvt_pk_bf16_f32 v189, v168, v169
    ds_write_addtid_b32 v187 offset:4080
    v_cvt_pk_bf16_f32 v190, v170, v171
    ds_write_addtid_b32 v188 offset:5168
    v_pk_fma_f32 v[172:173], v[168:169], v[150:151], v[172:173] op_sel:[1,1,0] op_sel_hi:[1,0,1] neg_lo:[1,0,0]
    v_pk_fma_f32 v[174:175], v[170:171], v[150:151], v[174:175] op_sel:[1,1,0] op_sel_hi:[1,0,1] neg_lo:[1,0,0]
    v_cvt_pk_bf16_f32 v191, v172, v173
    ds_write_addtid_b32 v189 offset:6256
    v_cvt_pk_bf16_f32 v192, v174, v175
    ds_write_addtid_b32 v190 offset:7344
    ds_write_addtid_b32 v191 offset:7616
    ds_write_addtid_b32 v192 offset:8432
    s_waitcnt lgkmcnt(0)
    ds_read_b128 v[104:107], v56 offset:0
    ds_read_b128 v[108:111], v96 offset:0
    ds_read_b128 v[112:115], v56 offset:32
    ds_read_b128 v[116:119], v96 offset:32
    ds_read_b128 v[120:123], v56 offset:64
    ds_read_b128 v[124:127], v96 offset:64
    ds_read_b128 v[128:131], v56 offset:96
    ds_read_b128 v[132:135], v96 offset:96
    ds_read_b128 v[136:139], v56 offset:128
    ds_read_b128 v[140:143], v96 offset:128
    ds_read_b128 v[144:147], v56 offset:160
    ds_read_b128 v[148:151], v96 offset:160
    ds_read_b128 v[152:155], v56 offset:192
    ds_read_b128 v[156:159], v96 offset:192
    s_waitcnt lgkmcnt(12)
    v_mfma_f32_32x32x16_bf16 v[64:79], v[104:107], v[108:111], v[64:79]
    ds_read_b128 v[160:163], v56 offset:224
    ds_read_b128 v[164:167], v96 offset:224
    s_waitcnt lgkmcnt(12)
    v_mfma_f32_32x32x16_bf16 v[64:79], v[112:115], v[116:119], v[64:79]
    s_waitcnt lgkmcnt(10)
    v_mfma_f32_32x32x16_bf16 v[64:79], v[120:123], v[124:127], v[64:79]
    s_waitcnt lgkmcnt(8)
    v_mfma_f32_32x32x16_bf16 v[64:79], v[128:131], v[132:135], v[64:79]
    s_waitcnt lgkmcnt(6)
    v_mfma_f32_32x32x16_bf16 v[64:79], v[136:139], v[140:143], v[64:79]
    s_waitcnt lgkmcnt(4)
    v_mfma_f32_32x32x16_bf16 v[64:79], v[144:147], v[148:151], v[64:79]
    s_waitcnt lgkmcnt(2)
    v_mfma_f32_32x32x16_bf16 v[64:79], v[152:155], v[156:159], v[64:79]
    s_waitcnt lgkmcnt(0)
    v_mfma_f32_32x32x16_bf16 v[64:79], v[160:163], v[164:167], v[64:79]
    s_branch KD_44
YK_43:
    v_lshlrev_b32 v134, 16, v32
    v_lshlrev_b32 v135, 16, v33
    v_lshlrev_b32 v136, 16, v34
    v_lshlrev_b32 v137, 16, v35
    v_mul_f32 v138, 0x3fb8aa3b, v134
    s_mov_b32 s34, 0x3fb8aa3b
    v_fma_f32 v139, v134, s34, -v138
    v_fmac_f32 v139, 0x32a57060, v134
    v_exp_f32 v140, v138
    v_mul_f32 v139, 0x3f317218, v139
    s_nop 0
    v_fma_f32 v134, v140, v139, v140
    v_cvt_pk_bf16_f32 v134, v134, v134
    v_and_b32 v134, 0xffff0000, v134
    v_mul_f32 v134, -v134, v184
    v_mul_f32 v135, v135, v184
    v_mul_f32 v134, 0x3fb8aa3b, v134
    v_mul_f32 v135, 0x3e22f983, v135
    v_mul_f32 v136, v136, v184
    v_mul_f32 v137, v137, v184
    v_add_f32 v122, v136, v136
    v_add_f32 v123, v137, v137
    v_exp_f32 v138, v134
    v_mul_f32 v142, 0x43800000, v134
    v_fract_f32 v139, v135
    v_mul_f32 v143, 0x43800000, v135
    v_exp_f32 v142, v142
    v_cos_f32 v140, v139
    v_fract_f32 v143, v143
    v_sin_f32 v141, v139
    v_cos_f32 v144, v143
    v_mul_f32 v104, v138, v140
    v_sin_f32 v145, v143
    v_mul_f32 v105, v138, v141
    v_mul_f32 v120, v142, v144
    v_mul_f32 v121, v142, v145
    v_cvt_pk_bf16_f32 v186, v122, -v123
    v_mov_b32 v180, 0x00003f80
    ds_write_addtid_b32 v180 offset:8704
    v_pk_mul_f32 v[106:107], v[104:105], v[104:105] op_sel:[0,0] op_sel_hi:[0,1]
    v_pk_mul_f32 v[152:153], v[122:123], v[120:121] op_sel:[0,0] op_sel_hi:[0,1]
    v_pk_fma_f32 v[106:107], v[104:105], v[104:105], v[106:107] op_sel:[1,1,0] op_sel_hi:[1,0,1] neg_lo:[1,0,0]
    v_pk_fma_f32 v[152:153], v[122:123], v[120:121], v[152:153] op_sel:[1,1,0] op_sel_hi:[1,0,1] neg_lo:[1,0,0]
    v_pk_mul_f32 v[110:111], v[106:107], v[106:107] op_sel:[0,0] op_sel_hi:[0,1]
    v_pk_mul_f32 v[108:109], v[106:107], v[104:105] op_sel:[0,0] op_sel_hi:[0,1]
    v_cvt_pk_bf16_f32 v187, v152, -v153
    v_pk_fma_f32 v[110:111], v[106:107], v[106:107], v[110:111] op_sel:[1,1,0] op_sel_hi:[1,0,1] neg_lo:[1,0,0]
    v_pk_fma_f32 v[108:109], v[106:107], v[104:105], v[108:109] op_sel:[1,1,0] op_sel_hi:[1,0,1] neg_lo:[1,0,0]
    v_pk_mul_f32 v[118:119], v[110:111], v[110:111] op_sel:[0,0] op_sel_hi:[0,1]
    v_pk_mul_f32 v[112:113], v[110:111], v[104:105] op_sel:[0,0] op_sel_hi:[0,1]
    v_pk_fma_f32 v[118:119], v[110:111], v[110:111], v[118:119] op_sel:[1,1,0] op_sel_hi:[1,0,1] neg_lo:[1,0,0]
    v_pk_fma_f32 v[112:113], v[110:111], v[104:105], v[112:113] op_sel:[1,1,0] op_sel_hi:[1,0,1] neg_lo:[1,0,0]
    v_pk_mul_f32 v[114:115], v[110:111], v[106:107] op_sel:[0,0] op_sel_hi:[0,1]
    v_pk_mul_f32 v[116:117], v[110:111], v[108:109] op_sel:[0,0] op_sel_hi:[0,1]
    v_cvt_pk_bf16_f32 v188, v118, v119
    ds_write_addtid_b32 v186 offset:0
    v_pk_fma_f32 v[114:115], v[110:111], v[106:107], v[114:115] op_sel:[1,1,0] op_sel_hi:[1,0,1] neg_lo:[1,0,0]
    v_pk_fma_f32 v[116:117], v[110:111], v[108:109], v[116:117] op_sel:[1,1,0] op_sel_hi:[1,0,1] neg_lo:[1,0,0]
    v_pk_mul_f32 v[150:151], v[118:119], v[118:119] op_sel:[0,0] op_sel_hi:[0,1]
    v_pk_mul_f32 v[154:155], v[152:153], v[120:121] op_sel:[0,0] op_sel_hi:[0,1]
    v_pk_fma_f32 v[150:151], v[118:119], v[118:119], v[150:151] op_sel:[1,1,0] op_sel_hi:[1,0,1] neg_lo:[1,0,0]
    v_pk_fma_f32 v[154:155], v[152:153], v[120:121], v[154:155] op_sel:[1,1,0] op_sel_hi:[1,0,1] neg_lo:[1,0,0]
    v_pk_mul_f32 v[174:175], v[118:119], v[150:151] op_sel:[0,0] op_sel_hi:[0,1]
    v_pk_mul_f32 v[156:157], v[154:155], v[120:121] op_sel:[0,0] op_sel_hi:[0,1]
    v_cvt_pk_bf16_f32 v189, v150, v151
    ds_write_addtid_b32 v187 offset:6528
    v_cvt_pk_bf16_f32 v190, v154, -v155
    ds_write_addtid_b32 v188 offset:8976
    v_pk_fma_f32 v[174:175], v[118:119], v[150:151], v[174:175] op_sel:[1,1,0] op_sel_hi:[1,0,1] neg_lo:[1,0,0]
    v_pk_fma_f32 v[156:157], v[154:155], v[120:121], v[156:157] op_sel:[1,1,0] op_sel_hi:[1,0,1] neg_lo:[1,0,0]
    v_pk_mul_f32 v[168:169], v[150:151], v[150:151] op_sel:[0,0] op_sel_hi:[0,1]
    v_pk_mul_f32 v[158:159], v[156:157], v[120:121] op_sel:[0,0] op_sel_hi:[0,1]
    v_cvt_pk_bf16_f32 v191, v174, v175
    ds_write_addtid_b32 v189 offset:9248
    v_cvt_pk_bf16_f32 v192, v156, -v157
    ds_write_addtid_b32 v190 offset:4352
    v_pk_fma_f32 v[168:169], v[150:151], v[150:151], v[168:169] op_sel:[1,1,0] op_sel_hi:[1,0,1] neg_lo:[1,0,0]
    v_pk_fma_f32 v[158:159], v[156:157], v[120:121], v[158:159] op_sel:[1,1,0] op_sel_hi:[1,0,1] neg_lo:[1,0,0]
    v_pk_mul_f32 v[170:171], v[174:175], v[150:151] op_sel:[0,0] op_sel_hi:[0,1]
    v_pk_mul_f32 v[160:161], v[158:159], v[120:121] op_sel:[0,0] op_sel_hi:[0,1]
    v_cvt_pk_bf16_f32 v193, v168, v169
    ds_write_addtid_b32 v191 offset:9520
    v_cvt_pk_bf16_f32 v186, v158, -v159
    ds_write_addtid_b32 v192 offset:5440
    v_pk_fma_f32 v[170:171], v[174:175], v[150:151], v[170:171] op_sel:[1,1,0] op_sel_hi:[1,0,1] neg_lo:[1,0,0]
    v_pk_fma_f32 v[160:161], v[158:159], v[120:121], v[160:161] op_sel:[1,1,0] op_sel_hi:[1,0,1] neg_lo:[1,0,0]
    v_pk_mul_f32 v[172:173], v[168:169], v[150:151] op_sel:[0,0] op_sel_hi:[0,1]
    v_pk_mul_f32 v[162:163], v[160:161], v[120:121] op_sel:[0,0] op_sel_hi:[0,1]
    v_cvt_pk_bf16_f32 v187, v170, v171
    ds_write_addtid_b32 v193 offset:9792
    v_cvt_pk_bf16_f32 v188, v160, -v161
    ds_write_addtid_b32 v186 offset:2176
    v_pk_fma_f32 v[172:173], v[168:169], v[150:151], v[172:173] op_sel:[1,1,0] op_sel_hi:[1,0,1] neg_lo:[1,0,0]
    v_pk_fma_f32 v[162:163], v[160:161], v[120:121], v[162:163] op_sel:[1,1,0] op_sel_hi:[1,0,1] neg_lo:[1,0,0]
    v_pk_mul_f32 v[174:175], v[170:171], v[150:151] op_sel:[0,0] op_sel_hi:[0,1]
    v_pk_mul_f32 v[164:165], v[162:163], v[120:121] op_sel:[0,0] op_sel_hi:[0,1]
    v_cvt_pk_bf16_f32 v189, v172, v173
    ds_write_addtid_b32 v187 offset:10064
    v_cvt_pk_bf16_f32 v190, v162, -v163
    ds_write_addtid_b32 v188 offset:2448
    v_pk_fma_f32 v[174:175], v[170:171], v[150:151], v[174:175] op_sel:[1,1,0] op_sel_hi:[1,0,1] neg_lo:[1,0,0]
    v_pk_fma_f32 v[164:165], v[162:163], v[120:121], v[164:165] op_sel:[1,1,0] op_sel_hi:[1,0,1] neg_lo:[1,0,0]
    v_pk_mul_f32 v[168:169], v[172:173], v[150:151] op_sel:[0,0] op_sel_hi:[0,1]
    v_pk_mul_f32 v[166:167], v[164:165], v[120:121] op_sel:[0,0] op_sel_hi:[0,1]
    v_cvt_pk_bf16_f32 v191, v174, v175
    ds_write_addtid_b32 v189 offset:10336
    v_cvt_pk_bf16_f32 v192, v164, -v165
    ds_write_addtid_b32 v190 offset:3264
    v_pk_fma_f32 v[168:169], v[172:173], v[150:151], v[168:169] op_sel:[1,1,0] op_sel_hi:[1,0,1] neg_lo:[1,0,0]
    v_pk_fma_f32 v[166:167], v[164:165], v[120:121], v[166:167] op_sel:[1,1,0] op_sel_hi:[1,0,1] neg_lo:[1,0,0]
    v_pk_mul_f32 v[170:171], v[174:175], v[150:151] op_sel:[0,0] op_sel_hi:[0,1]
    v_pk_mul_f32 v[130:131], v[122:123], v[104:105] op_sel:[0,0] op_sel_hi:[0,1]
    v_cvt_pk_bf16_f32 v193, v168, v169
    ds_write_addtid_b32 v191 offset:10608
    v_cvt_pk_bf16_f32 v186, v166, -v167
    ds_write_addtid_b32 v192 offset:3536
    v_pk_fma_f32 v[170:171], v[174:175], v[150:151], v[170:171] op_sel:[1,1,0] op_sel_hi:[1,0,1] neg_lo:[1,0,0]
    v_pk_fma_f32 v[130:131], v[122:123], v[104:105], v[130:131] op_sel:[1,1,0] op_sel_hi:[1,0,1] neg_lo:[1,0,0]
    v_pk_mul_f32 v[172:173], v[168:169], v[150:151] op_sel:[0,0] op_sel_hi:[0,1]
    v_pk_mul_f32 v[132:133], v[122:123], v[106:107] op_sel:[0,0] op_sel_hi:[0,1]
    v_cvt_pk_bf16_f32 v187, v170, v171
    ds_write_addtid_b32 v193 offset:10880
    v_cvt_pk_bf16_f32 v188, v130, -v131
    ds_write_addtid_b32 v186 offset:2720
    v_pk_fma_f32 v[172:173], v[168:169], v[150:151], v[172:173] op_sel:[1,1,0] op_sel_hi:[1,0,1] neg_lo:[1,0,0]
    v_pk_fma_f32 v[132:133], v[122:123], v[106:107], v[132:133] op_sel:[1,1,0] op_sel_hi:[1,0,1] neg_lo:[1,0,0]
    v_pk_mul_f32 v[174:175], v[170:171], v[150:151] op_sel:[0,0] op_sel_hi:[0,1]
    v_pk_mul_f32 v[176:177], v[122:123], v[108:109] op_sel:[0,0] op_sel_hi:[0,1]
    v_cvt_pk_bf16_f32 v189, v172, v173
    ds_write_addtid_b32 v187 offset:11152
    v_cvt_pk_bf16_f32 v190, v132, -v133
    ds_write_addtid_b32 v188 offset:272
    v_pk_fma_f32 v[174:175], v[170:171], v[150:151], v[174:175] op_sel:[1,1,0] op_sel_hi:[1,0,1] neg_lo:[1,0,0]
    v_pk_fma_f32 v[176:177], v[122:123], v[108:109], v[176:177] op_sel:[1,1,0] op_sel_hi:[1,0,1] neg_lo:[1,0,0]
    v_pk_mul_f32 v[168:169], v[172:173], v[150:151] op_sel:[0,0] op_sel_hi:[0,1]
    v_pk_mul_f32 v[178:179], v[122:123], v[110:111] op_sel:[0,0] op_sel_hi:[0,1]
    v_cvt_pk_bf16_f32 v191, v174, v175
    ds_write_addtid_b32 v189 offset:11424
    v_cvt_pk_bf16_f32 v192, v176, -v177
    ds_write_addtid_b32 v190 offset:544
    v_pk_fma_f32 v[168:169], v[172:173], v[150:151], v[168:169] op_sel:[1,1,0] op_sel_hi:[1,0,1] neg_lo:[1,0,0]
    v_pk_fma_f32 v[178:179], v[122:123], v[110:111], v[178:179] op_sel:[1,1,0] op_sel_hi:[1,0,1] neg_lo:[1,0,0]
    v_pk_mul_f32 v[170:171], v[174:175], v[150:151] op_sel:[0,0] op_sel_hi:[0,1]
    v_pk_mul_f32 v[130:131], v[122:123], v[112:113] op_sel:[0,0] op_sel_hi:[0,1]
    v_cvt_pk_bf16_f32 v193, v168, v169
    ds_write_addtid_b32 v191 offset:11696
    v_cvt_pk_bf16_f32 v186, v178, -v179
    ds_write_addtid_b32 v192 offset:816
    v_pk_fma_f32 v[170:171], v[174:175], v[150:151], v[170:171] op_sel:[1,1,0] op_sel_hi:[1,0,1] neg_lo:[1,0,0]
    v_pk_fma_f32 v[130:131], v[122:123], v[112:113], v[130:131] op_sel:[1,1,0] op_sel_hi:[1,0,1] neg_lo:[1,0,0]
    v_pk_mul_f32 v[172:173], v[168:169], v[150:151] op_sel:[0,0] op_sel_hi:[0,1]
    v_pk_mul_f32 v[132:133], v[122:123], v[114:115] op_sel:[0,0] op_sel_hi:[0,1]
    v_cvt_pk_bf16_f32 v187, v170, v171
    ds_write_addtid_b32 v193 offset:11968
    v_cvt_pk_bf16_f32 v188, v130, -v131
    ds_write_addtid_b32 v186 offset:1088
    v_pk_fma_f32 v[172:173], v[168:169], v[150:151], v[172:173] op_sel:[1,1,0] op_sel_hi:[1,0,1] neg_lo:[1,0,0]
    v_pk_fma_f32 v[132:133], v[122:123], v[114:115], v[132:133] op_sel:[1,1,0] op_sel_hi:[1,0,1] neg_lo:[1,0,0]
    v_pk_mul_f32 v[174:175], v[170:171], v[150:151] op_sel:[0,0] op_sel_hi:[0,1]
    v_pk_mul_f32 v[176:177], v[122:123], v[116:117] op_sel:[0,0] op_sel_hi:[0,1]
    v_cvt_pk_bf16_f32 v189, v172, v173
    ds_write_addtid_b32 v187 offset:12240
    v_cvt_pk_bf16_f32 v190, v132, -v133
    ds_write_addtid_b32 v188 offset:1360
    v_pk_fma_f32 v[174:175], v[170:171], v[150:151], v[174:175] op_sel:[1,1,0] op_sel_hi:[1,0,1] neg_lo:[1,0,0]
    v_pk_fma_f32 v[176:177], v[122:123], v[116:117], v[176:177] op_sel:[1,1,0] op_sel_hi:[1,0,1] neg_lo:[1,0,0]
    v_pk_mul_f32 v[168:169], v[172:173], v[150:151] op_sel:[0,0] op_sel_hi:[0,1]
    v_pk_mul_f32 v[178:179], v[152:153], v[106:107] op_sel:[0,0] op_sel_hi:[0,1]
    v_cvt_pk_bf16_f32 v191, v174, v175
    ds_write_addtid_b32 v189 offset:12512
    v_cvt_pk_bf16_f32 v192, v176, -v177
    ds_write_addtid_b32 v190 offset:1632
    v_pk_fma_f32 v[168:169], v[172:173], v[150:151], v[168:169] op_sel:[1,1,0] op_sel_hi:[1,0,1] neg_lo:[1,0,0]
    v_pk_fma_f32 v[178:179], v[152:153], v[106:107], v[178:179] op_sel:[1,1,0] op_sel_hi:[1,0,1] neg_lo:[1,0,0]
    v_pk_mul_f32 v[170:171], v[174:175], v[150:151] op_sel:[0,0] op_sel_hi:[0,1]
    v_pk_mul_f32 v[130:131], v[152:153], v[110:111] op_sel:[0,0] op_sel_hi:[0,1]
    v_cvt_pk_bf16_f32 v193, v168, v169
    ds_write_addtid_b32 v191 offset:12784
    v_cvt_pk_bf16_f32 v186, v178, -v179
    ds_write_addtid_b32 v192 offset:1904
    v_pk_fma_f32 v[170:171], v[174:175], v[150:151], v[170:171] op_sel:[1,1,0] op_sel_hi:[1,0,1] neg_lo:[1,0,0]
    v_pk_fma_f32 v[130:131], v[152:153], v[110:111], v[130:131] op_sel:[1,1,0] op_sel_hi:[1,0,1] neg_lo:[1,0,0]
    v_pk_mul_f32 v[172:173], v[168:169], v[150:151] op_sel:[0,0] op_sel_hi:[0,1]
    v_pk_mul_f32 v[132:133], v[152:153], v[114:115] op_sel:[0,0] op_sel_hi:[0,1]
    v_cvt_pk_bf16_f32 v187, v170, v171
    ds_write_addtid_b32 v193 offset:13056
    v_cvt_pk_bf16_f32 v188, v130, -v131
    ds_write_addtid_b32 v186 offset:6800
    v_pk_fma_f32 v[172:173], v[168:169], v[150:151], v[172:173] op_sel:[1,1,0] op_sel_hi:[1,0,1] neg_lo:[1,0,0]
    v_pk_fma_f32 v[132:133], v[152:153], v[114:115], v[132:133] op_sel:[1,1,0] op_sel_hi:[1,0,1] neg_lo:[1,0,0]
    v_pk_mul_f32 v[174:175], v[170:171], v[150:151] op_sel:[0,0] op_sel_hi:[0,1]
    v_pk_mul_f32 v[176:177], v[152:153], v[118:119] op_sel:[0,0] op_sel_hi:[0,1]
    v_cvt_pk_bf16_f32 v189, v172, v173
    ds_write_addtid_b32 v187 offset:13328
    v_cvt_pk_bf16_f32 v190, v132, -v133
    ds_write_addtid_b32 v188 offset:7072
    v_pk_fma_f32 v[174:175], v[170:171], v[150:151], v[174:175] op_sel:[1,1,0] op_sel_hi:[1,0,1] neg_lo:[1,0,0]
    v_pk_fma_f32 v[176:177], v[152:153], v[118:119], v[176:177] op_sel:[1,1,0] op_sel_hi:[1,0,1] neg_lo:[1,0,0]
    v_pk_mul_f32 v[168:169], v[172:173], v[150:151] op_sel:[0,0] op_sel_hi:[0,1]
    v_pk_mul_f32 v[178:179], v[154:155], v[110:111] op_sel:[0,0] op_sel_hi:[0,1]
    v_cvt_pk_bf16_f32 v191, v174, v175
    ds_write_addtid_b32 v189 offset:13600
    v_cvt_pk_bf16_f32 v192, v176, -v177
    ds_write_addtid_b32 v190 offset:7888
    v_pk_fma_f32 v[168:169], v[172:173], v[150:151], v[168:169] op_sel:[1,1,0] op_sel_hi:[1,0,1] neg_lo:[1,0,0]
    v_pk_fma_f32 v[178:179], v[154:155], v[110:111], v[178:179] op_sel:[1,1,0] op_sel_hi:[1,0,1] neg_lo:[1,0,0]
    v_pk_mul_f32 v[170:171], v[174:175], v[150:151] op_sel:[0,0] op_sel_hi:[0,1]
    v_pk_mul_f32 v[130:131], v[154:155], v[118:119] op_sel:[0,0] op_sel_hi:[0,1]
    v_cvt_pk_bf16_f32 v193, v168, v169
    ds_write_addtid_b32 v191 offset:13872
    v_cvt_pk_bf16_f32 v186, v178, -v179
    ds_write_addtid_b32 v192 offset:8160
    v_pk_fma_f32 v[170:171], v[174:175], v[150:151], v[170:171] op_sel:[1,1,0] op_sel_hi:[1,0,1] neg_lo:[1,0,0]
    v_pk_fma_f32 v[130:131], v[154:155], v[118:119], v[130:131] op_sel:[1,1,0] op_sel_hi:[1,0,1] neg_lo:[1,0,0]
    v_pk_mul_f32 v[172:173], v[168:169], v[150:151] op_sel:[0,0] op_sel_hi:[0,1]
    v_pk_mul_f32 v[132:133], v[156:157], v[110:111] op_sel:[0,0] op_sel_hi:[0,1]
    v_cvt_pk_bf16_f32 v187, v170, v171
    ds_write_addtid_b32 v193 offset:14144
    v_cvt_pk_bf16_f32 v188, v130, -v131
    ds_write_addtid_b32 v186 offset:4624
    v_pk_fma_f32 v[172:173], v[168:169], v[150:151], v[172:173] op_sel:[1,1,0] op_sel_hi:[1,0,1] neg_lo:[1,0,0]
    v_pk_fma_f32 v[132:133], v[156:157], v[110:111], v[132:133] op_sel:[1,1,0] op_sel_hi:[1,0,1] neg_lo:[1,0,0]
    v_pk_mul_f32 v[174:175], v[170:171], v[150:151] op_sel:[0,0] op_sel_hi:[0,1]
    v_pk_mul_f32 v[176:177], v[156:157], v[118:119] op_sel:[0,0] op_sel_hi:[0,1]
    v_cvt_pk_bf16_f32 v189, v172, v173
    ds_write_addtid_b32 v187 offset:14416
    v_cvt_pk_bf16_f32 v190, v132, -v133
    ds_write_addtid_b32 v188 offset:4896
    v_pk_fma_f32 v[174:175], v[170:171], v[150:151], v[174:175] op_sel:[1,1,0] op_sel_hi:[1,0,1] neg_lo:[1,0,0]
    v_pk_fma_f32 v[176:177], v[156:157], v[118:119], v[176:177] op_sel:[1,1,0] op_sel_hi:[1,0,1] neg_lo:[1,0,0]
    v_pk_mul_f32 v[168:169], v[172:173], v[150:151] op_sel:[0,0] op_sel_hi:[0,1]
    v_pk_mul_f32 v[170:171], v[174:175], v[150:151] op_sel:[0,0] op_sel_hi:[0,1]
    v_cvt_pk_bf16_f32 v191, v174, v175
    ds_write_addtid_b32 v189 offset:14688
    v_cvt_pk_bf16_f32 v192, v176, -v177
    ds_write_addtid_b32 v190 offset:5712
    v_pk_fma_f32 v[168:169], v[172:173], v[150:151], v[168:169] op_sel:[1,1,0] op_sel_hi:[1,0,1] neg_lo:[1,0,0]
    v_pk_fma_f32 v[170:171], v[174:175], v[150:151], v[170:171] op_sel:[1,1,0] op_sel_hi:[1,0,1] neg_lo:[1,0,0]
    v_pk_mul_f32 v[172:173], v[168:169], v[150:151] op_sel:[0,0] op_sel_hi:[0,1]
    v_pk_mul_f32 v[174:175], v[170:171], v[150:151] op_sel:[0,0] op_sel_hi:[0,1]
    v_cvt_pk_bf16_f32 v193, v168, v169
    ds_write_addtid_b32 v191 offset:14960
    v_cvt_pk_bf16_f32 v186, v170, v171
    ds_write_addtid_b32 v192 offset:5984
    v_pk_fma_f32 v[172:173], v[168:169], v[150:151], v[172:173] op_sel:[1,1,0] op_sel_hi:[1,0,1] neg_lo:[1,0,0]
    v_pk_fma_f32 v[174:175], v[170:171], v[150:151], v[174:175] op_sel:[1,1,0] op_sel_hi:[1,0,1] neg_lo:[1,0,0]
    v_pk_mul_f32 v[168:169], v[172:173], v[150:151] op_sel:[0,0] op_sel_hi:[0,1]
    v_pk_mul_f32 v[170:171], v[174:175], v[150:151] op_sel:[0,0] op_sel_hi:[0,1]
    v_cvt_pk_bf16_f32 v187, v172, v173
    ds_write_addtid_b32 v193 offset:2992
    v_cvt_pk_bf16_f32 v188, v174, v175
    ds_write_addtid_b32 v186 offset:3808
    v_pk_fma_f32 v[168:169], v[172:173], v[150:151], v[168:169] op_sel:[1,1,0] op_sel_hi:[1,0,1] neg_lo:[1,0,0]
    v_pk_fma_f32 v[170:171], v[174:175], v[150:151], v[170:171] op_sel:[1,1,0] op_sel_hi:[1,0,1] neg_lo:[1,0,0]
    v_pk_mul_f32 v[172:173], v[168:169], v[150:151] op_sel:[0,0] op_sel_hi:[0,1]
    v_pk_mul_f32 v[174:175], v[170:171], v[150:151] op_sel:[0,0] op_sel_hi:[0,1]
    v_cvt_pk_bf16_f32 v189, v168, v169
    ds_write_addtid_b32 v187 offset:4080
    v_cvt_pk_bf16_f32 v190, v170, v171
    ds_write_addtid_b32 v188 offset:5168
    v_pk_fma_f32 v[172:173], v[168:169], v[150:151], v[172:173] op_sel:[1,1,0] op_sel_hi:[1,0,1] neg_lo:[1,0,0]
    v_pk_fma_f32 v[174:175], v[170:171], v[150:151], v[174:175] op_sel:[1,1,0] op_sel_hi:[1,0,1] neg_lo:[1,0,0]
    v_cvt_pk_bf16_f32 v191, v172, v173
    ds_write_addtid_b32 v189 offset:6256
    v_cvt_pk_bf16_f32 v192, v174, v175
    ds_write_addtid_b32 v190 offset:7344
    ds_write_addtid_b32 v191 offset:7616
    ds_write_addtid_b32 v192 offset:8432
    s_waitcnt lgkmcnt(0)
    ds_read_b128 v[104:107], v56 offset:0
    ds_read_b128 v[108:111], v96 offset:0
    ds_read_b128 v[112:115], v56 offset:32
    ds_read_b128 v[116:119], v96 offset:32
    ds_read_b128 v[120:123], v56 offset:64
    ds_read_b128 v[124:127], v96 offset:64
    ds_read_b128 v[128:131], v56 offset:96
    ds_read_b128 v[132:135], v96 offset:96
    ds_read_b128 v[136:139], v56 offset:128
    ds_read_b128 v[140:143], v96 offset:128
    ds_read_b128 v[144:147], v56 offset:160
    ds_read_b128 v[148:151], v96 offset:160
    ds_read_b128 v[152:155], v56 offset:192
    ds_read_b128 v[156:159], v96 offset:192
    s_waitcnt lgkmcnt(12)
    v_mfma_f32_32x32x16_bf16 v[64:79], v[104:107], v[108:111], 0
    ds_read_b128 v[160:163], v56 offset:224
    ds_read_b128 v[164:167], v96 offset:224
    s_waitcnt lgkmcnt(12)
    v_mfma_f32_32x32x16_bf16 v[64:79], v[112:115], v[116:119], v[64:79]
    s_waitcnt lgkmcnt(10)
    v_mfma_f32_32x32x16_bf16 v[64:79], v[120:123], v[124:127], v[64:79]
    s_waitcnt lgkmcnt(8)
    v_mfma_f32_32x32x16_bf16 v[64:79], v[128:131], v[132:135], v[64:79]
    s_waitcnt lgkmcnt(6)
    v_mfma_f32_32x32x16_bf16 v[64:79], v[136:139], v[140:143], v[64:79]
    s_waitcnt lgkmcnt(4)
    v_mfma_f32_32x32x16_bf16 v[64:79], v[144:147], v[148:151], v[64:79]
    s_waitcnt lgkmcnt(2)
    v_mfma_f32_32x32x16_bf16 v[64:79], v[152:155], v[156:159], v[64:79]
    s_waitcnt lgkmcnt(0)
    v_mfma_f32_32x32x16_bf16 v[64:79], v[160:163], v[164:167], v[64:79]
    s_setprio 3
    s_waitcnt vmcnt(0)
    s_and_b32 s35, s3, 3
    v_lshrrev_b32 v5, 5, v1
    s_lshl_b32 s33, s35, 4
    v_add_u32 v5, s33, v5
    v_mul_u32_u24 v5, 80, v5
    v_and_b32 v3, 31, v1
    v_lshl_add_u32 v5, v3, 1, v5
    v_add_u32 v5, 80, v5
    s_lshl_b32 s34, s30, 1
    s_add_u32 s34, s34, 0
    s_and_b32 s34, s34, 7
    s_mul_i32 s34, s34, 160
    v_add_u32 v6, s34, v5
    v_add_u32 v7, 61440, v6
    v_add_u32 v8, 122880, v6
    ds_write_b16 v6, v16 offset:0
    ds_write_b16_d16_hi v6, v16 offset:20480
    ds_write_b16 v6, v17 offset:40960
    ds_write_b16_d16_hi v7, v17 offset:0
    ds_write_b16 v7, v18 offset:20480
    ds_write_b16_d16_hi v7, v18 offset:40960
    ds_write_b16 v8, v19 offset:0
    ds_write_b16_d16_hi v8, v19 offset:20480
    s_lshl_b32 s34, s30, 1
    s_add_u32 s34, s34, 1
    s_and_b32 s34, s34, 7
    s_mul_i32 s34, s34, 160
    v_add_u32 v6, s34, v5
    v_add_u32 v7, 61440, v6
    v_add_u32 v8, 122880, v6
    ds_write_b16 v6, v20 offset:0
    ds_write_b16_d16_hi v6, v20 offset:20480
    ds_write_b16 v6, v21 offset:40960
    ds_write_b16_d16_hi v7, v21 offset:0
    ds_write_b16 v7, v22 offset:20480
    ds_write_b16_d16_hi v7, v22 offset:40960
    ds_write_b16 v8, v23 offset:0
    ds_write_b16_d16_hi v8, v23 offset:20480
    s_lshl_b32 s34, s30, 1
    s_add_u32 s34, s34, 2
    s_and_b32 s34, s34, 7
    s_mul_i32 s34, s34, 160
    v_add_u32 v6, s34, v5
    v_add_u32 v7, 61440, v6
    v_add_u32 v8, 122880, v6
    ds_write_b16 v6, v24 offset:0
    ds_write_b16_d16_hi v6, v24 offset:20480
    ds_write_b16 v6, v25 offset:40960
    ds_write_b16_d16_hi v7, v25 offset:0
    ds_write_b16 v7, v26 offset:20480
    ds_write_b16_d16_hi v7, v26 offset:40960
    ds_write_b16 v8, v27 offset:0
    ds_write_b16_d16_hi v8, v27 offset:20480
    s_lshl_b32 s34, s30, 1
    s_add_u32 s34, s34, 3
    s_and_b32 s34, s34, 7
    s_mul_i32 s34, s34, 160
    v_add_u32 v6, s34, v5
    v_add_u32 v7, 61440, v6
    v_add_u32 v8, 122880, v6
    ds_write_b16 v6, v28 offset:0
    ds_write_b16_d16_hi v6, v28 offset:20480
    ds_write_b16 v6, v29 offset:40960
    ds_write_b16_d16_hi v7, v29 offset:0
    ds_write_b16 v7, v30 offset:20480
    ds_write_b16_d16_hi v7, v30 offset:40960
    ds_write_b16 v8, v31 offset:0
    ds_write_b16_d16_hi v8, v31 offset:20480
    s_lshl_b32 s34, s30, 1
    s_add_u32 s34, s34, 4
    s_and_b32 s34, s34, 7
    s_mul_i32 s34, s34, 160
    v_add_u32 v6, s34, v5
    v_add_u32 v7, 61440, v6
    v_add_u32 v8, 122880, v6
    ds_write_b16 v6, v194 offset:0
    ds_write_b16_d16_hi v6, v194 offset:20480
    ds_write_b16 v6, v195 offset:40960
    ds_write_b16_d16_hi v7, v195 offset:0
    ds_write_b16 v7, v196 offset:20480
    ds_write_b16_d16_hi v7, v196 offset:40960
    ds_write_b16 v8, v197 offset:0
    ds_write_b16_d16_hi v8, v197 offset:20480
    s_lshl_b32 s34, s30, 1
    s_add_u32 s34, s34, 5
    s_and_b32 s34, s34, 7
    s_mul_i32 s34, s34, 160
    v_add_u32 v6, s34, v5
    v_add_u32 v7, 61440, v6
    v_add_u32 v8, 122880, v6
    ds_write_b16 v6, v198 offset:0
    ds_write_b16_d16_hi v6, v198 offset:20480
    ds_write_b16 v6, v199 offset:40960
    ds_write_b16_d16_hi v7, v199 offset:0
    ds_write_b16 v7, v200 offset:20480
    ds_write_b16_d16_hi v7, v200 offset:40960
    ds_write_b16 v8, v201 offset:0
    ds_write_b16_d16_hi v8, v201 offset:20480
    s_lshl_b32 s34, s30, 1
    s_add_u32 s34, s34, 6
    s_and_b32 s34, s34, 7
    s_mul_i32 s34, s34, 160
    v_add_u32 v6, s34, v5
    v_add_u32 v7, 61440, v6
    v_add_u32 v8, 122880, v6
    ds_write_b16 v6, v202 offset:0
    ds_write_b16_d16_hi v6, v202 offset:20480
    ds_write_b16 v6, v203 offset:40960
    ds_write_b16_d16_hi v7, v203 offset:0
    ds_write_b16 v7, v204 offset:20480
    ds_write_b16_d16_hi v7, v204 offset:40960
    ds_write_b16 v8, v205 offset:0
    ds_write_b16_d16_hi v8, v205 offset:20480
    s_lshl_b32 s34, s30, 1
    s_add_u32 s34, s34, 7
    s_and_b32 s34, s34, 7
    s_mul_i32 s34, s34, 160
    v_add_u32 v6, s34, v5
    v_add_u32 v7, 61440, v6
    v_add_u32 v8, 122880, v6
    ds_write_b16 v6, v206 offset:0
    ds_write_b16_d16_hi v6, v206 offset:20480
    ds_write_b16 v6, v207 offset:40960
    ds_write_b16_d16_hi v7, v207 offset:0
    ds_write_b16 v7, v208 offset:20480
    ds_write_b16_d16_hi v7, v208 offset:40960
    ds_write_b16 v8, v209 offset:0
    ds_write_b16_d16_hi v8, v209 offset:20480
    v_mov_b32 v8, 0
    v_mov_b32 v9, 0
    v_mov_b32 v10, 0
    v_mov_b32 v11, 0
    s_mul_i32 s34, s35, 20480
    v_lshlrev_b32 v5, 4, v1
    v_add_u32 v5, s34, v5
    v_add_u32 v6, 81920, v5
    s_mov_b64 s[88:89], exec
    s_mov_b64 exec, 31
    ds_write_b128 v5, v[8:11]
    ds_write_b128 v6, v[8:11]
    s_waitcnt lgkmcnt(0)
    s_mov_b64 exec, 1
    v_mov_b32 v12, 20416
    v_mov_b32 v13, 1
    ds_add_u32 v12, v13
    s_mov_b64 exec, s[88:89]
    s_setprio 1
    v_and_b32 v134, 0xffff0000, v32
    v_and_b32 v135, 0xffff0000, v33
    v_and_b32 v136, 0xffff0000, v34
    v_and_b32 v137, 0xffff0000, v35
    v_mul_f32 v138, 0x3fb8aa3b, v134
    s_mov_b32 s34, 0x3fb8aa3b
    v_fma_f32 v139, v134, s34, -v138
    v_fmac_f32 v139, 0x32a57060, v134
    v_exp_f32 v140, v138
    v_mul_f32 v139, 0x3f317218, v139
    s_nop 0
    v_fma_f32 v134, v140, v139, v140
    v_cvt_pk_bf16_f32 v134, v134, v134
    v_and_b32 v134, 0xffff0000, v134
    v_mul_f32 v134, -v134, v184
    v_mul_f32 v135, v135, v184
    v_mul_f32 v134, 0x3fb8aa3b, v134
    v_mul_f32 v135, 0x3e22f983, v135
    v_mul_f32 v136, v136, v184
    v_mul_f32 v137, v137, v184
    v_add_f32 v122, v136, v136
    v_add_f32 v123, v137, v137
    v_exp_f32 v138, v134
    v_mul_f32 v142, 0x43800000, v134
    v_fract_f32 v139, v135
    v_mul_f32 v143, 0x43800000, v135
    v_exp_f32 v142, v142
    v_cos_f32 v140, v139
    v_fract_f32 v143, v143
    v_sin_f32 v141, v139
    v_cos_f32 v144, v143
    v_mul_f32 v104, v138, v140
    v_sin_f32 v145, v143
    v_mul_f32 v105, v138, v141
    v_mul_f32 v120, v142, v144
    v_mul_f32 v121, v142, v145
    v_cvt_pk_bf16_f32 v186, v122, -v123
    v_mov_b32 v180, 0x00003f80
    ds_write_addtid_b32 v180 offset:8704
    v_mul_f32 v106, v104, v104
    v_mul_f32 v107, v104, v105
    v_mul_f32 v152, v122, v120
    v_mul_f32 v153, v122, v121
    v_fma_f32 v106, -v105, v105, v106
    v_fma_f32 v107, v105, v104, v107
    v_fma_f32 v152, -v123, v121, v152
    v_fma_f32 v153, v123, v120, v153
    v_mul_f32 v110, v106, v106
    v_mul_f32 v111, v106, v107
    v_mul_f32 v108, v106, v104
    v_mul_f32 v109, v106, v105
    v_cvt_pk_bf16_f32 v187, v152, -v153
    v_fma_f32 v110, -v107, v107, v110
    v_fma_f32 v111, v107, v106, v111
    v_fma_f32 v108, -v107, v105, v108
    v_fma_f32 v109, v107, v104, v109
    v_mul_f32 v118, v110, v110
    v_mul_f32 v119, v110, v111
    v_mul_f32 v112, v110, v104
    v_mul_f32 v113, v110, v105
    v_fma_f32 v118, -v111, v111, v118
    v_fma_f32 v119, v111, v110, v119
    v_fma_f32 v112, -v111, v105, v112
    v_fma_f32 v113, v111, v104, v113
    v_mul_f32 v114, v110, v106
    v_mul_f32 v115, v110, v107
    v_mul_f32 v116, v110, v108
    v_mul_f32 v117, v110, v109
    v_cvt_pk_bf16_f32 v188, v118, v119
    ds_write_addtid_b32 v186 offset:0
    v_fma_f32 v114, -v111, v107, v114
    v_fma_f32 v115, v111, v106, v115
    v_fma_f32 v116, -v111, v109, v116
    v_fma_f32 v117, v111, v108, v117
    v_mul_f32 v150, v118, v118
    v_mul_f32 v151, v118, v119
    v_mul_f32 v154, v152, v120
    v_mul_f32 v155, v152, v121
    v_fma_f32 v150, -v119, v119, v150
    v_fma_f32 v151, v119, v118, v151
    v_fma_f32 v154, -v153, v121, v154
    v_fma_f32 v155, v153, v120, v155
    v_mul_f32 v174, v118, v150
    v_mul_f32 v175, v118, v151
    v_mul_f32 v156, v154, v120
    v_mul_f32 v157, v154, v121
    v_cvt_pk_bf16_f32 v189, v150, v151
    ds_write_addtid_b32 v187 offset:6528
    v_cvt_pk_bf16_f32 v190, v154, -v155
    ds_write_addtid_b32 v188 offset:8976
    v_fma_f32 v174, -v119, v151, v174
    v_fma_f32 v175, v119, v150, v175
    v_fma_f32 v156, -v155, v121, v156
    v_fma_f32 v157, v155, v120, v157
    v_mul_f32 v168, v150, v150
    v_mul_f32 v169, v150, v151
    v_mul_f32 v158, v156, v120
    v_mul_f32 v159, v156, v121
    v_cvt_pk_bf16_f32 v191, v174, v175
    ds_write_addtid_b32 v189 offset:9248
    v_cvt_pk_bf16_f32 v192, v156, -v157
    ds_write_addtid_b32 v190 offset:4352
    v_fma_f32 v168, -v151, v151, v168
    v_fma_f32 v169, v151, v150, v169
    v_fma_f32 v158, -v157, v121, v158
    v_fma_f32 v159, v157, v120, v159
    v_mul_f32 v170, v174, v150
    v_mul_f32 v171, v174, v151
    v_mul_f32 v160, v158, v120
    v_mul_f32 v161, v158, v121
    v_cvt_pk_bf16_f32 v193, v168, v169
    ds_write_addtid_b32 v191 offset:9520
    v_cvt_pk_bf16_f32 v186, v158, -v159
    ds_write_addtid_b32 v192 offset:5440
    v_fma_f32 v170, -v175, v151, v170
    v_fma_f32 v171, v175, v150, v171
    v_fma_f32 v160, -v159, v121, v160
    v_fma_f32 v161, v159, v120, v161
    v_mul_f32 v172, v168, v150
    v_mul_f32 v173, v168, v151
    v_mul_f32 v162, v160, v120
    v_mul_f32 v163, v160, v121
    v_cvt_pk_bf16_f32 v187, v170, v171
    ds_write_addtid_b32 v193 offset:9792
    v_cvt_pk_bf16_f32 v188, v160, -v161
    ds_write_addtid_b32 v186 offset:2176
    v_fma_f32 v172, -v169, v151, v172
    v_fma_f32 v173, v169, v150, v173
    v_fma_f32 v162, -v161, v121, v162
    v_fma_f32 v163, v161, v120, v163
    v_mul_f32 v174, v170, v150
    v_mul_f32 v175, v170, v151
    v_mul_f32 v164, v162, v120
    v_mul_f32 v165, v162, v121
    v_cvt_pk_bf16_f32 v189, v172, v173
    ds_write_addtid_b32 v187 offset:10064
    v_cvt_pk_bf16_f32 v190, v162, -v163
    ds_write_addtid_b32 v188 offset:2448
    v_fma_f32 v174, -v171, v151, v174
    v_fma_f32 v175, v171, v150, v175
    v_fma_f32 v164, -v163, v121, v164
    v_fma_f32 v165, v163, v120, v165
    v_mul_f32 v168, v172, v150
    v_mul_f32 v169, v172, v151
    v_mul_f32 v166, v164, v120
    v_mul_f32 v167, v164, v121
    v_cvt_pk_bf16_f32 v191, v174, v175
    ds_write_addtid_b32 v189 offset:10336
    v_cvt_pk_bf16_f32 v192, v164, -v165
    ds_write_addtid_b32 v190 offset:3264
    v_fma_f32 v168, -v173, v151, v168
    v_fma_f32 v169, v173, v150, v169
    v_fma_f32 v166, -v165, v121, v166
    v_fma_f32 v167, v165, v120, v167
    v_mul_f32 v170, v174, v150
    v_mul_f32 v171, v174, v151
    v_mul_f32 v130, v122, v104
    v_mul_f32 v131, v122, v105
    v_cvt_pk_bf16_f32 v193, v168, v169
    ds_write_addtid_b32 v191 offset:10608
    v_cvt_pk_bf16_f32 v186, v166, -v167
    ds_write_addtid_b32 v192 offset:3536
    v_fma_f32 v170, -v175, v151, v170
    v_fma_f32 v171, v175, v150, v171
    v_fma_f32 v130, -v123, v105, v130
    v_fma_f32 v131, v123, v104, v131
    v_mul_f32 v172, v168, v150
    v_mul_f32 v173, v168, v151
    v_mul_f32 v132, v122, v106
    v_mul_f32 v133, v122, v107
    v_cvt_pk_bf16_f32 v187, v170, v171
    ds_write_addtid_b32 v193 offset:10880
    v_cvt_pk_bf16_f32 v188, v130, -v131
    ds_write_addtid_b32 v186 offset:2720
    v_fma_f32 v172, -v169, v151, v172
    v_fma_f32 v173, v169, v150, v173
    v_fma_f32 v132, -v123, v107, v132
    v_fma_f32 v133, v123, v106, v133
    v_mul_f32 v174, v170, v150
    v_mul_f32 v175, v170, v151
    v_mul_f32 v176, v122, v108
    v_mul_f32 v177, v122, v109
    v_cvt_pk_bf16_f32 v189, v172, v173
    ds_write_addtid_b32 v187 offset:11152
    v_cvt_pk_bf16_f32 v190, v132, -v133
    ds_write_addtid_b32 v188 offset:272
    v_fma_f32 v174, -v171, v151, v174
    v_fma_f32 v175, v171, v150, v175
    v_fma_f32 v176, -v123, v109, v176
    v_fma_f32 v177, v123, v108, v177
    v_mul_f32 v168, v172, v150
    v_mul_f32 v169, v172, v151
    v_mul_f32 v178, v122, v110
    v_mul_f32 v179, v122, v111
    v_cvt_pk_bf16_f32 v191, v174, v175
    ds_write_addtid_b32 v189 offset:11424
    v_cvt_pk_bf16_f32 v192, v176, -v177
    ds_write_addtid_b32 v190 offset:544
    v_fma_f32 v168, -v173, v151, v168
    v_fma_f32 v169, v173, v150, v169
    v_fma_f32 v178, -v123, v111, v178
    v_fma_f32 v179, v123, v110, v179
    v_mul_f32 v170, v174, v150
    v_mul_f32 v171, v174, v151
    v_mul_f32 v130, v122, v112
    v_mul_f32 v131, v122, v113
    v_cvt_pk_bf16_f32 v193, v168, v169
    ds_write_addtid_b32 v191 offset:11696
    v_cvt_pk_bf16_f32 v186, v178, -v179
    ds_write_addtid_b32 v192 offset:816
    v_fma_f32 v170, -v175, v151, v170
    v_fma_f32 v171, v175, v150, v171
    v_fma_f32 v130, -v123, v113, v130
    v_fma_f32 v131, v123, v112, v131
    v_mul_f32 v172, v168, v150
    v_mul_f32 v173, v168, v151
    v_mul_f32 v132, v122, v114
    v_mul_f32 v133, v122, v115
    v_cvt_pk_bf16_f32 v187, v170, v171
    ds_write_addtid_b32 v193 offset:11968
    v_cvt_pk_bf16_f32 v188, v130, -v131
    ds_write_addtid_b32 v186 offset:1088
    v_fma_f32 v172, -v169, v151, v172
    v_fma_f32 v173, v169, v150, v173
    v_fma_f32 v132, -v123, v115, v132
    v_fma_f32 v133, v123, v114, v133
    v_mul_f32 v174, v170, v150
    v_mul_f32 v175, v170, v151
    v_mul_f32 v176, v122, v116
    v_mul_f32 v177, v122, v117
    v_cvt_pk_bf16_f32 v189, v172, v173
    ds_write_addtid_b32 v187 offset:12240
    v_cvt_pk_bf16_f32 v190, v132, -v133
    ds_write_addtid_b32 v188 offset:1360
    v_fma_f32 v174, -v171, v151, v174
    v_fma_f32 v175, v171, v150, v175
    v_fma_f32 v176, -v123, v117, v176
    v_fma_f32 v177, v123, v116, v177
    v_mul_f32 v168, v172, v150
    v_mul_f32 v169, v172, v151
    v_mul_f32 v178, v152, v106
    v_mul_f32 v179, v152, v107
    v_cvt_pk_bf16_f32 v191, v174, v175
    ds_write_addtid_b32 v189 offset:12512
    v_cvt_pk_bf16_f32 v192, v176, -v177
    ds_write_addtid_b32 v190 offset:1632
    v_fma_f32 v168, -v173, v151, v168
    v_fma_f32 v169, v173, v150, v169
    v_fma_f32 v178, -v153, v107, v178
    v_fma_f32 v179, v153, v106, v179
    v_mul_f32 v170, v174, v150
    v_mul_f32 v171, v174, v151
    v_mul_f32 v130, v152, v110
    v_mul_f32 v131, v152, v111
    v_cvt_pk_bf16_f32 v193, v168, v169
    ds_write_addtid_b32 v191 offset:12784
    v_cvt_pk_bf16_f32 v186, v178, -v179
    ds_write_addtid_b32 v192 offset:1904
    v_fma_f32 v170, -v175, v151, v170
    v_fma_f32 v171, v175, v150, v171
    v_fma_f32 v130, -v153, v111, v130
    v_fma_f32 v131, v153, v110, v131
    v_mul_f32 v172, v168, v150
    v_mul_f32 v173, v168, v151
    v_mul_f32 v132, v152, v114
    v_mul_f32 v133, v152, v115
    v_cvt_pk_bf16_f32 v187, v170, v171
    ds_write_addtid_b32 v193 offset:13056
    v_cvt_pk_bf16_f32 v188, v130, -v131
    ds_write_addtid_b32 v186 offset:6800
    v_fma_f32 v172, -v169, v151, v172
    v_fma_f32 v173, v169, v150, v173
    v_fma_f32 v132, -v153, v115, v132
    v_fma_f32 v133, v153, v114, v133
    v_mul_f32 v174, v170, v150
    v_mul_f32 v175, v170, v151
    v_mul_f32 v176, v152, v118
    v_mul_f32 v177, v152, v119
    v_cvt_pk_bf16_f32 v189, v172, v173
    ds_write_addtid_b32 v187 offset:13328
    v_cvt_pk_bf16_f32 v190, v132, -v133
    ds_write_addtid_b32 v188 offset:7072
    v_fma_f32 v174, -v171, v151, v174
    v_fma_f32 v175, v171, v150, v175
    v_fma_f32 v176, -v153, v119, v176
    v_fma_f32 v177, v153, v118, v177
    v_mul_f32 v168, v172, v150
    v_mul_f32 v169, v172, v151
    v_mul_f32 v178, v154, v110
    v_mul_f32 v179, v154, v111
    v_cvt_pk_bf16_f32 v191, v174, v175
    ds_write_addtid_b32 v189 offset:13600
    v_cvt_pk_bf16_f32 v192, v176, -v177
    ds_write_addtid_b32 v190 offset:7888
    v_fma_f32 v168, -v173, v151, v168
    v_fma_f32 v169, v173, v150, v169
    v_fma_f32 v178, -v155, v111, v178
    v_fma_f32 v179, v155, v110, v179
    v_mul_f32 v170, v174, v150
    v_mul_f32 v171, v174, v151
    v_mul_f32 v130, v154, v118
    v_mul_f32 v131, v154, v119
    v_cvt_pk_bf16_f32 v193, v168, v169
    ds_write_addtid_b32 v191 offset:13872
    v_cvt_pk_bf16_f32 v186, v178, -v179
    ds_write_addtid_b32 v192 offset:8160
    v_fma_f32 v170, -v175, v151, v170
    v_fma_f32 v171, v175, v150, v171
    v_fma_f32 v130, -v155, v119, v130
    v_fma_f32 v131, v155, v118, v131
    v_mul_f32 v172, v168, v150
    v_mul_f32 v173, v168, v151
    v_mul_f32 v132, v156, v110
    v_mul_f32 v133, v156, v111
    v_cvt_pk_bf16_f32 v187, v170, v171
    ds_write_addtid_b32 v193 offset:14144
    v_cvt_pk_bf16_f32 v188, v130, -v131
    ds_write_addtid_b32 v186 offset:4624
    v_fma_f32 v172, -v169, v151, v172
    v_fma_f32 v173, v169, v150, v173
    v_fma_f32 v132, -v157, v111, v132
    v_fma_f32 v133, v157, v110, v133
    v_mul_f32 v174, v170, v150
    v_mul_f32 v175, v170, v151
    v_mul_f32 v176, v156, v118
    v_mul_f32 v177, v156, v119
    v_cvt_pk_bf16_f32 v189, v172, v173
    ds_write_addtid_b32 v187 offset:14416
    v_cvt_pk_bf16_f32 v190, v132, -v133
    ds_write_addtid_b32 v188 offset:4896
    v_fma_f32 v174, -v171, v151, v174
    v_fma_f32 v175, v171, v150, v175
    v_fma_f32 v176, -v157, v119, v176
    v_fma_f32 v177, v157, v118, v177
    v_mul_f32 v168, v172, v150
    v_mul_f32 v169, v172, v151
    v_mul_f32 v170, v174, v150
    v_mul_f32 v171, v174, v151
    v_cvt_pk_bf16_f32 v191, v174, v175
    ds_write_addtid_b32 v189 offset:14688
    v_cvt_pk_bf16_f32 v192, v176, -v177
    ds_write_addtid_b32 v190 offset:5712
    v_fma_f32 v168, -v173, v151, v168
    v_fma_f32 v169, v173, v150, v169
    v_fma_f32 v170, -v175, v151, v170
    v_fma_f32 v171, v175, v150, v171
    v_mul_f32 v172, v168, v150
    v_mul_f32 v173, v168, v151
    v_mul_f32 v174, v170, v150
    v_mul_f32 v175, v170, v151
    v_cvt_pk_bf16_f32 v193, v168, v169
    ds_write_addtid_b32 v191 offset:14960
    v_cvt_pk_bf16_f32 v186, v170, v171
    ds_write_addtid_b32 v192 offset:5984
    v_fma_f32 v172, -v169, v151, v172
    v_fma_f32 v173, v169, v150, v173
    v_fma_f32 v174, -v171, v151, v174
    v_fma_f32 v175, v171, v150, v175
    v_mul_f32 v168, v172, v150
    v_mul_f32 v169, v172, v151
    v_mul_f32 v170, v174, v150
    v_mul_f32 v171, v174, v151
    v_cvt_pk_bf16_f32 v187, v172, v173
    ds_write_addtid_b32 v193 offset:2992
    v_cvt_pk_bf16_f32 v188, v174, v175
    ds_write_addtid_b32 v186 offset:3808
    v_fma_f32 v168, -v173, v151, v168
    v_fma_f32 v169, v173, v150, v169
    v_fma_f32 v170, -v175, v151, v170
    v_fma_f32 v171, v175, v150, v171
    v_mul_f32 v172, v168, v150
    v_mul_f32 v173, v168, v151
    v_mul_f32 v174, v170, v150
    v_mul_f32 v175, v170, v151
    v_cvt_pk_bf16_f32 v189, v168, v169
    ds_write_addtid_b32 v187 offset:4080
    v_cvt_pk_bf16_f32 v190, v170, v171
    ds_write_addtid_b32 v188 offset:5168
    v_fma_f32 v172, -v169, v151, v172
    v_fma_f32 v173, v169, v150, v173
    v_fma_f32 v174, -v171, v151, v174
    v_fma_f32 v175, v171, v150, v175
    v_cvt_pk_bf16_f32 v191, v172, v173
    ds_write_addtid_b32 v189 offset:6256
    v_cvt_pk_bf16_f32 v192, v174, v175
    ds_write_addtid_b32 v190 offset:7344
    ds_write_addtid_b32 v191 offset:7616
    ds_write_addtid_b32 v192 offset:8432
    s_waitcnt lgkmcnt(0)
    ds_read_b128 v[104:107], v56 offset:0
    ds_read_b128 v[108:111], v96 offset:0
    ds_read_b128 v[112:115], v56 offset:32
    ds_read_b128 v[116:119], v96 offset:32
    ds_read_b128 v[120:123], v56 offset:64
    ds_read_b128 v[124:127], v96 offset:64
    ds_read_b128 v[128:131], v56 offset:96
    ds_read_b128 v[132:135], v96 offset:96
    ds_read_b128 v[136:139], v56 offset:128
    ds_read_b128 v[140:143], v96 offset:128
    ds_read_b128 v[144:147], v56 offset:160
    ds_read_b128 v[148:151], v96 offset:160
    ds_read_b128 v[152:155], v56 offset:192
    ds_read_b128 v[156:159], v96 offset:192
    s_waitcnt lgkmcnt(12)
    v_mfma_f32_32x32x16_bf16 v[64:79], v[104:107], v[108:111], v[64:79]
    ds_read_b128 v[160:163], v56 offset:224
    ds_read_b128 v[164:167], v96 offset:224
    s_waitcnt lgkmcnt(12)
    v_mfma_f32_32x32x16_bf16 v[64:79], v[112:115], v[116:119], v[64:79]
    s_waitcnt lgkmcnt(10)
    v_mfma_f32_32x32x16_bf16 v[64:79], v[120:123], v[124:127], v[64:79]
    s_waitcnt lgkmcnt(8)
    v_mfma_f32_32x32x16_bf16 v[64:79], v[128:131], v[132:135], v[64:79]
    s_waitcnt lgkmcnt(6)
    v_mfma_f32_32x32x16_bf16 v[64:79], v[136:139], v[140:143], v[64:79]
    s_waitcnt lgkmcnt(4)
    v_mfma_f32_32x32x16_bf16 v[64:79], v[144:147], v[148:151], v[64:79]
    s_waitcnt lgkmcnt(2)
    v_mfma_f32_32x32x16_bf16 v[64:79], v[152:155], v[156:159], v[64:79]
    s_waitcnt lgkmcnt(0)
    v_mfma_f32_32x32x16_bf16 v[64:79], v[160:163], v[164:167], v[64:79]
KD_44:
    v_mov_b32 v5, 0
    buffer_load_dwordx2 v[52:53], v5, s[24:27], 0 offen sc1
    v_mov_b32 v8, 0
    v_mov_b32 v9, 0
    v_mov_b32 v10, 0
    v_mov_b32 v11, 0
    s_mov_b64 s[88:89], exec
    s_nop 7
    v_and_b32 v5, 31, v1
    v_lshrrev_b32 v6, 5, v1
    s_add_u32 s33, s32, 5200
    v_lshlrev_b32 v7, 4, v1
    v_add_u32 v7, s33, v7
    s_mov_b64 exec, 0x7f
    ds_write_b128 v7, v[8:11]
    s_mov_b64 exec, 15
    ds_write_b128 v7, v[8:11] offset:2176
    s_mov_b64 exec, 0xffff
    ds_write_b128 v7, v[8:11] offset:9760
    s_mov_b64 exec, -1
    v_lshlrev_b32 v12, 4, v5
    v_lshl_add_u32 v12, v6, 3, v12
    v_sub_u32 v12, 1656, v12
    v_add_u32 v12, s33, v12
    v_cvt_pk_bf16_f32 v200, v67, v66
    v_cvt_pk_bf16_f32 v201, v65, v64
    ds_write_b64 v12, v[200:201] offset:512
    v_cvt_pk_bf16_f32 v202, v78, v77
    v_cvt_pk_bf16_f32 v203, v76, v76
    ds_write_b64 v12, v[202:203]
    v_lshlrev_b32 v12, 4, v5
    v_lshl_add_u32 v12, v6, 9, v12
    v_sub_u32 v12, 1136, v12
    v_add_u32 v12, s33, v12
    v_cvt_pk_bf16_f32 v206, v74, v74
    v_cvt_pk_bf16_f32 v207, v73, v73
    v_cvt_pk_bf16_f32 v208, v73, v72
    v_cvt_pk_bf16_f32 v209, v72, v72
    ds_write_b128 v12, v[206:209]
    v_cvt_pk_bf16_f32 v213, v68, v68
    v_mov_b32 v210, 0
    v_and_b32 v211, 0xffff0000, v213
    v_mov_b32 v212, v213
    v_mov_b32 v13, s33
    s_mov_b64 exec, 1
    ds_write_b128 v13, v[210:213] offset:112
    s_mov_b64 exec, -1
    v_lshlrev_b32 v12, 1, v5
    v_lshl_add_u32 v12, v6, 7, v12
    v_sub_u32 v12, 192, v12
    v_add_u32 v12, s33, v12
    v_cvt_pk_bf16_f32 v200, v68, v69
    ds_write_b16 v12, v200 offset:9568
    ds_write_b16_d16_hi v12, v200 offset:9504
    v_cvt_pk_bf16_f32 v201, v70, v70
    v_mov_b32 v202, 0
    s_mov_b64 exec, 1
    ds_write_b16 v13, v202 offset:9760
    ds_write_b16 v13, v201 offset:9504
    s_mov_b64 exec, -1
    s_waitcnt lgkmcnt(0)
    v_lshlrev_b32 v6, 4, v1
    s_add_u32 s34, s32, 5232
    v_add_u32 v6, s34, v6
    ds_read_b128 v[104:107], v7 offset:32
    ds_read_b128 v[108:111], v7 offset:48
    ds_read_b128 v[124:127], v7 offset:1056
    ds_read_b128 v[128:131], v7 offset:1072
    s_waitcnt lgkmcnt(2)
    v_alignbyte_b32 v112, v105, v104, 2
    v_alignbyte_b32 v113, v106, v105, 2
    v_alignbyte_b32 v114, v107, v106, 2
    v_alignbyte_b32 v115, v108, v107, 2
    v_mov_b32 v116, v105
    v_mov_b32 v117, v106
    v_mov_b32 v118, v107
    v_mov_b32 v119, v108
    ds_write_b128 v6, v[112:115] offset:2368
    v_alignbyte_b32 v120, v106, v105, 2
    v_alignbyte_b32 v121, v107, v106, 2
    v_alignbyte_b32 v122, v108, v107, 2
    v_alignbyte_b32 v123, v109, v108, 2
    ds_write_b128 v6, v[116:119] offset:4736
    ds_write_b128 v6, v[120:123] offset:7104
    s_waitcnt lgkmcnt(3)
    v_alignbyte_b32 v132, v125, v124, 2
    v_alignbyte_b32 v133, v126, v125, 2
    v_alignbyte_b32 v134, v127, v126, 2
    v_alignbyte_b32 v135, v128, v127, 2
    v_mov_b32 v136, v125
    v_mov_b32 v137, v126
    v_mov_b32 v138, v127
    v_mov_b32 v139, v128
    ds_write_b128 v6, v[132:135] offset:3392
    v_alignbyte_b32 v140, v126, v125, 2
    v_alignbyte_b32 v141, v127, v126, 2
    v_alignbyte_b32 v142, v128, v127, 2
    v_alignbyte_b32 v143, v129, v128, 2
    ds_write_b128 v6, v[136:139] offset:5760
    ds_write_b128 v6, v[140:143] offset:8128
    s_mov_b64 s[88:89], exec
    s_mov_b64 exec, 0x3ff
    ds_read_b128 v[104:107], v7 offset:2080
    ds_read_b128 v[108:111], v7 offset:2096
    s_waitcnt lgkmcnt(0)
    v_alignbyte_b32 v112, v105, v104, 2
    v_alignbyte_b32 v113, v106, v105, 2
    v_alignbyte_b32 v114, v107, v106, 2
    v_alignbyte_b32 v115, v108, v107, 2
    v_mov_b32 v116, v105
    v_mov_b32 v117, v106
    v_mov_b32 v118, v107
    v_mov_b32 v119, v108
    ds_write_b128 v6, v[112:115] offset:4416
    v_alignbyte_b32 v120, v106, v105, 2
    v_alignbyte_b32 v121, v107, v106, 2
    v_alignbyte_b32 v122, v108, v107, 2
    v_alignbyte_b32 v123, v109, v108, 2
    ds_write_b128 v6, v[116:119] offset:6784
    ds_write_b128 v6, v[120:123] offset:9152
    s_mov_b64 exec, s[88:89]
    s_add_u32 s34, s32, 5232
    v_and_b32 v9, 31, v1
    v_lshrrev_b32 v8, 5, v1
    v_sub_u32 v10, 3, v9
    v_and_b32 v10, 3, v10
    v_lshlrev_b32 v11, 3, v8
    v_sub_u32 v11, v11, v9
    v_sub_u32 v11, v11, v10
    v_lshlrev_b32 v11, 1, v11
    v_add_u32 v11, 30, v11
    v_mul_u32_u24 v10, 2368, v10
    v_add_u32 v11, v11, v10
    v_add_u32 v40, s34, v11
    v_lshlrev_b32 v11, 4, v8
    v_add_u32 v43, s32, v11
    v_mul_u32_u24 v10, 80, v9
    v_add_u32 v41, v10, v43
    v_add_u32 v42, 80, v41
    v_mov_b32 v48, s32
    v_mov_b32 v54, v185
    v_lshlrev_b32 v10, 3, v9
    v_lshlrev_b32 v11, 4, v8
    v_sub_u32 v11, v11, v10
    v_add_u32 v11, 14952, v11
    v_add_u32 v51, s32, v11
    s_mov_b32 s12, s60
    s_and_b32 s13, s61, 0xffff
    s_mov_b32 s14, 819200
    s_mov_b32 s15, 0x00020000
    s_mov_b32 s16, s62
    s_and_b32 s17, s63, 0xffff
    s_mov_b32 s18, 819200
    s_mov_b32 s19, 0x00020000
    s_cmp_lt_u32 s3, 4
    s_cselect_b32 s14, 819200, 0
    s_cselect_b32 s18, 819200, 0
    v_lshrrev_b32 v14, 3, v1
    v_mul_u32_u24 v14, 1280, v14
    v_and_b32 v15, 7, v1
    v_lshl_add_u32 v39, v15, 6, v14
    s_mul_hi_u32 s35, s30, 429496730
    s_mul_i32 s34, s35, 10
    s_sub_u32 s34, s30, s34
    s_and_b32 s35, s35, 1
    s_mul_i32 s35, s35, 40
    s_lshl_b32 s34, s34, 2
    s_add_u32 s35, s35, s34
    s_and_b32 s34, s3, 3
    s_add_u32 s35, s35, s34
    s_mul_i32 s94, s35, 10240
    buffer_load_dword v38, v39, s[12:15], s94 offen offset:0
    buffer_load_dword v38, v39, s[16:19], s94 offen offset:0
    buffer_load_dword v38, v39, s[12:15], s94 offen offset:512
    buffer_load_dword v38, v39, s[16:19], s94 offen offset:512
    buffer_load_dword v38, v39, s[12:15], s94 offen offset:1024
    buffer_load_dword v38, v39, s[16:19], s94 offen offset:1024
    v_mov_b32 v12, 20416
    s_mov_b32 s82, 2000000
USP_45:
    ds_read_b32 v13, v12
    s_waitcnt lgkmcnt(0)
    v_readfirstlane_b32 s87, v13
    s_nop 0
    s_cmp_ge_u32 s87, 4
    s_cbranch_scc1 USOK_46
    s_sleep 2
    s_sub_u32 s82, s82, 1
    s_cbranch_scc0 USP_45
USOK_46:
    s_setprio 0
    s_cmp_lt_u32 s3, 4
    s_cbranch_scc1 YDP_47
    s_setprio 1
    s_branch YDE_48
YDP_47:
    s_setprio 2
YDE_48:
    v_max_i32 v44, v42, v43
    ds_read_b64 v[104:105], v40 offset:2112
    ds_read_b64 v[106:107], v40 offset:2120
    ds_read_b128 v[112:115], v41 offset:2640
    ds_read_b128 v[108:111], v44 offset:0
    ds_read_b64 v[116:117], v40 offset:2144
    ds_read_b64 v[118:119], v40 offset:2152
    ds_read_b128 v[124:127], v41 offset:2672
    ds_read_b128 v[120:123], v44 offset:32
    v_subrev_u32 v42, 80, v42
    v_max_i32 v45, v42, v43
    ds_read_b64 v[128:129], v40 offset:2048
    ds_read_b64 v[130:131], v40 offset:2056
    ds_read_b128 v[136:139], v41 offset:2560
    ds_read_b128 v[132:135], v45 offset:0
    s_waitcnt lgkmcnt(8)
    v_mfma_f32_32x32x16_bf16 v[80:95], v[104:107], v[112:115], 0
    ds_read_b64 v[140:141], v40 offset:2080
    ds_read_b64 v[142:143], v40 offset:2088
    v_mfma_f32_32x32x16_bf16 v[64:79], v[104:107], v[108:111], 0
    ds_read_b128 v[148:151], v41 offset:2592
    ds_read_b128 v[144:147], v45 offset:32
    s_waitcnt lgkmcnt(8)
    v_mfma_f32_32x32x16_bf16 v[80:95], v[116:119], v[124:127], v[80:95]
    v_subrev_u32 v42, 80, v42
    v_max_i32 v46, v42, v43
    ds_read_b64 v[104:105], v40 offset:1984
    v_mfma_f32_32x32x16_bf16 v[64:79], v[116:119], v[120:123], v[64:79]
    ds_read_b64 v[106:107], v40 offset:1992
    ds_read_b128 v[112:115], v41 offset:2480
    ds_read_b128 v[108:111], v46 offset:0
    s_waitcnt lgkmcnt(8)
    v_mfma_f32_32x32x16_bf16 v[80:95], v[128:131], v[136:139], v[80:95]
    ds_read_b64 v[116:117], v40 offset:2016
    ds_read_b64 v[118:119], v40 offset:2024
    ds_read_b128 v[124:127], v41 offset:2512
    ds_read_b128 v[120:123], v46 offset:32
    v_mfma_f32_32x32x16_bf16 v[64:79], v[128:131], v[132:135], v[64:79]
    v_and_b32 v186, 31, v1
    v_lshrrev_b32 v187, 5, v1
    v_lshlrev_b32 v188, 3, v187
    s_waitcnt lgkmcnt(8)
    v_mfma_f32_32x32x16_bf16 v[80:95], v[140:143], v[148:151], v[80:95]
    v_subrev_u32 v42, 80, v42
    v_max_i32 v47, v42, v43
    ds_read_b64 v[128:129], v40 offset:1920
    ds_read_b64 v[130:131], v40 offset:1928
    ds_read_b128 v[136:139], v41 offset:2400
    v_mfma_f32_32x32x16_bf16 v[64:79], v[140:143], v[144:147], v[64:79]
    ds_read_b128 v[132:135], v47 offset:0
    v_sub_u32 v188, v188, v186
    v_subrev_u32 v188, 8, v188
    v_lshlrev_b32 v189, 4, v186
    s_waitcnt lgkmcnt(8)
    v_mfma_f32_32x32x16_bf16 v[80:95], v[104:107], v[112:115], v[80:95]
    ds_read_b64 v[140:141], v40 offset:1952
    ds_read_b64 v[142:143], v40 offset:1960
    ds_read_b128 v[148:151], v41 offset:2432
    ds_read_b128 v[144:147], v47 offset:32
    v_mfma_f32_32x32x16_bf16 v[64:79], v[104:107], v[108:111], v[64:79]
    v_lshl_add_u32 v189, v187, 3, v189
    s_add_u32 s95, s32, 1200
    v_mov_b32 v192, s32
    s_waitcnt lgkmcnt(8)
    v_mfma_f32_32x32x16_bf16 v[80:95], v[116:119], v[124:127], v[80:95]
    v_subrev_u32 v42, 80, v42
    v_max_i32 v44, v42, v43
    ds_read_b64 v[104:105], v40 offset:1856
    ds_read_b64 v[106:107], v40 offset:1864
    ds_read_b128 v[112:115], v41 offset:2320
    v_mfma_f32_32x32x16_bf16 v[64:79], v[116:119], v[120:123], v[64:79]
    ds_read_b128 v[108:111], v44 offset:0
    v_add_u32 v190, 24, v189
    v_lshrrev_b32 v191, 5, v190
    v_mul_u32_u24 v191, 80, v191
    s_waitcnt lgkmcnt(8)
    v_mfma_f32_32x32x16_bf16 v[80:95], v[128:131], v[136:139], v[80:95]
    ds_read_b64 v[116:117], v40 offset:1888
    ds_read_b64 v[118:119], v40 offset:1896
    ds_read_b128 v[124:127], v41 offset:2352
    ds_read_b128 v[120:123], v44 offset:32
    v_mfma_f32_32x32x16_bf16 v[64:79], v[128:131], v[132:135], v[64:79]
    v_and_b32 v190, 31, v190
    v_lshl_add_u32 v191, v190, 1, v191
    v_add_u32 v246, s95, v191
    s_waitcnt lgkmcnt(8)
    v_mfma_f32_32x32x16_bf16 v[80:95], v[140:143], v[148:151], v[80:95]
    v_subrev_u32 v42, 80, v42
    v_max_i32 v45, v42, v43
    ds_read_b64 v[128:129], v40 offset:1792
    ds_read_b64 v[130:131], v40 offset:1800
    ds_read_b128 v[136:139], v41 offset:2240
    v_mfma_f32_32x32x16_bf16 v[64:79], v[140:143], v[144:147], v[64:79]
    ds_read_b128 v[132:135], v45 offset:0
    v_subrev_u32 v191, 1280, v246
    v_max_i32 v240, v191, v192
    v_add_u32 v190, 40, v189
    s_waitcnt lgkmcnt(8)
    v_mfma_f32_32x32x16_bf16 v[80:95], v[104:107], v[112:115], v[80:95]
    ds_read_b64 v[140:141], v40 offset:1824
    ds_read_b64 v[142:143], v40 offset:1832
    ds_read_b128 v[148:151], v41 offset:2272
    ds_read_b128 v[144:147], v45 offset:32
    v_mfma_f32_32x32x16_bf16 v[64:79], v[104:107], v[108:111], v[64:79]
    v_lshrrev_b32 v191, 5, v190
    v_mul_u32_u24 v191, 80, v191
    v_and_b32 v190, 31, v190
    s_waitcnt lgkmcnt(8)
    v_mfma_f32_32x32x16_bf16 v[80:95], v[116:119], v[124:127], v[80:95]
    v_subrev_u32 v42, 80, v42
    v_max_i32 v46, v42, v43
    ds_read_b64 v[104:105], v40 offset:1728
    ds_read_b64 v[106:107], v40 offset:1736
    ds_read_b128 v[112:115], v41 offset:2160
    v_mfma_f32_32x32x16_bf16 v[64:79], v[116:119], v[120:123], v[64:79]
    ds_read_b128 v[108:111], v46 offset:0
    v_lshl_add_u32 v191, v190, 1, v191
    v_add_u32 v247, s95, v191
    v_subrev_u32 v191, 1280, v247
    s_waitcnt lgkmcnt(8)
    v_mfma_f32_32x32x16_bf16 v[80:95], v[128:131], v[136:139], v[80:95]
    ds_read_b64 v[116:117], v40 offset:1760
    ds_read_b64 v[118:119], v40 offset:1768
    ds_read_b128 v[124:127], v41 offset:2192
    ds_read_b128 v[120:123], v46 offset:32
    v_mfma_f32_32x32x16_bf16 v[64:79], v[128:131], v[132:135], v[64:79]
    v_max_i32 v241, v191, v192
    v_add_u32 v190, 56, v189
    v_lshrrev_b32 v191, 5, v190
    s_waitcnt lgkmcnt(8)
    v_mfma_f32_32x32x16_bf16 v[80:95], v[140:143], v[148:151], v[80:95]
    v_subrev_u32 v42, 80, v42
    v_max_i32 v47, v42, v43
    ds_read_b64 v[128:129], v40 offset:1664
    ds_read_b64 v[130:131], v40 offset:1672
    ds_read_b128 v[136:139], v41 offset:2080
    v_mfma_f32_32x32x16_bf16 v[64:79], v[140:143], v[144:147], v[64:79]
    ds_read_b128 v[132:135], v47 offset:0
    v_mul_u32_u24 v191, 80, v191
    v_and_b32 v190, 31, v190
    v_lshl_add_u32 v191, v190, 1, v191
    s_waitcnt lgkmcnt(8)
    v_mfma_f32_32x32x16_bf16 v[80:95], v[104:107], v[112:115], v[80:95]
    ds_read_b64 v[140:141], v40 offset:1696
    ds_read_b64 v[142:143], v40 offset:1704
    ds_read_b128 v[148:151], v41 offset:2112
    ds_read_b128 v[144:147], v47 offset:32
    v_mfma_f32_32x32x16_bf16 v[64:79], v[104:107], v[108:111], v[64:79]
    v_add_u32 v248, s95, v191
    v_subrev_u32 v191, 1280, v248
    v_max_i32 v242, v191, v192
    s_waitcnt lgkmcnt(8)
    v_mfma_f32_32x32x16_bf16 v[80:95], v[116:119], v[124:127], v[80:95]
    v_subrev_u32 v42, 80, v42
    v_max_i32 v44, v42, v43
    ds_read_b64 v[104:105], v40 offset:1600
    ds_read_b64 v[106:107], v40 offset:1608
    ds_read_b128 v[112:115], v41 offset:2000
    v_mfma_f32_32x32x16_bf16 v[64:79], v[116:119], v[120:123], v[64:79]
    ds_read_b128 v[108:111], v44 offset:0
    v_add_u32 v190, 32, v189
    v_lshrrev_b32 v191, 5, v190
    v_mul_u32_u24 v191, 80, v191
    s_waitcnt lgkmcnt(8)
    v_mfma_f32_32x32x16_bf16 v[80:95], v[128:131], v[136:139], v[80:95]
    ds_read_b64 v[116:117], v40 offset:1632
    ds_read_b64 v[118:119], v40 offset:1640
    ds_read_b128 v[124:127], v41 offset:2032
    ds_read_b128 v[120:123], v44 offset:32
    v_mfma_f32_32x32x16_bf16 v[64:79], v[128:131], v[132:135], v[64:79]
    v_and_b32 v190, 31, v190
    v_lshl_add_u32 v191, v190, 1, v191
    v_add_u32 v249, s95, v191
    s_waitcnt lgkmcnt(8)
    v_mfma_f32_32x32x16_bf16 v[80:95], v[140:143], v[148:151], v[80:95]
    v_subrev_u32 v42, 80, v42
    v_max_i32 v45, v42, v43
    ds_read_b64 v[128:129], v40 offset:1536
    ds_read_b64 v[130:131], v40 offset:1544
    ds_read_b128 v[136:139], v41 offset:1920
    v_mfma_f32_32x32x16_bf16 v[64:79], v[140:143], v[144:147], v[64:79]
    ds_read_b128 v[132:135], v45 offset:0
    v_subrev_u32 v191, 1280, v249
    v_max_i32 v243, v191, v192
    v_add_u32 v190, 48, v189
    s_waitcnt lgkmcnt(8)
    v_mfma_f32_32x32x16_bf16 v[80:95], v[104:107], v[112:115], v[80:95]
    ds_read_b64 v[140:141], v40 offset:1568
    ds_read_b64 v[142:143], v40 offset:1576
    ds_read_b128 v[148:151], v41 offset:1952
    ds_read_b128 v[144:147], v45 offset:32
    v_mfma_f32_32x32x16_bf16 v[64:79], v[104:107], v[108:111], v[64:79]
    v_lshrrev_b32 v191, 5, v190
    v_mul_u32_u24 v191, 80, v191
    v_and_b32 v190, 31, v190
    s_waitcnt lgkmcnt(8)
    v_mfma_f32_32x32x16_bf16 v[80:95], v[116:119], v[124:127], v[80:95]
    v_subrev_u32 v42, 80, v42
    v_max_i32 v46, v42, v43
    ds_read_b64 v[104:105], v40 offset:1472
    ds_read_b64 v[106:107], v40 offset:1480
    ds_read_b128 v[112:115], v41 offset:1840
    v_mfma_f32_32x32x16_bf16 v[64:79], v[116:119], v[120:123], v[64:79]
    ds_read_b128 v[108:111], v46 offset:0
    v_lshl_add_u32 v191, v190, 1, v191
    v_add_u32 v250, s95, v191
    v_subrev_u32 v191, 1280, v250
    s_waitcnt lgkmcnt(8)
    v_mfma_f32_32x32x16_bf16 v[80:95], v[128:131], v[136:139], v[80:95]
    ds_read_b64 v[116:117], v40 offset:1504
    ds_read_b64 v[118:119], v40 offset:1512
    ds_read_b128 v[124:127], v41 offset:1872
    ds_read_b128 v[120:123], v46 offset:32
    v_mfma_f32_32x32x16_bf16 v[64:79], v[128:131], v[132:135], v[64:79]
    v_max_i32 v244, v191, v192
    v_add_u32 v190, 64, v189
    v_lshrrev_b32 v191, 5, v190
    s_waitcnt lgkmcnt(8)
    v_mfma_f32_32x32x16_bf16 v[80:95], v[140:143], v[148:151], v[80:95]
    v_subrev_u32 v42, 80, v42
    v_max_i32 v47, v42, v43
    ds_read_b64 v[128:129], v40 offset:1408
    ds_read_b64 v[130:131], v40 offset:1416
    ds_read_b128 v[136:139], v41 offset:1760
    v_mfma_f32_32x32x16_bf16 v[64:79], v[140:143], v[144:147], v[64:79]
    ds_read_b128 v[132:135], v47 offset:0
    v_mul_u32_u24 v191, 80, v191
    v_and_b32 v190, 31, v190
    v_lshl_add_u32 v191, v190, 1, v191
    s_waitcnt lgkmcnt(8)
    v_mfma_f32_32x32x16_bf16 v[80:95], v[104:107], v[112:115], v[80:95]
    ds_read_b64 v[140:141], v40 offset:1440
    ds_read_b64 v[142:143], v40 offset:1448
    ds_read_b128 v[148:151], v41 offset:1792
    ds_read_b128 v[144:147], v47 offset:32
    v_mfma_f32_32x32x16_bf16 v[64:79], v[104:107], v[108:111], v[64:79]
    v_add_u32 v251, s95, v191
    v_subrev_u32 v191, 1280, v251
    v_max_i32 v245, v191, v192
    s_waitcnt lgkmcnt(8)
    v_mfma_f32_32x32x16_bf16 v[80:95], v[116:119], v[124:127], v[80:95]
    v_subrev_u32 v42, 80, v42
    v_max_i32 v44, v42, v43
    ds_read_b64 v[104:105], v40 offset:1344
    ds_read_b64 v[106:107], v40 offset:1352
    ds_read_b128 v[112:115], v41 offset:1680
    v_mfma_f32_32x32x16_bf16 v[64:79], v[116:119], v[120:123], v[64:79]
    ds_read_b128 v[108:111], v44 offset:0
    v_lshlrev_b32 v195, 3, v187
    v_mov_b32 v196, 511
    v_mov_b32 v197, 0
    s_waitcnt lgkmcnt(8)
    v_mfma_f32_32x32x16_bf16 v[80:95], v[128:131], v[136:139], v[80:95]
    ds_read_b64 v[116:117], v40 offset:1376
    ds_read_b64 v[118:119], v40 offset:1384
    ds_read_b128 v[124:127], v41 offset:1712
    ds_read_b128 v[120:123], v44 offset:32
    v_mfma_f32_32x32x16_bf16 v[64:79], v[128:131], v[132:135], v[64:79]
    v_add_u32 v190, 4, v186
    v_lshlrev_b64 v[196:197], v190, v[196:197]
    v_lshrrev_b64 v[196:197], v195, v[196:197]
    s_waitcnt lgkmcnt(8)
    v_mfma_f32_32x32x16_bf16 v[80:95], v[140:143], v[148:151], v[80:95]
    v_subrev_u32 v42, 80, v42
    v_max_i32 v45, v42, v43
    ds_read_b64 v[128:129], v40 offset:1280
    ds_read_b64 v[130:131], v40 offset:1288
    ds_read_b128 v[136:139], v41 offset:1600
    v_mfma_f32_32x32x16_bf16 v[64:79], v[140:143], v[144:147], v[64:79]
    ds_read_b128 v[132:135], v45 offset:0
    v_bfe_u32 v216, v196, 0, 2
    v_lshl_or_b32 v216, v216, 15, v216
    v_and_b32 v216, 0x00010001, v216
    s_waitcnt lgkmcnt(8)
    v_mfma_f32_32x32x16_bf16 v[80:95], v[104:107], v[112:115], v[80:95]
    ds_read_b64 v[140:141], v40 offset:1312
    ds_read_b64 v[142:143], v40 offset:1320
    ds_read_b128 v[148:151], v41 offset:1632
    ds_read_b128 v[144:147], v45 offset:32
    v_mfma_f32_32x32x16_bf16 v[64:79], v[104:107], v[108:111], v[64:79]
    v_mul_u32_u24 v216, 0x3f80, v216
    v_bfe_u32 v217, v196, 2, 2
    v_lshl_or_b32 v217, v217, 15, v217
    s_waitcnt lgkmcnt(8)
    v_mfma_f32_32x32x16_bf16 v[80:95], v[116:119], v[124:127], v[80:95]
    v_subrev_u32 v42, 80, v42
    v_max_i32 v46, v42, v43
    ds_read_b64 v[104:105], v40 offset:1216
    ds_read_b64 v[106:107], v40 offset:1224
    ds_read_b128 v[112:115], v41 offset:1520
    v_mfma_f32_32x32x16_bf16 v[64:79], v[116:119], v[120:123], v[64:79]
    ds_read_b128 v[108:111], v46 offset:0
    v_and_b32 v217, 0x00010001, v217
    v_mul_u32_u24 v217, 0x3f80, v217
    v_bfe_u32 v218, v196, 4, 2
    s_waitcnt lgkmcnt(8)
    v_mfma_f32_32x32x16_bf16 v[80:95], v[128:131], v[136:139], v[80:95]
    ds_read_b64 v[116:117], v40 offset:1248
    ds_read_b64 v[118:119], v40 offset:1256
    ds_read_b128 v[124:127], v41 offset:1552
    ds_read_b128 v[120:123], v46 offset:32
    v_mfma_f32_32x32x16_bf16 v[64:79], v[128:131], v[132:135], v[64:79]
    v_lshl_or_b32 v218, v218, 15, v218
    v_and_b32 v218, 0x00010001, v218
    v_mul_u32_u24 v218, 0x3f80, v218
    s_waitcnt lgkmcnt(8)
    v_mfma_f32_32x32x16_bf16 v[80:95], v[140:143], v[148:151], v[80:95]
    v_subrev_u32 v42, 80, v42
    v_max_i32 v47, v42, v43
    ds_read_b64 v[128:129], v40 offset:1152
    ds_read_b64 v[130:131], v40 offset:1160
    ds_read_b128 v[136:139], v41 offset:1440
    v_mfma_f32_32x32x16_bf16 v[64:79], v[140:143], v[144:147], v[64:79]
    ds_read_b128 v[132:135], v47 offset:0
    v_bfe_u32 v219, v196, 6, 2
    v_lshl_or_b32 v219, v219, 15, v219
    v_and_b32 v219, 0x00010001, v219
    s_waitcnt lgkmcnt(8)
    v_mfma_f32_32x32x16_bf16 v[80:95], v[104:107], v[112:115], v[80:95]
    ds_read_b64 v[140:141], v40 offset:1184
    ds_read_b64 v[142:143], v40 offset:1192
    ds_read_b128 v[148:151], v41 offset:1472
    ds_read_b128 v[144:147], v47 offset:32
    v_mfma_f32_32x32x16_bf16 v[64:79], v[104:107], v[108:111], v[64:79]
    v_mul_u32_u24 v219, 0x3f80, v219
    v_bfe_u32 v220, v196, 16, 2
    v_lshl_or_b32 v220, v220, 15, v220
    s_waitcnt lgkmcnt(8)
    v_mfma_f32_32x32x16_bf16 v[80:95], v[116:119], v[124:127], v[80:95]
    v_subrev_u32 v42, 80, v42
    v_max_i32 v44, v42, v43
    ds_read_b64 v[104:105], v40 offset:1088
    ds_read_b64 v[106:107], v40 offset:1096
    ds_read_b128 v[112:115], v41 offset:1360
    v_mfma_f32_32x32x16_bf16 v[64:79], v[116:119], v[120:123], v[64:79]
    ds_read_b128 v[108:111], v44 offset:0
    v_and_b32 v220, 0x00010001, v220
    v_mul_u32_u24 v220, 0x3f80, v220
    v_bfe_u32 v221, v196, 18, 2
    s_waitcnt lgkmcnt(8)
    v_mfma_f32_32x32x16_bf16 v[80:95], v[128:131], v[136:139], v[80:95]
    ds_read_b64 v[116:117], v40 offset:1120
    ds_read_b64 v[118:119], v40 offset:1128
    ds_read_b128 v[124:127], v41 offset:1392
    ds_read_b128 v[120:123], v44 offset:32
    v_mfma_f32_32x32x16_bf16 v[64:79], v[128:131], v[132:135], v[64:79]
    v_lshl_or_b32 v221, v221, 15, v221
    v_and_b32 v221, 0x00010001, v221
    v_mul_u32_u24 v221, 0x3f80, v221
    s_waitcnt lgkmcnt(8)
    v_mfma_f32_32x32x16_bf16 v[80:95], v[140:143], v[148:151], v[80:95]
    v_subrev_u32 v42, 80, v42
    v_max_i32 v45, v42, v43
    ds_read_b64 v[128:129], v40 offset:1024
    ds_read_b64 v[130:131], v40 offset:1032
    ds_read_b128 v[136:139], v41 offset:1280
    v_mfma_f32_32x32x16_bf16 v[64:79], v[140:143], v[144:147], v[64:79]
    ds_read_b128 v[132:135], v45 offset:0
    v_bfe_u32 v222, v196, 20, 2
    v_lshl_or_b32 v222, v222, 15, v222
    v_and_b32 v222, 0x00010001, v222
    s_waitcnt lgkmcnt(8)
    v_mfma_f32_32x32x16_bf16 v[80:95], v[104:107], v[112:115], v[80:95]
    ds_read_b64 v[140:141], v40 offset:1056
    ds_read_b64 v[142:143], v40 offset:1064
    ds_read_b128 v[148:151], v41 offset:1312
    ds_read_b128 v[144:147], v45 offset:32
    v_mfma_f32_32x32x16_bf16 v[64:79], v[104:107], v[108:111], v[64:79]
    v_mul_u32_u24 v222, 0x3f80, v222
    v_bfe_u32 v223, v196, 22, 2
    v_lshl_or_b32 v223, v223, 15, v223
    s_waitcnt lgkmcnt(8)
    v_mfma_f32_32x32x16_bf16 v[80:95], v[116:119], v[124:127], v[80:95]
    v_subrev_u32 v42, 80, v42
    v_max_i32 v46, v42, v43
    ds_read_b64 v[104:105], v40 offset:960
    ds_read_b64 v[106:107], v40 offset:968
    ds_read_b128 v[112:115], v41 offset:1200
    v_mfma_f32_32x32x16_bf16 v[64:79], v[116:119], v[120:123], v[64:79]
    ds_read_b128 v[108:111], v46 offset:0
    v_and_b32 v223, 0x00010001, v223
    v_mul_u32_u24 v223, 0x3f80, v223
    v_bfe_u32 v224, v197, 0, 2
    s_waitcnt lgkmcnt(8)
    v_mfma_f32_32x32x16_bf16 v[80:95], v[128:131], v[136:139], v[80:95]
    ds_read_b64 v[116:117], v40 offset:992
    ds_read_b64 v[118:119], v40 offset:1000
    ds_read_b128 v[124:127], v41 offset:1232
    ds_read_b128 v[120:123], v46 offset:32
    v_mfma_f32_32x32x16_bf16 v[64:79], v[128:131], v[132:135], v[64:79]
    v_lshl_or_b32 v224, v224, 15, v224
    v_and_b32 v224, 0x00010001, v224
    v_mul_u32_u24 v224, 0x3f80, v224
    s_waitcnt lgkmcnt(8)
    v_mfma_f32_32x32x16_bf16 v[80:95], v[140:143], v[148:151], v[80:95]
    v_subrev_u32 v42, 80, v42
    v_max_i32 v47, v42, v43
    ds_read_b64 v[128:129], v40 offset:896
    ds_read_b64 v[130:131], v40 offset:904
    ds_read_b128 v[136:139], v41 offset:1120
    v_mfma_f32_32x32x16_bf16 v[64:79], v[140:143], v[144:147], v[64:79]
    ds_read_b128 v[132:135], v47 offset:0
    v_bfe_u32 v225, v197, 2, 2
    v_lshl_or_b32 v225, v225, 15, v225
    v_and_b32 v225, 0x00010001, v225
    s_waitcnt lgkmcnt(8)
    v_mfma_f32_32x32x16_bf16 v[80:95], v[104:107], v[112:115], v[80:95]
    ds_read_b64 v[140:141], v40 offset:928
    ds_read_b64 v[142:143], v40 offset:936
    ds_read_b128 v[148:151], v41 offset:1152
    ds_read_b128 v[144:147], v47 offset:32
    v_mfma_f32_32x32x16_bf16 v[64:79], v[104:107], v[108:111], v[64:79]
    v_mul_u32_u24 v225, 0x3f80, v225
    v_bfe_u32 v226, v197, 4, 2
    v_lshl_or_b32 v226, v226, 15, v226
    s_waitcnt lgkmcnt(8)
    v_mfma_f32_32x32x16_bf16 v[80:95], v[116:119], v[124:127], v[80:95]
    v_subrev_u32 v42, 80, v42
    v_max_i32 v44, v42, v43
    ds_read_b64 v[104:105], v40 offset:832
    ds_read_b64 v[106:107], v40 offset:840
    ds_read_b128 v[112:115], v41 offset:1040
    v_mfma_f32_32x32x16_bf16 v[64:79], v[116:119], v[120:123], v[64:79]
    ds_read_b128 v[108:111], v44 offset:0
    v_and_b32 v226, 0x00010001, v226
    v_mul_u32_u24 v226, 0x3f80, v226
    v_bfe_u32 v227, v197, 6, 2
    s_waitcnt lgkmcnt(8)
    v_mfma_f32_32x32x16_bf16 v[80:95], v[128:131], v[136:139], v[80:95]
    ds_read_b64 v[116:117], v40 offset:864
    ds_read_b64 v[118:119], v40 offset:872
    ds_read_b128 v[124:127], v41 offset:1072
    ds_read_b128 v[120:123], v44 offset:32
    v_mfma_f32_32x32x16_bf16 v[64:79], v[128:131], v[132:135], v[64:79]
    v_lshl_or_b32 v227, v227, 15, v227
    v_and_b32 v227, 0x00010001, v227
    v_mul_u32_u24 v227, 0x3f80, v227
    s_waitcnt lgkmcnt(8)
    v_mfma_f32_32x32x16_bf16 v[80:95], v[140:143], v[148:151], v[80:95]
    v_subrev_u32 v42, 80, v42
    v_max_i32 v45, v42, v43
    ds_read_b64 v[128:129], v40 offset:768
    ds_read_b64 v[130:131], v40 offset:776
    ds_read_b128 v[136:139], v41 offset:960
    v_mfma_f32_32x32x16_bf16 v[64:79], v[140:143], v[144:147], v[64:79]
    ds_read_b128 v[132:135], v45 offset:0
    v_mov_b32 v196, 127
    v_mov_b32 v197, 0
    v_add_u32 v190, 5, v186
    s_waitcnt lgkmcnt(8)
    v_mfma_f32_32x32x16_bf16 v[80:95], v[104:107], v[112:115], v[80:95]
    ds_read_b64 v[140:141], v40 offset:800
    ds_read_b64 v[142:143], v40 offset:808
    ds_read_b128 v[148:151], v41 offset:992
    ds_read_b128 v[144:147], v45 offset:32
    v_mfma_f32_32x32x16_bf16 v[64:79], v[104:107], v[108:111], v[64:79]
    v_lshlrev_b64 v[196:197], v190, v[196:197]
    v_lshrrev_b64 v[196:197], v195, v[196:197]
    v_bfe_u32 v228, v196, 0, 2
    s_waitcnt lgkmcnt(8)
    v_mfma_f32_32x32x16_bf16 v[80:95], v[116:119], v[124:127], v[80:95]
    v_subrev_u32 v42, 80, v42
    v_max_i32 v46, v42, v43
    ds_read_b64 v[104:105], v40 offset:704
    ds_read_b64 v[106:107], v40 offset:712
    ds_read_b128 v[112:115], v41 offset:880
    v_mfma_f32_32x32x16_bf16 v[64:79], v[116:119], v[120:123], v[64:79]
    ds_read_b128 v[108:111], v46 offset:0
    v_lshl_or_b32 v228, v228, 15, v228
    v_and_b32 v228, 0x00010001, v228
    v_mul_u32_u24 v228, 0x3f80, v228
    s_waitcnt lgkmcnt(8)
    v_mfma_f32_32x32x16_bf16 v[80:95], v[128:131], v[136:139], v[80:95]
    ds_read_b64 v[116:117], v40 offset:736
    ds_read_b64 v[118:119], v40 offset:744
    ds_read_b128 v[124:127], v41 offset:912
    ds_read_b128 v[120:123], v46 offset:32
    v_mfma_f32_32x32x16_bf16 v[64:79], v[128:131], v[132:135], v[64:79]
    v_bfe_u32 v229, v196, 2, 2
    v_lshl_or_b32 v229, v229, 15, v229
    v_and_b32 v229, 0x00010001, v229
    s_waitcnt lgkmcnt(8)
    v_mfma_f32_32x32x16_bf16 v[80:95], v[140:143], v[148:151], v[80:95]
    v_subrev_u32 v42, 80, v42
    v_max_i32 v47, v42, v43
    ds_read_b64 v[128:129], v40 offset:640
    ds_read_b64 v[130:131], v40 offset:648
    ds_read_b128 v[136:139], v41 offset:800
    v_mfma_f32_32x32x16_bf16 v[64:79], v[140:143], v[144:147], v[64:79]
    ds_read_b128 v[132:135], v47 offset:0
    v_mul_u32_u24 v229, 0x3f80, v229
    v_bfe_u32 v230, v196, 4, 2
    v_lshl_or_b32 v230, v230, 15, v230
    s_waitcnt lgkmcnt(8)
    v_mfma_f32_32x32x16_bf16 v[80:95], v[104:107], v[112:115], v[80:95]
    ds_read_b64 v[140:141], v40 offset:672
    ds_read_b64 v[142:143], v40 offset:680
    ds_read_b128 v[148:151], v41 offset:832
    ds_read_b128 v[144:147], v47 offset:32
    v_mfma_f32_32x32x16_bf16 v[64:79], v[104:107], v[108:111], v[64:79]
    v_and_b32 v230, 0x00010001, v230
    v_mul_u32_u24 v230, 0x3f80, v230
    v_bfe_u32 v231, v196, 6, 2
    s_waitcnt lgkmcnt(8)
    v_mfma_f32_32x32x16_bf16 v[80:95], v[116:119], v[124:127], v[80:95]
    v_subrev_u32 v42, 80, v42
    v_max_i32 v44, v42, v43
    ds_read_b64 v[104:105], v40 offset:576
    ds_read_b64 v[106:107], v40 offset:584
    ds_read_b128 v[112:115], v41 offset:720
    v_mfma_f32_32x32x16_bf16 v[64:79], v[116:119], v[120:123], v[64:79]
    ds_read_b128 v[108:111], v44 offset:0
    v_lshl_or_b32 v231, v231, 15, v231
    v_and_b32 v231, 0x00010001, v231
    v_mul_u32_u24 v231, 0x3f80, v231
    s_waitcnt lgkmcnt(8)
    v_mfma_f32_32x32x16_bf16 v[80:95], v[128:131], v[136:139], v[80:95]
    ds_read_b64 v[116:117], v40 offset:608
    ds_read_b64 v[118:119], v40 offset:616
    ds_read_b128 v[124:127], v41 offset:752
    ds_read_b128 v[120:123], v44 offset:32
    v_mfma_f32_32x32x16_bf16 v[64:79], v[128:131], v[132:135], v[64:79]
    v_bfe_u32 v232, v196, 16, 2
    v_lshl_or_b32 v232, v232, 15, v232
    v_and_b32 v232, 0x00010001, v232
    s_waitcnt lgkmcnt(8)
    v_mfma_f32_32x32x16_bf16 v[80:95], v[140:143], v[148:151], v[80:95]
    v_subrev_u32 v42, 80, v42
    v_max_i32 v45, v42, v43
    ds_read_b64 v[128:129], v40 offset:512
    ds_read_b64 v[130:131], v40 offset:520
    ds_read_b128 v[136:139], v41 offset:640
    v_mfma_f32_32x32x16_bf16 v[64:79], v[140:143], v[144:147], v[64:79]
    ds_read_b128 v[132:135], v45 offset:0
    v_mul_u32_u24 v232, 0x3f80, v232
    v_bfe_u32 v233, v196, 18, 2
    v_lshl_or_b32 v233, v233, 15, v233
    s_waitcnt lgkmcnt(8)
    v_mfma_f32_32x32x16_bf16 v[80:95], v[104:107], v[112:115], v[80:95]
    ds_read_b64 v[140:141], v40 offset:544
    ds_read_b64 v[142:143], v40 offset:552
    ds_read_b128 v[148:151], v41 offset:672
    ds_read_b128 v[144:147], v45 offset:32
    v_mfma_f32_32x32x16_bf16 v[64:79], v[104:107], v[108:111], v[64:79]
    v_and_b32 v233, 0x00010001, v233
    v_mul_u32_u24 v233, 0x3f80, v233
    v_bfe_u32 v234, v196, 20, 2
    s_waitcnt lgkmcnt(8)
    v_mfma_f32_32x32x16_bf16 v[80:95], v[116:119], v[124:127], v[80:95]
    v_subrev_u32 v42, 80, v42
    v_max_i32 v46, v42, v43
    ds_read_b64 v[104:105], v40 offset:448
    ds_read_b64 v[106:107], v40 offset:456
    ds_read_b128 v[112:115], v41 offset:560
    v_mfma_f32_32x32x16_bf16 v[64:79], v[116:119], v[120:123], v[64:79]
    ds_read_b128 v[108:111], v46 offset:0
    v_lshl_or_b32 v234, v234, 15, v234
    v_and_b32 v234, 0x00010001, v234
    v_mul_u32_u24 v234, 0x3f80, v234
    s_waitcnt lgkmcnt(8)
    v_mfma_f32_32x32x16_bf16 v[80:95], v[128:131], v[136:139], v[80:95]
    ds_read_b64 v[116:117], v40 offset:480
    ds_read_b64 v[118:119], v40 offset:488
    ds_read_b128 v[124:127], v41 offset:592
    ds_read_b128 v[120:123], v46 offset:32
    v_mfma_f32_32x32x16_bf16 v[64:79], v[128:131], v[132:135], v[64:79]
    v_bfe_u32 v235, v196, 22, 2
    v_lshl_or_b32 v235, v235, 15, v235
    v_and_b32 v235, 0x00010001, v235
    s_waitcnt lgkmcnt(8)
    v_mfma_f32_32x32x16_bf16 v[80:95], v[140:143], v[148:151], v[80:95]
    v_subrev_u32 v42, 80, v42
    v_max_i32 v47, v42, v43
    ds_read_b64 v[128:129], v40 offset:384
    ds_read_b64 v[130:131], v40 offset:392
    ds_read_b128 v[136:139], v41 offset:480
    v_mfma_f32_32x32x16_bf16 v[64:79], v[140:143], v[144:147], v[64:79]
    ds_read_b128 v[132:135], v47 offset:0
    v_mul_u32_u24 v235, 0x3f80, v235
    v_bfe_u32 v236, v197, 0, 2
    v_lshl_or_b32 v236, v236, 15, v236
    s_waitcnt lgkmcnt(8)
    v_mfma_f32_32x32x16_bf16 v[80:95], v[104:107], v[112:115], v[80:95]
    ds_read_b64 v[140:141], v40 offset:416
    ds_read_b64 v[142:143], v40 offset:424
    ds_read_b128 v[148:151], v41 offset:512
    ds_read_b128 v[144:147], v47 offset:32
    v_mfma_f32_32x32x16_bf16 v[64:79], v[104:107], v[108:111], v[64:79]
    v_and_b32 v236, 0x00010001, v236
    v_mul_u32_u24 v236, 0x3f80, v236
    v_bfe_u32 v237, v197, 2, 2
    s_waitcnt lgkmcnt(8)
    v_mfma_f32_32x32x16_bf16 v[80:95], v[116:119], v[124:127], v[80:95]
    v_subrev_u32 v42, 80, v42
    v_max_i32 v44, v42, v43
    ds_read_b64 v[104:105], v40 offset:320
    ds_read_b64 v[106:107], v40 offset:328
    ds_read_b128 v[112:115], v41 offset:400
    v_mfma_f32_32x32x16_bf16 v[64:79], v[116:119], v[120:123], v[64:79]
    ds_read_b128 v[108:111], v44 offset:0
    v_lshl_or_b32 v237, v237, 15, v237
    v_and_b32 v237, 0x00010001, v237
    v_mul_u32_u24 v237, 0x3f80, v237
    s_waitcnt lgkmcnt(8)
    v_mfma_f32_32x32x16_bf16 v[80:95], v[128:131], v[136:139], v[80:95]
    ds_read_b64 v[116:117], v40 offset:352
    ds_read_b64 v[118:119], v40 offset:360
    ds_read_b128 v[124:127], v41 offset:432
    ds_read_b128 v[120:123], v44 offset:32
    v_mfma_f32_32x32x16_bf16 v[64:79], v[128:131], v[132:135], v[64:79]
    v_bfe_u32 v238, v197, 4, 2
    v_lshl_or_b32 v238, v238, 15, v238
    v_and_b32 v238, 0x00010001, v238
    s_waitcnt lgkmcnt(8)
    v_mfma_f32_32x32x16_bf16 v[80:95], v[140:143], v[148:151], v[80:95]
    v_subrev_u32 v42, 80, v42
    v_max_i32 v45, v42, v43
    ds_read_b64 v[128:129], v40 offset:256
    ds_read_b64 v[130:131], v40 offset:264
    ds_read_b128 v[136:139], v41 offset:320
    v_mfma_f32_32x32x16_bf16 v[64:79], v[140:143], v[144:147], v[64:79]
    ds_read_b128 v[132:135], v45 offset:0
    v_mul_u32_u24 v238, 0x3f80, v238
    v_bfe_u32 v239, v197, 6, 2
    v_lshl_or_b32 v239, v239, 15, v239
    s_waitcnt lgkmcnt(8)
    v_mfma_f32_32x32x16_bf16 v[80:95], v[104:107], v[112:115], v[80:95]
    ds_read_b64 v[140:141], v40 offset:288
    ds_read_b64 v[142:143], v40 offset:296
    ds_read_b128 v[148:151], v41 offset:352
    v_mfma_f32_32x32x16_bf16 v[64:79], v[104:107], v[108:111], v[64:79]
    ds_read_b128 v[144:147], v45 offset:32
    v_and_b32 v239, 0x00010001, v239
    v_mul_u32_u24 v239, 0x3f80, v239
    s_waitcnt lgkmcnt(8)
    v_mfma_f32_32x32x16_bf16 v[80:95], v[116:119], v[124:127], v[80:95]
    v_subrev_u32 v42, 80, v42
    v_max_i32 v46, v42, v43
    ds_read_b64 v[104:105], v40 offset:192
    v_mfma_f32_32x32x16_bf16 v[64:79], v[116:119], v[120:123], v[64:79]
    ds_read_b64 v[106:107], v40 offset:200
    ds_read_b128 v[112:115], v41 offset:240
    ds_read_b128 v[108:111], v46 offset:0
    s_waitcnt lgkmcnt(8)
    v_mfma_f32_32x32x16_bf16 v[80:95], v[128:131], v[136:139], v[80:95]
    ds_read_b64 v[116:117], v40 offset:224
    ds_read_b64 v[118:119], v40 offset:232
    v_mfma_f32_32x32x16_bf16 v[64:79], v[128:131], v[132:135], v[64:79]
    ds_read_b128 v[124:127], v41 offset:272
    ds_read_b128 v[120:123], v46 offset:32
    s_waitcnt lgkmcnt(8)
    v_mfma_f32_32x32x16_bf16 v[80:95], v[140:143], v[148:151], v[80:95]
    v_subrev_u32 v42, 80, v42
    v_max_i32 v47, v42, v43
    ds_read_b64 v[128:129], v40 offset:128
    v_mfma_f32_32x32x16_bf16 v[64:79], v[140:143], v[144:147], v[64:79]
    ds_read_b64 v[130:131], v40 offset:136
    ds_read_b128 v[136:139], v41 offset:160
    ds_read_b128 v[132:135], v47 offset:0
    s_waitcnt lgkmcnt(8)
    v_mfma_f32_32x32x16_bf16 v[80:95], v[104:107], v[112:115], v[80:95]
    ds_read_b64 v[140:141], v40 offset:160
    ds_read_b64 v[142:143], v40 offset:168
    v_mfma_f32_32x32x16_bf16 v[64:79], v[104:107], v[108:111], v[64:79]
    ds_read_b128 v[148:151], v41 offset:192
    ds_read_b128 v[144:147], v47 offset:32
    s_waitcnt lgkmcnt(8)
    v_mfma_f32_32x32x16_bf16 v[80:95], v[116:119], v[124:127], v[80:95]
    ds_read_b64 v[104:105], v40 offset:64
    ds_read_b64 v[106:107], v40 offset:72
    v_mfma_f32_32x32x16_bf16 v[64:79], v[116:119], v[120:123], v[64:79]
    ds_read_b128 v[112:115], v41 offset:80
    s_waitcnt lgkmcnt(7)
    v_mfma_f32_32x32x16_bf16 v[80:95], v[128:131], v[136:139], v[80:95]
    ds_read_b64 v[116:117], v40 offset:96
    ds_read_b64 v[118:119], v40 offset:104
    v_mfma_f32_32x32x16_bf16 v[64:79], v[128:131], v[132:135], v[64:79]
    ds_read_b128 v[124:127], v41 offset:112
    s_waitcnt lgkmcnt(6)
    v_mfma_f32_32x32x16_bf16 v[80:95], v[140:143], v[148:151], v[80:95]
    ds_read_b64 v[128:129], v40 offset:32
    ds_read_b64 v[130:131], v40 offset:40
    v_mfma_f32_32x32x16_bf16 v[64:79], v[140:143], v[144:147], v[64:79]
    ds_read_b128 v[136:139], v41 offset:32
    s_waitcnt lgkmcnt(6)
    v_mfma_f32_32x32x16_bf16 v[80:95], v[104:107], v[112:115], v[80:95]
    s_waitcnt lgkmcnt(3)
    v_mfma_f32_32x32x16_bf16 v[80:95], v[116:119], v[124:127], v[80:95]
    s_waitcnt lgkmcnt(0)
    v_mfma_f32_32x32x16_bf16 v[80:95], v[128:131], v[136:139], v[80:95]
    s_cmp_ge_u32 s3, 4
    s_cbranch_scc1 AFD_49
    s_setprio 0
AFD_49:
    ds_read_b128 v[104:107], v240
    ds_read_b128 v[108:111], v241
    ds_read_b128 v[112:115], v242
    ds_read_b128 v[116:119], v243
    ds_read_b128 v[120:123], v244
    ds_read_b128 v[124:127], v245
    ds_read_b128 v[128:131], v246
    ds_read_b128 v[132:135], v247
    s_waitcnt lgkmcnt(7)
    v_mfma_f32_32x32x16_bf16 v[144:159], v[104:107], v[216:219], 0
    ds_read_b128 v[104:107], v248
    s_waitcnt lgkmcnt(7)
    v_mfma_f32_32x32x16_bf16 v[144:159], v[108:111], v[220:223], v[144:159]
    ds_read_b128 v[108:111], v249
    s_waitcnt lgkmcnt(7)
    v_mfma_f32_32x32x16_bf16 v[144:159], v[112:115], v[224:227], v[144:159]
    ds_read_b128 v[112:115], v250
    s_waitcnt lgkmcnt(7)
    v_mfma_f32_32x32x16_bf16 v[160:175], v[116:119], v[228:231], 0
    ds_read_b128 v[116:119], v251
    s_waitcnt lgkmcnt(7)
    v_mfma_f32_32x32x16_bf16 v[160:175], v[120:123], v[232:235], v[160:175]
    s_waitcnt lgkmcnt(6)
    v_mfma_f32_32x32x16_bf16 v[160:175], v[124:127], v[236:239], v[160:175]
    s_waitcnt lgkmcnt(5)
    v_mfma_f32_32x32x16_bf16 v[176:191], v[128:131], v[216:219], 0
    s_waitcnt lgkmcnt(4)
    v_mfma_f32_32x32x16_bf16 v[176:191], v[132:135], v[220:223], v[176:191]
    s_waitcnt lgkmcnt(3)
    v_mfma_f32_32x32x16_bf16 v[176:191], v[104:107], v[224:227], v[176:191]
    s_waitcnt lgkmcnt(2)
    v_mfma_f32_32x32x16_bf16 v[192:207], v[108:111], v[228:231], 0
    s_waitcnt lgkmcnt(1)
    v_mfma_f32_32x32x16_bf16 v[192:207], v[112:115], v[232:235], v[192:207]
    s_waitcnt lgkmcnt(0)
    v_mfma_f32_32x32x16_bf16 v[192:207], v[116:119], v[236:239], v[192:207]
    v_cvt_pk_bf16_f32 v104, v144, v160
    v_cvt_pk_bf16_f32 v105, v145, v161
    v_cvt_pk_bf16_f32 v106, v146, v162
    v_cvt_pk_bf16_f32 v107, v147, v163
    v_cvt_pk_bf16_f32 v108, v148, v164
    v_cvt_pk_bf16_f32 v109, v149, v165
    v_cvt_pk_bf16_f32 v110, v150, v166
    v_cvt_pk_bf16_f32 v111, v151, v167
    v_cvt_pk_bf16_f32 v112, v152, v168
    v_cvt_pk_bf16_f32 v113, v153, v169
    v_cvt_pk_bf16_f32 v114, v154, v170
    v_cvt_pk_bf16_f32 v115, v155, v171
    v_cvt_pk_bf16_f32 v116, v156, v172
    v_cvt_pk_bf16_f32 v117, v157, v173
    v_cvt_pk_bf16_f32 v118, v158, v174
    v_cvt_pk_bf16_f32 v119, v159, v175
    ds_read_b64 v[144:145], v51 offset:0
    ds_read_b64 v[146:147], v51 offset:8
    ds_read_b64 v[148:149], v51 offset:32
    ds_read_b64 v[150:151], v51 offset:40
    ds_read_b64 v[152:153], v51 offset:64
    ds_read_b64 v[154:155], v51 offset:72
    ds_read_b64 v[156:157], v51 offset:96
    ds_read_b64 v[158:159], v51 offset:104
    ds_read_b64 v[160:161], v51 offset:128
    ds_read_b64 v[162:163], v51 offset:136
    ds_read_b64 v[164:165], v51 offset:160
    ds_read_b64 v[166:167], v51 offset:168
    v_cvt_pk_bf16_f32 v120, v176, v192
    v_cvt_pk_bf16_f32 v121, v177, v193
    v_cvt_pk_bf16_f32 v122, v178, v194
    v_cvt_pk_bf16_f32 v123, v179, v195
    v_cvt_pk_bf16_f32 v124, v180, v196
    v_cvt_pk_bf16_f32 v125, v181, v197
    v_cvt_pk_bf16_f32 v126, v182, v198
    v_cvt_pk_bf16_f32 v127, v183, v199
    v_cvt_pk_bf16_f32 v128, v184, v200
    v_cvt_pk_bf16_f32 v129, v185, v201
    v_cvt_pk_bf16_f32 v130, v186, v202
    v_cvt_pk_bf16_f32 v131, v187, v203
    v_cvt_pk_bf16_f32 v132, v188, v204
    v_cvt_pk_bf16_f32 v133, v189, v205
    v_cvt_pk_bf16_f32 v134, v190, v206
    v_cvt_pk_bf16_f32 v135, v191, v207
    s_waitcnt lgkmcnt(10)
    v_mfma_f32_32x32x16_bf16 v[80:95], v[104:107], v[144:147], v[80:95]
    ds_read_b64 v[168:169], v51 offset:192
    ds_read_b64 v[170:171], v51 offset:200
    ds_read_b64 v[172:173], v51 offset:224
    ds_read_b64 v[174:175], v51 offset:232
    s_waitcnt lgkmcnt(12)
    v_mfma_f32_32x32x16_bf16 v[80:95], v[108:111], v[148:151], v[80:95]
    s_waitcnt lgkmcnt(10)
    v_mfma_f32_32x32x16_bf16 v[80:95], v[112:115], v[152:155], v[80:95]
    s_waitcnt lgkmcnt(8)
    v_mfma_f32_32x32x16_bf16 v[80:95], v[116:119], v[156:159], v[80:95]
    s_waitcnt lgkmcnt(6)
    v_mfma_f32_32x32x16_bf16 v[80:95], v[120:123], v[160:163], v[80:95]
    s_waitcnt lgkmcnt(4)
    v_mfma_f32_32x32x16_bf16 v[80:95], v[124:127], v[164:167], v[80:95]
    s_waitcnt lgkmcnt(2)
    v_mfma_f32_32x32x16_bf16 v[80:95], v[128:131], v[168:171], v[80:95]
    s_waitcnt lgkmcnt(0)
    v_mfma_f32_32x32x16_bf16 v[80:95], v[132:135], v[172:175], v[80:95]
    v_and_b32 v7, 31, v1
    v_lshrrev_b32 v8, 5, v1
    v_mul_u32_u24 v9, 80, v7
    v_lshl_add_u32 v9, v8, 3, v9
    v_add_u32 v9, s32, v9
    ds_read_b64 v[104:105], v9 offset:80
    ds_read_b64 v[106:107], v9 offset:96
    ds_read_b64 v[108:109], v9 offset:112
    ds_read_b64 v[110:111], v9 offset:128
    ds_read_b64 v[112:113], v9 offset:2640
    ds_read_b64 v[114:115], v9 offset:2656
    ds_read_b64 v[116:117], v9 offset:2672
    ds_read_b64 v[118:119], v9 offset:2688
    s_add_u32 s34, s32, 5232
    v_lshlrev_b32 v10, 6, v7
    v_lshl_add_u32 v10, v8, 3, v10
    v_add_u32 v10, s34, v10
    v_lshlrev_b32 v6, 4, v1
    v_add_u32 v6, s34, v6
    s_waitcnt lgkmcnt(0)
    s_nop 7
    v_lshlrev_b32 v125, 16, v104
    v_and_b32 v126, 0xffff0000, v104
    v_cvt_pk_bf16_f32 v124, v64, v65
    v_mul_f32 v125, v125, v54
    v_mul_f32 v126, v126, v54
    v_lshlrev_b32 v127, 16, v124
    v_cvt_pk_bf16_f32 v125, v125, v126
    v_and_b32 v124, 0xffff0000, v124
    v_lshlrev_b32 v128, 16, v125
    v_and_b32 v125, 0xffff0000, v125
    v_add_f32 v127, v127, v128
    v_add_f32 v124, v124, v125
    v_cvt_pk_bf16_f32 v136, v127, v124
    v_lshlrev_b32 v131, 16, v105
    v_and_b32 v132, 0xffff0000, v105
    v_cvt_pk_bf16_f32 v130, v66, v67
    v_mul_f32 v131, v131, v54
    v_mul_f32 v132, v132, v54
    v_lshlrev_b32 v133, 16, v130
    v_cvt_pk_bf16_f32 v131, v131, v132
    v_and_b32 v130, 0xffff0000, v130
    v_lshlrev_b32 v134, 16, v131
    v_and_b32 v131, 0xffff0000, v131
    v_add_f32 v133, v133, v134
    v_add_f32 v130, v130, v131
    v_cvt_pk_bf16_f32 v137, v133, v130
    ds_write_b64 v10, v[136:137] offset:0
    v_lshlrev_b32 v125, 16, v106
    v_and_b32 v126, 0xffff0000, v106
    v_cvt_pk_bf16_f32 v124, v68, v69
    v_mul_f32 v125, v125, v54
    v_mul_f32 v126, v126, v54
    v_lshlrev_b32 v127, 16, v124
    v_cvt_pk_bf16_f32 v125, v125, v126
    v_and_b32 v124, 0xffff0000, v124
    v_lshlrev_b32 v128, 16, v125
    v_and_b32 v125, 0xffff0000, v125
    v_add_f32 v127, v127, v128
    v_add_f32 v124, v124, v125
    v_cvt_pk_bf16_f32 v138, v127, v124
    v_lshlrev_b32 v131, 16, v107
    v_and_b32 v132, 0xffff0000, v107
    v_cvt_pk_bf16_f32 v130, v70, v71
    v_mul_f32 v131, v131, v54
    v_mul_f32 v132, v132, v54
    v_lshlrev_b32 v133, 16, v130
    v_cvt_pk_bf16_f32 v131, v131, v132
    v_and_b32 v130, 0xffff0000, v130
    v_lshlrev_b32 v134, 16, v131
    v_and_b32 v131, 0xffff0000, v131
    v_add_f32 v133, v133, v134
    v_add_f32 v130, v130, v131
    v_cvt_pk_bf16_f32 v139, v133, v130
    ds_write_b64 v10, v[138:139] offset:16
    v_lshlrev_b32 v125, 16, v108
    v_and_b32 v126, 0xffff0000, v108
    v_cvt_pk_bf16_f32 v124, v72, v73
    v_mul_f32 v125, v125, v54
    v_mul_f32 v126, v126, v54
    v_lshlrev_b32 v127, 16, v124
    v_cvt_pk_bf16_f32 v125, v125, v126
    v_and_b32 v124, 0xffff0000, v124
    v_lshlrev_b32 v128, 16, v125
    v_and_b32 v125, 0xffff0000, v125
    v_add_f32 v127, v127, v128
    v_add_f32 v124, v124, v125
    v_cvt_pk_bf16_f32 v136, v127, v124
    v_lshlrev_b32 v131, 16, v109
    v_and_b32 v132, 0xffff0000, v109
    v_cvt_pk_bf16_f32 v130, v74, v75
    v_mul_f32 v131, v131, v54
    v_mul_f32 v132, v132, v54
    v_lshlrev_b32 v133, 16, v130
    v_cvt_pk_bf16_f32 v131, v131, v132
    v_and_b32 v130, 0xffff0000, v130
    v_lshlrev_b32 v134, 16, v131
    v_and_b32 v131, 0xffff0000, v131
    v_add_f32 v133, v133, v134
    v_add_f32 v130, v130, v131
    v_cvt_pk_bf16_f32 v137, v133, v130
    ds_write_b64 v10, v[136:137] offset:32
    v_lshlrev_b32 v125, 16, v110
    v_and_b32 v126, 0xffff0000, v110
    v_cvt_pk_bf16_f32 v124, v76, v77
    v_mul_f32 v125, v125, v54
    v_mul_f32 v126, v126, v54
    v_lshlrev_b32 v127, 16, v124
    v_cvt_pk_bf16_f32 v125, v125, v126
    v_and_b32 v124, 0xffff0000, v124
    v_lshlrev_b32 v128, 16, v125
    v_and_b32 v125, 0xffff0000, v125
    v_add_f32 v127, v127, v128
    v_add_f32 v124, v124, v125
    v_cvt_pk_bf16_f32 v138, v127, v124
    v_lshlrev_b32 v131, 16, v111
    v_and_b32 v132, 0xffff0000, v111
    v_cvt_pk_bf16_f32 v130, v78, v79
    v_mul_f32 v131, v131, v54
    v_mul_f32 v132, v132, v54
    v_lshlrev_b32 v133, 16, v130
    v_cvt_pk_bf16_f32 v131, v131, v132
    v_and_b32 v130, 0xffff0000, v130
    v_lshlrev_b32 v134, 16, v131
    v_and_b32 v131, 0xffff0000, v131
    v_add_f32 v133, v133, v134
    v_add_f32 v130, v130, v131
    v_cvt_pk_bf16_f32 v139, v133, v130
    ds_write_b64 v10, v[138:139] offset:48
    v_lshlrev_b32 v125, 16, v112
    v_and_b32 v126, 0xffff0000, v112
    v_cvt_pk_bf16_f32 v124, v80, v81
    v_mul_f32 v125, v125, v54
    v_mul_f32 v126, v126, v54
    v_lshlrev_b32 v127, 16, v124
    v_cvt_pk_bf16_f32 v125, v125, v126
    v_and_b32 v124, 0xffff0000, v124
    v_lshlrev_b32 v128, 16, v125
    v_and_b32 v125, 0xffff0000, v125
    v_add_f32 v127, v127, v128
    v_add_f32 v124, v124, v125
    v_cvt_pk_bf16_f32 v136, v127, v124
    v_lshlrev_b32 v131, 16, v113
    v_and_b32 v132, 0xffff0000, v113
    v_cvt_pk_bf16_f32 v130, v82, v83
    v_mul_f32 v131, v131, v54
    v_mul_f32 v132, v132, v54
    v_lshlrev_b32 v133, 16, v130
    v_cvt_pk_bf16_f32 v131, v131, v132
    v_and_b32 v130, 0xffff0000, v130
    v_lshlrev_b32 v134, 16, v131
    v_and_b32 v131, 0xffff0000, v131
    v_add_f32 v133, v133, v134
    v_add_f32 v130, v130, v131
    v_cvt_pk_bf16_f32 v137, v133, v130
    ds_write_b64 v10, v[136:137] offset:2048
    v_lshlrev_b32 v125, 16, v114
    v_and_b32 v126, 0xffff0000, v114
    v_cvt_pk_bf16_f32 v124, v84, v85
    v_mul_f32 v125, v125, v54
    v_mul_f32 v126, v126, v54
    v_lshlrev_b32 v127, 16, v124
    v_cvt_pk_bf16_f32 v125, v125, v126
    v_and_b32 v124, 0xffff0000, v124
    v_lshlrev_b32 v128, 16, v125
    v_and_b32 v125, 0xffff0000, v125
    v_add_f32 v127, v127, v128
    v_add_f32 v124, v124, v125
    v_cvt_pk_bf16_f32 v138, v127, v124
    v_lshlrev_b32 v131, 16, v115
    v_and_b32 v132, 0xffff0000, v115
    v_cvt_pk_bf16_f32 v130, v86, v87
    v_mul_f32 v131, v131, v54
    v_mul_f32 v132, v132, v54
    v_lshlrev_b32 v133, 16, v130
    v_cvt_pk_bf16_f32 v131, v131, v132
    v_and_b32 v130, 0xffff0000, v130
    v_lshlrev_b32 v134, 16, v131
    v_and_b32 v131, 0xffff0000, v131
    v_add_f32 v133, v133, v134
    v_add_f32 v130, v130, v131
    v_cvt_pk_bf16_f32 v139, v133, v130
    ds_write_b64 v10, v[138:139] offset:2064
    v_lshlrev_b32 v125, 16, v116
    v_and_b32 v126, 0xffff0000, v116
    v_cvt_pk_bf16_f32 v124, v88, v89
    v_mul_f32 v125, v125, v54
    v_mul_f32 v126, v126, v54
    v_lshlrev_b32 v127, 16, v124
    v_cvt_pk_bf16_f32 v125, v125, v126
    v_and_b32 v124, 0xffff0000, v124
    v_lshlrev_b32 v128, 16, v125
    v_and_b32 v125, 0xffff0000, v125
    v_add_f32 v127, v127, v128
    v_add_f32 v124, v124, v125
    v_cvt_pk_bf16_f32 v136, v127, v124
    v_lshlrev_b32 v131, 16, v117
    v_and_b32 v132, 0xffff0000, v117
    v_cvt_pk_bf16_f32 v130, v90, v91
    v_mul_f32 v131, v131, v54
    v_mul_f32 v132, v132, v54
    v_lshlrev_b32 v133, 16, v130
    v_cvt_pk_bf16_f32 v131, v131, v132
    v_and_b32 v130, 0xffff0000, v130
    v_lshlrev_b32 v134, 16, v131
    v_and_b32 v131, 0xffff0000, v131
    v_add_f32 v133, v133, v134
    v_add_f32 v130, v130, v131
    v_cvt_pk_bf16_f32 v137, v133, v130
    ds_write_b64 v10, v[136:137] offset:2080
    v_lshlrev_b32 v125, 16, v118
    v_and_b32 v126, 0xffff0000, v118
    v_cvt_pk_bf16_f32 v124, v92, v93
    v_mul_f32 v125, v125, v54
    v_mul_f32 v126, v126, v54
    v_lshlrev_b32 v127, 16, v124
    v_cvt_pk_bf16_f32 v125, v125, v126
    v_and_b32 v124, 0xffff0000, v124
    v_lshlrev_b32 v128, 16, v125
    v_and_b32 v125, 0xffff0000, v125
    v_add_f32 v127, v127, v128
    v_add_f32 v124, v124, v125
    v_cvt_pk_bf16_f32 v138, v127, v124
    v_lshlrev_b32 v131, 16, v119
    v_and_b32 v132, 0xffff0000, v119
    v_cvt_pk_bf16_f32 v130, v94, v95
    v_mul_f32 v131, v131, v54
    v_mul_f32 v132, v132, v54
    v_lshlrev_b32 v133, 16, v130
    v_cvt_pk_bf16_f32 v131, v131, v132
    v_and_b32 v130, 0xffff0000, v130
    v_lshlrev_b32 v134, 16, v131
    v_and_b32 v131, 0xffff0000, v131
    v_add_f32 v133, v133, v134
    v_add_f32 v130, v130, v131
    v_cvt_pk_bf16_f32 v139, v133, v130
    ds_write_b64 v10, v[138:139] offset:2096
    s_waitcnt lgkmcnt(0)
    ds_read_b128 v[104:107], v6 offset:0
    ds_read_b128 v[108:111], v6 offset:1024
    ds_read_b128 v[112:115], v6 offset:2048
    ds_read_b128 v[116:119], v6 offset:3072
    v_lshlrev_b32 v7, 4, v1
    s_lshl_b32 s33, s31, 12
    s_add_u32 s33, s33, 6291456
    s_waitcnt lgkmcnt(3)
    buffer_store_dwordx4 v[104:107], v7, s[8:11], s33 offen offset:0 sc1
    s_waitcnt lgkmcnt(2)
    buffer_store_dwordx4 v[108:111], v7, s[8:11], s33 offen offset:1024 sc1
    s_waitcnt lgkmcnt(1)
    buffer_store_dwordx4 v[112:115], v7, s[8:11], s33 offen offset:2048 sc1
    s_waitcnt lgkmcnt(0)
    buffer_store_dwordx4 v[116:119], v7, s[8:11], s33 offen offset:3072 sc1
    v_mov_b32 v5, 0
    s_waitcnt vmcnt(0)
    v_readfirstlane_b32 s28, v52
    v_readfirstlane_b32 s29, v53
    s_nop 0
    s_cmp_lg_u32 s28, 0
    s_cbranch_scc1 CNOK_50
    s_mov_b32 s82, 100000
GN_51:
    buffer_load_dwordx2 v[2:3], v5, s[24:27], 0 offen sc1
    s_waitcnt vmcnt(0)
    v_readfirstlane_b32 s28, v2
    v_readfirstlane_b32 s29, v3
    s_nop 0
    s_cmp_lg_u32 s28, 0
    s_cbranch_scc1 GNOK_52
    s_sub_u32 s82, s82, 1
    s_cbranch_scc1 L_END
    s_branch GN_51
GNOK_52:
CNOK_50:
    s_setprio 0
    s_barrier
    s_cmp_lg_u32 s3, 0
    s_cbranch_scc1 CNF_53
    s_lshr_b32 s33, s30, 3
    s_lshl_b32 s33, s33, 7
    s_and_b32 s34, s30, 7
    s_lshl_b32 s34, s34, 3
    s_add_u32 s33, s33, s34
    s_add_u32 s33, s33, 266240
    v_mov_b32 v6, s28
    v_mov_b32 v7, s29
    s_mov_b64 exec, 1
    buffer_store_dwordx2 v[6:7], v5, s[8:11], s33 offen sc1
    s_mov_b64 exec, -1
CNF_53:
    s_branch L_END
L_GATE:
    s_waitcnt lgkmcnt(0)
    s_mov_b32 s4, s36
    s_and_b32 s5, s37, 0xffff
    s_mov_b32 s6, 2621440
    s_mov_b32 s7, 0x00020000
    s_mov_b32 s8, s74
    s_and_b32 s9, s75, 0xffff
    s_mov_b32 s10, 12582912
    s_mov_b32 s11, 0x00020000
    s_mov_b32 s24, s72
    s_and_b32 s25, s73, 0xffff
    s_mov_b32 s26, 256
    s_mov_b32 s27, 0x00020000
    s_lshl_b32 s30, s30, 1
    s_sub_u32 s31, s31, 30
    s_add_u32 s30, s30, s31
    s_mov_b32 s12, s68
    s_and_b32 s13, s69, 0xffff
    s_mov_b32 s14, 1280
    s_mov_b32 s15, 0x00020000
    v_lshrrev_b32 v2, 4, v1
    v_and_b32 v3, 15, v1
    v_lshlrev_b32 v3, 4, v3
    buffer_load_dwordx4 v[16:19], v3, s[12:15], 0 offen offset:0
    buffer_load_dwordx4 v[20:23], v3, s[12:15], 0 offen offset:256
    buffer_load_dwordx4 v[24:27], v3, s[12:15], 0 offen offset:512
    buffer_load_dwordx4 v[28:31], v3, s[12:15], 0 offen offset:768
    buffer_load_dwordx4 v[32:35], v3, s[12:15], 0 offen offset:1024
    v_mul_u32_u24 v4, 1280, v2
    v_add_u32 v4, v4, v3
    s_lshl_b32 s32, s30, 7
    s_lshl_b32 s33, s3, 4
    s_add_u32 s32, s32, s33
    s_mul_i32 s33, s32, 1280
    s_add_u32 s34, s33, 0
    buffer_load_dwordx4 v[40:43], v4, s[4:7], s34 offen offset:0
    buffer_load_dwordx4 v[44:47], v4, s[4:7], s34 offen offset:256
    buffer_load_dwordx4 v[48:51], v4, s[4:7], s34 offen offset:512
    buffer_load_dwordx4 v[52:55], v4, s[4:7], s34 offen offset:768
    buffer_load_dwordx4 v[56:59], v4, s[4:7], s34 offen offset:1024
    s_add_u32 s34, s33, 5120
    buffer_load_dwordx4 v[60:63], v4, s[4:7], s34 offen offset:0
    buffer_load_dwordx4 v[64:67], v4, s[4:7], s34 offen offset:256
    buffer_load_dwordx4 v[68:71], v4, s[4:7], s34 offen offset:512
    buffer_load_dwordx4 v[72:75], v4, s[4:7], s34 offen offset:768
    buffer_load_dwordx4 v[76:79], v4, s[4:7], s34 offen offset:1024
    s_add_u32 s34, s33, 10240
    buffer_load_dwordx4 v[80:83], v4, s[4:7], s34 offen offset:0
    buffer_load_dwordx4 v[84:87], v4, s[4:7], s34 offen offset:256
    buffer_load_dwordx4 v[88:91], v4, s[4:7], s34 offen offset:512
    buffer_load_dwordx4 v[92:95], v4, s[4:7], s34 offen offset:768
    buffer_load_dwordx4 v[96:99], v4, s[4:7], s34 offen offset:1024
    s_add_u32 s34, s33, 15360
    buffer_load_dwordx4 v[100:103], v4, s[4:7], s34 offen offset:0
    buffer_load_dwordx4 v[104:107], v4, s[4:7], s34 offen offset:256
    buffer_load_dwordx4 v[108:111], v4, s[4:7], s34 offen offset:512
    buffer_load_dwordx4 v[112:115], v4, s[4:7], s34 offen offset:768
    buffer_load_dwordx4 v[116:119], v4, s[4:7], s34 offen offset:1024
    s_waitcnt vmcnt(20)
    v_lshlrev_b32 v128, 16, v16
    v_and_b32 v129, 0xffff0000, v16
    v_lshlrev_b32 v130, 16, v17
    v_and_b32 v131, 0xffff0000, v17
    v_lshlrev_b32 v132, 16, v18
    v_and_b32 v133, 0xffff0000, v18
    v_lshlrev_b32 v134, 16, v19
    v_and_b32 v135, 0xffff0000, v19
    v_lshlrev_b32 v136, 16, v20
    v_and_b32 v137, 0xffff0000, v20
    v_lshlrev_b32 v138, 16, v21
    v_and_b32 v139, 0xffff0000, v21
    v_lshlrev_b32 v140, 16, v22
    v_and_b32 v141, 0xffff0000, v22
    v_lshlrev_b32 v142, 16, v23
    v_and_b32 v143, 0xffff0000, v23
    v_lshlrev_b32 v144, 16, v24
    v_and_b32 v145, 0xffff0000, v24
    v_lshlrev_b32 v146, 16, v25
    v_and_b32 v147, 0xffff0000, v25
    v_lshlrev_b32 v148, 16, v26
    v_and_b32 v149, 0xffff0000, v26
    v_lshlrev_b32 v150, 16, v27
    v_and_b32 v151, 0xffff0000, v27
    v_lshlrev_b32 v152, 16, v28
    v_and_b32 v153, 0xffff0000, v28
    v_lshlrev_b32 v154, 16, v29
    v_and_b32 v155, 0xffff0000, v29
    v_lshlrev_b32 v156, 16, v30
    v_and_b32 v157, 0xffff0000, v30
    v_lshlrev_b32 v158, 16, v31
    v_and_b32 v159, 0xffff0000, v31
    v_lshlrev_b32 v160, 16, v32
    v_and_b32 v161, 0xffff0000, v32
    v_lshlrev_b32 v162, 16, v33
    v_and_b32 v163, 0xffff0000, v33
    v_lshlrev_b32 v164, 16, v34
    v_and_b32 v165, 0xffff0000, v34
    v_lshlrev_b32 v166, 16, v35
    v_and_b32 v167, 0xffff0000, v35
    s_waitcnt vmcnt(15)
    v_mov_b32 v180, 0
    v_mov_b32 v181, 0
    v_lshlrev_b32 v184, 16, v40
    v_and_b32 v185, 0xffff0000, v40
    v_mul_f32 v184, v184, v128
    v_mul_f32 v185, v185, v129
    v_cvt_pk_bf16_f32 v184, v184, v185
    v_and_b32 v185, 0xffff0000, v184
    v_lshlrev_b32 v184, 16, v184
    v_add_f32 v180, v180, v184
    v_add_f32 v181, v181, v185
    v_lshlrev_b32 v186, 16, v41
    v_and_b32 v187, 0xffff0000, v41
    v_mul_f32 v186, v186, v130
    v_mul_f32 v187, v187, v131
    v_cvt_pk_bf16_f32 v186, v186, v187
    v_and_b32 v187, 0xffff0000, v186
    v_lshlrev_b32 v186, 16, v186
    v_add_f32 v180, v180, v186
    v_add_f32 v181, v181, v187
    v_lshlrev_b32 v184, 16, v42
    v_and_b32 v185, 0xffff0000, v42
    v_mul_f32 v184, v184, v132
    v_mul_f32 v185, v185, v133
    v_cvt_pk_bf16_f32 v184, v184, v185
    v_and_b32 v185, 0xffff0000, v184
    v_lshlrev_b32 v184, 16, v184
    v_add_f32 v180, v180, v184
    v_add_f32 v181, v181, v185
    v_lshlrev_b32 v186, 16, v43
    v_and_b32 v187, 0xffff0000, v43
    v_mul_f32 v186, v186, v134
    v_mul_f32 v187, v187, v135
    v_cvt_pk_bf16_f32 v186, v186, v187
    v_and_b32 v187, 0xffff0000, v186
    v_lshlrev_b32 v186, 16, v186
    v_add_f32 v180, v180, v186
    v_add_f32 v181, v181, v187
    v_lshlrev_b32 v184, 16, v44
    v_and_b32 v185, 0xffff0000, v44
    v_mul_f32 v184, v184, v136
    v_mul_f32 v185, v185, v137
    v_cvt_pk_bf16_f32 v184, v184, v185
    v_and_b32 v185, 0xffff0000, v184
    v_lshlrev_b32 v184, 16, v184
    v_add_f32 v180, v180, v184
    v_add_f32 v181, v181, v185
    v_lshlrev_b32 v186, 16, v45
    v_and_b32 v187, 0xffff0000, v45
    v_mul_f32 v186, v186, v138
    v_mul_f32 v187, v187, v139
    v_cvt_pk_bf16_f32 v186, v186, v187
    v_and_b32 v187, 0xffff0000, v186
    v_lshlrev_b32 v186, 16, v186
    v_add_f32 v180, v180, v186
    v_add_f32 v181, v181, v187
    v_lshlrev_b32 v184, 16, v46
    v_and_b32 v185, 0xffff0000, v46
    v_mul_f32 v184, v184, v140
    v_mul_f32 v185, v185, v141
    v_cvt_pk_bf16_f32 v184, v184, v185
    v_and_b32 v185, 0xffff0000, v184
    v_lshlrev_b32 v184, 16, v184
    v_add_f32 v180, v180, v184
    v_add_f32 v181, v181, v185
    v_lshlrev_b32 v186, 16, v47
    v_and_b32 v187, 0xffff0000, v47
    v_mul_f32 v186, v186, v142
    v_mul_f32 v187, v187, v143
    v_cvt_pk_bf16_f32 v186, v186, v187
    v_and_b32 v187, 0xffff0000, v186
    v_lshlrev_b32 v186, 16, v186
    v_add_f32 v180, v180, v186
    v_add_f32 v181, v181, v187
    v_lshlrev_b32 v184, 16, v48
    v_and_b32 v185, 0xffff0000, v48
    v_mul_f32 v184, v184, v144
    v_mul_f32 v185, v185, v145
    v_cvt_pk_bf16_f32 v184, v184, v185
    v_and_b32 v185, 0xffff0000, v184
    v_lshlrev_b32 v184, 16, v184
    v_add_f32 v180, v180, v184
    v_add_f32 v181, v181, v185
    v_lshlrev_b32 v186, 16, v49
    v_and_b32 v187, 0xffff0000, v49
    v_mul_f32 v186, v186, v146
    v_mul_f32 v187, v187, v147
    v_cvt_pk_bf16_f32 v186, v186, v187
    v_and_b32 v187, 0xffff0000, v186
    v_lshlrev_b32 v186, 16, v186
    v_add_f32 v180, v180, v186
    v_add_f32 v181, v181, v187
    v_lshlrev_b32 v184, 16, v50
    v_and_b32 v185, 0xffff0000, v50
    v_mul_f32 v184, v184, v148
    v_mul_f32 v185, v185, v149
    v_cvt_pk_bf16_f32 v184, v184, v185
    v_and_b32 v185, 0xffff0000, v184
    v_lshlrev_b32 v184, 16, v184
    v_add_f32 v180, v180, v184
    v_add_f32 v181, v181, v185
    v_lshlrev_b32 v186, 16, v51
    v_and_b32 v187, 0xffff0000, v51
    v_mul_f32 v186, v186, v150
    v_mul_f32 v187, v187, v151
    v_cvt_pk_bf16_f32 v186, v186, v187
    v_and_b32 v187, 0xffff0000, v186
    v_lshlrev_b32 v186, 16, v186
    v_add_f32 v180, v180, v186
    v_add_f32 v181, v181, v187
    v_lshlrev_b32 v184, 16, v52
    v_and_b32 v185, 0xffff0000, v52
    v_mul_f32 v184, v184, v152
    v_mul_f32 v185, v185, v153
    v_cvt_pk_bf16_f32 v184, v184, v185
    v_and_b32 v185, 0xffff0000, v184
    v_lshlrev_b32 v184, 16, v184
    v_add_f32 v180, v180, v184
    v_add_f32 v181, v181, v185
    v_lshlrev_b32 v186, 16, v53
    v_and_b32 v187, 0xffff0000, v53
    v_mul_f32 v186, v186, v154
    v_mul_f32 v187, v187, v155
    v_cvt_pk_bf16_f32 v186, v186, v187
    v_and_b32 v187, 0xffff0000, v186
    v_lshlrev_b32 v186, 16, v186
    v_add_f32 v180, v180, v186
    v_add_f32 v181, v181, v187
    v_lshlrev_b32 v184, 16, v54
    v_and_b32 v185, 0xffff0000, v54
    v_mul_f32 v184, v184, v156
    v_mul_f32 v185, v185, v157
    v_cvt_pk_bf16_f32 v184, v184, v185
    v_and_b32 v185, 0xffff0000, v184
    v_lshlrev_b32 v184, 16, v184
    v_add_f32 v180, v180, v184
    v_add_f32 v181, v181, v185
    v_lshlrev_b32 v186, 16, v55
    v_and_b32 v187, 0xffff0000, v55
    v_mul_f32 v186, v186, v158
    v_mul_f32 v187, v187, v159
    v_cvt_pk_bf16_f32 v186, v186, v187
    v_and_b32 v187, 0xffff0000, v186
    v_lshlrev_b32 v186, 16, v186
    v_add_f32 v180, v180, v186
    v_add_f32 v181, v181, v187
    v_lshlrev_b32 v184, 16, v56
    v_and_b32 v185, 0xffff0000, v56
    v_mul_f32 v184, v184, v160
    v_mul_f32 v185, v185, v161
    v_cvt_pk_bf16_f32 v184, v184, v185
    v_and_b32 v185, 0xffff0000, v184
    v_lshlrev_b32 v184, 16, v184
    v_add_f32 v180, v180, v184
    v_add_f32 v181, v181, v185
    v_lshlrev_b32 v186, 16, v57
    v_and_b32 v187, 0xffff0000, v57
    v_mul_f32 v186, v186, v162
    v_mul_f32 v187, v187, v163
    v_cvt_pk_bf16_f32 v186, v186, v187
    v_and_b32 v187, 0xffff0000, v186
    v_lshlrev_b32 v186, 16, v186
    v_add_f32 v180, v180, v186
    v_add_f32 v181, v181, v187
    v_lshlrev_b32 v184, 16, v58
    v_and_b32 v185, 0xffff0000, v58
    v_mul_f32 v184, v184, v164
    v_mul_f32 v185, v185, v165
    v_cvt_pk_bf16_f32 v184, v184, v185
    v_and_b32 v185, 0xffff0000, v184
    v_lshlrev_b32 v184, 16, v184
    v_add_f32 v180, v180, v184
    v_add_f32 v181, v181, v185
    v_lshlrev_b32 v186, 16, v59
    v_and_b32 v187, 0xffff0000, v59
    v_mul_f32 v186, v186, v166
    v_mul_f32 v187, v187, v167
    v_cvt_pk_bf16_f32 v186, v186, v187
    v_and_b32 v187, 0xffff0000, v186
    v_lshlrev_b32 v186, 16, v186
    v_add_f32 v180, v180, v186
    v_add_f32 v181, v181, v187
    v_add_f32 v180, v180, v181
    s_nop 1
    v_add_f32_dpp v180, v180, v180 row_ror:8 row_mask:0xf bank_mask:0xf
    s_nop 1
    v_add_f32_dpp v180, v180, v180 row_ror:4 row_mask:0xf bank_mask:0xf
    s_nop 1
    v_add_f32_dpp v180, v180, v180 row_ror:2 row_mask:0xf bank_mask:0xf
    s_nop 1
    v_add_f32_dpp v180, v180, v180 row_ror:1 row_mask:0xf bank_mask:0xf
    v_cvt_pk_bf16_f32 v180, v180, v180
    v_and_b32 v180, 0xffff0000, v180
    v_mul_f32 v181, 0xbfb8aa3b, v180
    v_exp_f32 v181, v181
    s_nop 0
    v_add_f32 v181, 1.0, v181
    v_rcp_f32 v182, v181
    s_nop 0
    v_fma_f32 v183, -v181, v182, 2.0
    v_mul_f32 v182, v182, v183
    v_cvt_pk_bf16_f32 v170, v182, v182
    v_and_b32 v170, 0xffff0000, v170
    v_sub_f32 v183, 1.0, v170
    v_cvt_pk_bf16_f32 v171, v183, v183
    v_and_b32 v171, 0xffff0000, v171
    s_waitcnt vmcnt(10)
    v_mov_b32 v180, 0
    v_mov_b32 v181, 0
    v_lshlrev_b32 v184, 16, v60
    v_and_b32 v185, 0xffff0000, v60
    v_mul_f32 v184, v184, v128
    v_mul_f32 v185, v185, v129
    v_cvt_pk_bf16_f32 v184, v184, v185
    v_and_b32 v185, 0xffff0000, v184
    v_lshlrev_b32 v184, 16, v184
    v_add_f32 v180, v180, v184
    v_add_f32 v181, v181, v185
    v_lshlrev_b32 v186, 16, v61
    v_and_b32 v187, 0xffff0000, v61
    v_mul_f32 v186, v186, v130
    v_mul_f32 v187, v187, v131
    v_cvt_pk_bf16_f32 v186, v186, v187
    v_and_b32 v187, 0xffff0000, v186
    v_lshlrev_b32 v186, 16, v186
    v_add_f32 v180, v180, v186
    v_add_f32 v181, v181, v187
    v_lshlrev_b32 v184, 16, v62
    v_and_b32 v185, 0xffff0000, v62
    v_mul_f32 v184, v184, v132
    v_mul_f32 v185, v185, v133
    v_cvt_pk_bf16_f32 v184, v184, v185
    v_and_b32 v185, 0xffff0000, v184
    v_lshlrev_b32 v184, 16, v184
    v_add_f32 v180, v180, v184
    v_add_f32 v181, v181, v185
    v_lshlrev_b32 v186, 16, v63
    v_and_b32 v187, 0xffff0000, v63
    v_mul_f32 v186, v186, v134
    v_mul_f32 v187, v187, v135
    v_cvt_pk_bf16_f32 v186, v186, v187
    v_and_b32 v187, 0xffff0000, v186
    v_lshlrev_b32 v186, 16, v186
    v_add_f32 v180, v180, v186
    v_add_f32 v181, v181, v187
    v_lshlrev_b32 v184, 16, v64
    v_and_b32 v185, 0xffff0000, v64
    v_mul_f32 v184, v184, v136
    v_mul_f32 v185, v185, v137
    v_cvt_pk_bf16_f32 v184, v184, v185
    v_and_b32 v185, 0xffff0000, v184
    v_lshlrev_b32 v184, 16, v184
    v_add_f32 v180, v180, v184
    v_add_f32 v181, v181, v185
    v_lshlrev_b32 v186, 16, v65
    v_and_b32 v187, 0xffff0000, v65
    v_mul_f32 v186, v186, v138
    v_mul_f32 v187, v187, v139
    v_cvt_pk_bf16_f32 v186, v186, v187
    v_and_b32 v187, 0xffff0000, v186
    v_lshlrev_b32 v186, 16, v186
    v_add_f32 v180, v180, v186
    v_add_f32 v181, v181, v187
    v_lshlrev_b32 v184, 16, v66
    v_and_b32 v185, 0xffff0000, v66
    v_mul_f32 v184, v184, v140
    v_mul_f32 v185, v185, v141
    v_cvt_pk_bf16_f32 v184, v184, v185
    v_and_b32 v185, 0xffff0000, v184
    v_lshlrev_b32 v184, 16, v184
    v_add_f32 v180, v180, v184
    v_add_f32 v181, v181, v185
    v_lshlrev_b32 v186, 16, v67
    v_and_b32 v187, 0xffff0000, v67
    v_mul_f32 v186, v186, v142
    v_mul_f32 v187, v187, v143
    v_cvt_pk_bf16_f32 v186, v186, v187
    v_and_b32 v187, 0xffff0000, v186
    v_lshlrev_b32 v186, 16, v186
    v_add_f32 v180, v180, v186
    v_add_f32 v181, v181, v187
    v_lshlrev_b32 v184, 16, v68
    v_and_b32 v185, 0xffff0000, v68
    v_mul_f32 v184, v184, v144
    v_mul_f32 v185, v185, v145
    v_cvt_pk_bf16_f32 v184, v184, v185
    v_and_b32 v185, 0xffff0000, v184
    v_lshlrev_b32 v184, 16, v184
    v_add_f32 v180, v180, v184
    v_add_f32 v181, v181, v185
    v_lshlrev_b32 v186, 16, v69
    v_and_b32 v187, 0xffff0000, v69
    v_mul_f32 v186, v186, v146
    v_mul_f32 v187, v187, v147
    v_cvt_pk_bf16_f32 v186, v186, v187
    v_and_b32 v187, 0xffff0000, v186
    v_lshlrev_b32 v186, 16, v186
    v_add_f32 v180, v180, v186
    v_add_f32 v181, v181, v187
    v_lshlrev_b32 v184, 16, v70
    v_and_b32 v185, 0xffff0000, v70
    v_mul_f32 v184, v184, v148
    v_mul_f32 v185, v185, v149
    v_cvt_pk_bf16_f32 v184, v184, v185
    v_and_b32 v185, 0xffff0000, v184
    v_lshlrev_b32 v184, 16, v184
    v_add_f32 v180, v180, v184
    v_add_f32 v181, v181, v185
    v_lshlrev_b32 v186, 16, v71
    v_and_b32 v187, 0xffff0000, v71
    v_mul_f32 v186, v186, v150
    v_mul_f32 v187, v187, v151
    v_cvt_pk_bf16_f32 v186, v186, v187
    v_and_b32 v187, 0xffff0000, v186
    v_lshlrev_b32 v186, 16, v186
    v_add_f32 v180, v180, v186
    v_add_f32 v181, v181, v187
    v_lshlrev_b32 v184, 16, v72
    v_and_b32 v185, 0xffff0000, v72
    v_mul_f32 v184, v184, v152
    v_mul_f32 v185, v185, v153
    v_cvt_pk_bf16_f32 v184, v184, v185
    v_and_b32 v185, 0xffff0000, v184
    v_lshlrev_b32 v184, 16, v184
    v_add_f32 v180, v180, v184
    v_add_f32 v181, v181, v185
    v_lshlrev_b32 v186, 16, v73
    v_and_b32 v187, 0xffff0000, v73
    v_mul_f32 v186, v186, v154
    v_mul_f32 v187, v187, v155
    v_cvt_pk_bf16_f32 v186, v186, v187
    v_and_b32 v187, 0xffff0000, v186
    v_lshlrev_b32 v186, 16, v186
    v_add_f32 v180, v180, v186
    v_add_f32 v181, v181, v187
    v_lshlrev_b32 v184, 16, v74
    v_and_b32 v185, 0xffff0000, v74
    v_mul_f32 v184, v184, v156
    v_mul_f32 v185, v185, v157
    v_cvt_pk_bf16_f32 v184, v184, v185
    v_and_b32 v185, 0xffff0000, v184
    v_lshlrev_b32 v184, 16, v184
    v_add_f32 v180, v180, v184
    v_add_f32 v181, v181, v185
    v_lshlrev_b32 v186, 16, v75
    v_and_b32 v187, 0xffff0000, v75
    v_mul_f32 v186, v186, v158
    v_mul_f32 v187, v187, v159
    v_cvt_pk_bf16_f32 v186, v186, v187
    v_and_b32 v187, 0xffff0000, v186
    v_lshlrev_b32 v186, 16, v186
    v_add_f32 v180, v180, v186
    v_add_f32 v181, v181, v187
    v_lshlrev_b32 v184, 16, v76
    v_and_b32 v185, 0xffff0000, v76
    v_mul_f32 v184, v184, v160
    v_mul_f32 v185, v185, v161
    v_cvt_pk_bf16_f32 v184, v184, v185
    v_and_b32 v185, 0xffff0000, v184
    v_lshlrev_b32 v184, 16, v184
    v_add_f32 v180, v180, v184
    v_add_f32 v181, v181, v185
    v_lshlrev_b32 v186, 16, v77
    v_and_b32 v187, 0xffff0000, v77
    v_mul_f32 v186, v186, v162
    v_mul_f32 v187, v187, v163
    v_cvt_pk_bf16_f32 v186, v186, v187
    v_and_b32 v187, 0xffff0000, v186
    v_lshlrev_b32 v186, 16, v186
    v_add_f32 v180, v180, v186
    v_add_f32 v181, v181, v187
    v_lshlrev_b32 v184, 16, v78
    v_and_b32 v185, 0xffff0000, v78
    v_mul_f32 v184, v184, v164
    v_mul_f32 v185, v185, v165
    v_cvt_pk_bf16_f32 v184, v184, v185
    v_and_b32 v185, 0xffff0000, v184
    v_lshlrev_b32 v184, 16, v184
    v_add_f32 v180, v180, v184
    v_add_f32 v181, v181, v185
    v_lshlrev_b32 v186, 16, v79
    v_and_b32 v187, 0xffff0000, v79
    v_mul_f32 v186, v186, v166
    v_mul_f32 v187, v187, v167
    v_cvt_pk_bf16_f32 v186, v186, v187
    v_and_b32 v187, 0xffff0000, v186
    v_lshlrev_b32 v186, 16, v186
    v_add_f32 v180, v180, v186
    v_add_f32 v181, v181, v187
    v_add_f32 v180, v180, v181
    s_nop 1
    v_add_f32_dpp v180, v180, v180 row_ror:8 row_mask:0xf bank_mask:0xf
    s_nop 1
    v_add_f32_dpp v180, v180, v180 row_ror:4 row_mask:0xf bank_mask:0xf
    s_nop 1
    v_add_f32_dpp v180, v180, v180 row_ror:2 row_mask:0xf bank_mask:0xf
    s_nop 1
    v_add_f32_dpp v180, v180, v180 row_ror:1 row_mask:0xf bank_mask:0xf
    v_cvt_pk_bf16_f32 v180, v180, v180
    v_and_b32 v180, 0xffff0000, v180
    v_mul_f32 v181, 0xbfb8aa3b, v180
    v_exp_f32 v181, v181
    s_nop 0
    v_add_f32 v181, 1.0, v181
    v_rcp_f32 v182, v181
    s_nop 0
    v_fma_f32 v183, -v181, v182, 2.0
    v_mul_f32 v182, v182, v183
    v_cvt_pk_bf16_f32 v172, v182, v182
    v_and_b32 v172, 0xffff0000, v172
    v_sub_f32 v183, 1.0, v172
    v_cvt_pk_bf16_f32 v173, v183, v183
    v_and_b32 v173, 0xffff0000, v173
    s_waitcnt vmcnt(5)
    v_mov_b32 v180, 0
    v_mov_b32 v181, 0
    v_lshlrev_b32 v184, 16, v80
    v_and_b32 v185, 0xffff0000, v80
    v_mul_f32 v184, v184, v128
    v_mul_f32 v185, v185, v129
    v_cvt_pk_bf16_f32 v184, v184, v185
    v_and_b32 v185, 0xffff0000, v184
    v_lshlrev_b32 v184, 16, v184
    v_add_f32 v180, v180, v184
    v_add_f32 v181, v181, v185
    v_lshlrev_b32 v186, 16, v81
    v_and_b32 v187, 0xffff0000, v81
    v_mul_f32 v186, v186, v130
    v_mul_f32 v187, v187, v131
    v_cvt_pk_bf16_f32 v186, v186, v187
    v_and_b32 v187, 0xffff0000, v186
    v_lshlrev_b32 v186, 16, v186
    v_add_f32 v180, v180, v186
    v_add_f32 v181, v181, v187
    v_lshlrev_b32 v184, 16, v82
    v_and_b32 v185, 0xffff0000, v82
    v_mul_f32 v184, v184, v132
    v_mul_f32 v185, v185, v133
    v_cvt_pk_bf16_f32 v184, v184, v185
    v_and_b32 v185, 0xffff0000, v184
    v_lshlrev_b32 v184, 16, v184
    v_add_f32 v180, v180, v184
    v_add_f32 v181, v181, v185
    v_lshlrev_b32 v186, 16, v83
    v_and_b32 v187, 0xffff0000, v83
    v_mul_f32 v186, v186, v134
    v_mul_f32 v187, v187, v135
    v_cvt_pk_bf16_f32 v186, v186, v187
    v_and_b32 v187, 0xffff0000, v186
    v_lshlrev_b32 v186, 16, v186
    v_add_f32 v180, v180, v186
    v_add_f32 v181, v181, v187
    v_lshlrev_b32 v184, 16, v84
    v_and_b32 v185, 0xffff0000, v84
    v_mul_f32 v184, v184, v136
    v_mul_f32 v185, v185, v137
    v_cvt_pk_bf16_f32 v184, v184, v185
    v_and_b32 v185, 0xffff0000, v184
    v_lshlrev_b32 v184, 16, v184
    v_add_f32 v180, v180, v184
    v_add_f32 v181, v181, v185
    v_lshlrev_b32 v186, 16, v85
    v_and_b32 v187, 0xffff0000, v85
    v_mul_f32 v186, v186, v138
    v_mul_f32 v187, v187, v139
    v_cvt_pk_bf16_f32 v186, v186, v187
    v_and_b32 v187, 0xffff0000, v186
    v_lshlrev_b32 v186, 16, v186
    v_add_f32 v180, v180, v186
    v_add_f32 v181, v181, v187
    v_lshlrev_b32 v184, 16, v86
    v_and_b32 v185, 0xffff0000, v86
    v_mul_f32 v184, v184, v140
    v_mul_f32 v185, v185, v141
    v_cvt_pk_bf16_f32 v184, v184, v185
    v_and_b32 v185, 0xffff0000, v184
    v_lshlrev_b32 v184, 16, v184
    v_add_f32 v180, v180, v184
    v_add_f32 v181, v181, v185
    v_lshlrev_b32 v186, 16, v87
    v_and_b32 v187, 0xffff0000, v87
    v_mul_f32 v186, v186, v142
    v_mul_f32 v187, v187, v143
    v_cvt_pk_bf16_f32 v186, v186, v187
    v_and_b32 v187, 0xffff0000, v186
    v_lshlrev_b32 v186, 16, v186
    v_add_f32 v180, v180, v186
    v_add_f32 v181, v181, v187
    v_lshlrev_b32 v184, 16, v88
    v_and_b32 v185, 0xffff0000, v88
    v_mul_f32 v184, v184, v144
    v_mul_f32 v185, v185, v145
    v_cvt_pk_bf16_f32 v184, v184, v185
    v_and_b32 v185, 0xffff0000, v184
    v_lshlrev_b32 v184, 16, v184
    v_add_f32 v180, v180, v184
    v_add_f32 v181, v181, v185
    v_lshlrev_b32 v186, 16, v89
    v_and_b32 v187, 0xffff0000, v89
    v_mul_f32 v186, v186, v146
    v_mul_f32 v187, v187, v147
    v_cvt_pk_bf16_f32 v186, v186, v187
    v_and_b32 v187, 0xffff0000, v186
    v_lshlrev_b32 v186, 16, v186
    v_add_f32 v180, v180, v186
    v_add_f32 v181, v181, v187
    v_lshlrev_b32 v184, 16, v90
    v_and_b32 v185, 0xffff0000, v90
    v_mul_f32 v184, v184, v148
    v_mul_f32 v185, v185, v149
    v_cvt_pk_bf16_f32 v184, v184, v185
    v_and_b32 v185, 0xffff0000, v184
    v_lshlrev_b32 v184, 16, v184
    v_add_f32 v180, v180, v184
    v_add_f32 v181, v181, v185
    v_lshlrev_b32 v186, 16, v91
    v_and_b32 v187, 0xffff0000, v91
    v_mul_f32 v186, v186, v150
    v_mul_f32 v187, v187, v151
    v_cvt_pk_bf16_f32 v186, v186, v187
    v_and_b32 v187, 0xffff0000, v186
    v_lshlrev_b32 v186, 16, v186
    v_add_f32 v180, v180, v186
    v_add_f32 v181, v181, v187
    v_lshlrev_b32 v184, 16, v92
    v_and_b32 v185, 0xffff0000, v92
    v_mul_f32 v184, v184, v152
    v_mul_f32 v185, v185, v153
    v_cvt_pk_bf16_f32 v184, v184, v185
    v_and_b32 v185, 0xffff0000, v184
    v_lshlrev_b32 v184, 16, v184
    v_add_f32 v180, v180, v184
    v_add_f32 v181, v181, v185
    v_lshlrev_b32 v186, 16, v93
    v_and_b32 v187, 0xffff0000, v93
    v_mul_f32 v186, v186, v154
    v_mul_f32 v187, v187, v155
    v_cvt_pk_bf16_f32 v186, v186, v187
    v_and_b32 v187, 0xffff0000, v186
    v_lshlrev_b32 v186, 16, v186
    v_add_f32 v180, v180, v186
    v_add_f32 v181, v181, v187
    v_lshlrev_b32 v184, 16, v94
    v_and_b32 v185, 0xffff0000, v94
    v_mul_f32 v184, v184, v156
    v_mul_f32 v185, v185, v157
    v_cvt_pk_bf16_f32 v184, v184, v185
    v_and_b32 v185, 0xffff0000, v184
    v_lshlrev_b32 v184, 16, v184
    v_add_f32 v180, v180, v184
    v_add_f32 v181, v181, v185
    v_lshlrev_b32 v186, 16, v95
    v_and_b32 v187, 0xffff0000, v95
    v_mul_f32 v186, v186, v158
    v_mul_f32 v187, v187, v159
    v_cvt_pk_bf16_f32 v186, v186, v187
    v_and_b32 v187, 0xffff0000, v186
    v_lshlrev_b32 v186, 16, v186
    v_add_f32 v180, v180, v186
    v_add_f32 v181, v181, v187
    v_lshlrev_b32 v184, 16, v96
    v_and_b32 v185, 0xffff0000, v96
    v_mul_f32 v184, v184, v160
    v_mul_f32 v185, v185, v161
    v_cvt_pk_bf16_f32 v184, v184, v185
    v_and_b32 v185, 0xffff0000, v184
    v_lshlrev_b32 v184, 16, v184
    v_add_f32 v180, v180, v184
    v_add_f32 v181, v181, v185
    v_lshlrev_b32 v186, 16, v97
    v_and_b32 v187, 0xffff0000, v97
    v_mul_f32 v186, v186, v162
    v_mul_f32 v187, v187, v163
    v_cvt_pk_bf16_f32 v186, v186, v187
    v_and_b32 v187, 0xffff0000, v186
    v_lshlrev_b32 v186, 16, v186
    v_add_f32 v180, v180, v186
    v_add_f32 v181, v181, v187
    v_lshlrev_b32 v184, 16, v98
    v_and_b32 v185, 0xffff0000, v98
    v_mul_f32 v184, v184, v164
    v_mul_f32 v185, v185, v165
    v_cvt_pk_bf16_f32 v184, v184, v185
    v_and_b32 v185, 0xffff0000, v184
    v_lshlrev_b32 v184, 16, v184
    v_add_f32 v180, v180, v184
    v_add_f32 v181, v181, v185
    v_lshlrev_b32 v186, 16, v99
    v_and_b32 v187, 0xffff0000, v99
    v_mul_f32 v186, v186, v166
    v_mul_f32 v187, v187, v167
    v_cvt_pk_bf16_f32 v186, v186, v187
    v_and_b32 v187, 0xffff0000, v186
    v_lshlrev_b32 v186, 16, v186
    v_add_f32 v180, v180, v186
    v_add_f32 v181, v181, v187
    v_add_f32 v180, v180, v181
    s_nop 1
    v_add_f32_dpp v180, v180, v180 row_ror:8 row_mask:0xf bank_mask:0xf
    s_nop 1
    v_add_f32_dpp v180, v180, v180 row_ror:4 row_mask:0xf bank_mask:0xf
    s_nop 1
    v_add_f32_dpp v180, v180, v180 row_ror:2 row_mask:0xf bank_mask:0xf
    s_nop 1
    v_add_f32_dpp v180, v180, v180 row_ror:1 row_mask:0xf bank_mask:0xf
    v_cvt_pk_bf16_f32 v180, v180, v180
    v_and_b32 v180, 0xffff0000, v180
    v_mul_f32 v181, 0xbfb8aa3b, v180
    v_exp_f32 v181, v181
    s_nop 0
    v_add_f32 v181, 1.0, v181
    v_rcp_f32 v182, v181
    s_nop 0
    v_fma_f32 v183, -v181, v182, 2.0
    v_mul_f32 v182, v182, v183
    v_cvt_pk_bf16_f32 v174, v182, v182
    v_and_b32 v174, 0xffff0000, v174
    v_sub_f32 v183, 1.0, v174
    v_cvt_pk_bf16_f32 v175, v183, v183
    v_and_b32 v175, 0xffff0000, v175
    s_waitcnt vmcnt(0)
    v_mov_b32 v180, 0
    v_mov_b32 v181, 0
    v_lshlrev_b32 v184, 16, v100
    v_and_b32 v185, 0xffff0000, v100
    v_mul_f32 v184, v184, v128
    v_mul_f32 v185, v185, v129
    v_cvt_pk_bf16_f32 v184, v184, v185
    v_and_b32 v185, 0xffff0000, v184
    v_lshlrev_b32 v184, 16, v184
    v_add_f32 v180, v180, v184
    v_add_f32 v181, v181, v185
    v_lshlrev_b32 v186, 16, v101
    v_and_b32 v187, 0xffff0000, v101
    v_mul_f32 v186, v186, v130
    v_mul_f32 v187, v187, v131
    v_cvt_pk_bf16_f32 v186, v186, v187
    v_and_b32 v187, 0xffff0000, v186
    v_lshlrev_b32 v186, 16, v186
    v_add_f32 v180, v180, v186
    v_add_f32 v181, v181, v187
    v_lshlrev_b32 v184, 16, v102
    v_and_b32 v185, 0xffff0000, v102
    v_mul_f32 v184, v184, v132
    v_mul_f32 v185, v185, v133
    v_cvt_pk_bf16_f32 v184, v184, v185
    v_and_b32 v185, 0xffff0000, v184
    v_lshlrev_b32 v184, 16, v184
    v_add_f32 v180, v180, v184
    v_add_f32 v181, v181, v185
    v_lshlrev_b32 v186, 16, v103
    v_and_b32 v187, 0xffff0000, v103
    v_mul_f32 v186, v186, v134
    v_mul_f32 v187, v187, v135
    v_cvt_pk_bf16_f32 v186, v186, v187
    v_and_b32 v187, 0xffff0000, v186
    v_lshlrev_b32 v186, 16, v186
    v_add_f32 v180, v180, v186
    v_add_f32 v181, v181, v187
    v_lshlrev_b32 v184, 16, v104
    v_and_b32 v185, 0xffff0000, v104
    v_mul_f32 v184, v184, v136
    v_mul_f32 v185, v185, v137
    v_cvt_pk_bf16_f32 v184, v184, v185
    v_and_b32 v185, 0xffff0000, v184
    v_lshlrev_b32 v184, 16, v184
    v_add_f32 v180, v180, v184
    v_add_f32 v181, v181, v185
    v_lshlrev_b32 v186, 16, v105
    v_and_b32 v187, 0xffff0000, v105
    v_mul_f32 v186, v186, v138
    v_mul_f32 v187, v187, v139
    v_cvt_pk_bf16_f32 v186, v186, v187
    v_and_b32 v187, 0xffff0000, v186
    v_lshlrev_b32 v186, 16, v186
    v_add_f32 v180, v180, v186
    v_add_f32 v181, v181, v187
    v_lshlrev_b32 v184, 16, v106
    v_and_b32 v185, 0xffff0000, v106
    v_mul_f32 v184, v184, v140
    v_mul_f32 v185, v185, v141
    v_cvt_pk_bf16_f32 v184, v184, v185
    v_and_b32 v185, 0xffff0000, v184
    v_lshlrev_b32 v184, 16, v184
    v_add_f32 v180, v180, v184
    v_add_f32 v181, v181, v185
    v_lshlrev_b32 v186, 16, v107
    v_and_b32 v187, 0xffff0000, v107
    v_mul_f32 v186, v186, v142
    v_mul_f32 v187, v187, v143
    v_cvt_pk_bf16_f32 v186, v186, v187
    v_and_b32 v187, 0xffff0000, v186
    v_lshlrev_b32 v186, 16, v186
    v_add_f32 v180, v180, v186
    v_add_f32 v181, v181, v187
    v_lshlrev_b32 v184, 16, v108
    v_and_b32 v185, 0xffff0000, v108
    v_mul_f32 v184, v184, v144
    v_mul_f32 v185, v185, v145
    v_cvt_pk_bf16_f32 v184, v184, v185
    v_and_b32 v185, 0xffff0000, v184
    v_lshlrev_b32 v184, 16, v184
    v_add_f32 v180, v180, v184
    v_add_f32 v181, v181, v185
    v_lshlrev_b32 v186, 16, v109
    v_and_b32 v187, 0xffff0000, v109
    v_mul_f32 v186, v186, v146
    v_mul_f32 v187, v187, v147
    v_cvt_pk_bf16_f32 v186, v186, v187
    v_and_b32 v187, 0xffff0000, v186
    v_lshlrev_b32 v186, 16, v186
    v_add_f32 v180, v180, v186
    v_add_f32 v181, v181, v187
    v_lshlrev_b32 v184, 16, v110
    v_and_b32 v185, 0xffff0000, v110
    v_mul_f32 v184, v184, v148
    v_mul_f32 v185, v185, v149
    v_cvt_pk_bf16_f32 v184, v184, v185
    v_and_b32 v185, 0xffff0000, v184
    v_lshlrev_b32 v184, 16, v184
    v_add_f32 v180, v180, v184
    v_add_f32 v181, v181, v185
    v_lshlrev_b32 v186, 16, v111
    v_and_b32 v187, 0xffff0000, v111
    v_mul_f32 v186, v186, v150
    v_mul_f32 v187, v187, v151
    v_cvt_pk_bf16_f32 v186, v186, v187
    v_and_b32 v187, 0xffff0000, v186
    v_lshlrev_b32 v186, 16, v186
    v_add_f32 v180, v180, v186
    v_add_f32 v181, v181, v187
    v_lshlrev_b32 v184, 16, v112
    v_and_b32 v185, 0xffff0000, v112
    v_mul_f32 v184, v184, v152
    v_mul_f32 v185, v185, v153
    v_cvt_pk_bf16_f32 v184, v184, v185
    v_and_b32 v185, 0xffff0000, v184
    v_lshlrev_b32 v184, 16, v184
    v_add_f32 v180, v180, v184
    v_add_f32 v181, v181, v185
    v_lshlrev_b32 v186, 16, v113
    v_and_b32 v187, 0xffff0000, v113
    v_mul_f32 v186, v186, v154
    v_mul_f32 v187, v187, v155
    v_cvt_pk_bf16_f32 v186, v186, v187
    v_and_b32 v187, 0xffff0000, v186
    v_lshlrev_b32 v186, 16, v186
    v_add_f32 v180, v180, v186
    v_add_f32 v181, v181, v187
    v_lshlrev_b32 v184, 16, v114
    v_and_b32 v185, 0xffff0000, v114
    v_mul_f32 v184, v184, v156
    v_mul_f32 v185, v185, v157
    v_cvt_pk_bf16_f32 v184, v184, v185
    v_and_b32 v185, 0xffff0000, v184
    v_lshlrev_b32 v184, 16, v184
    v_add_f32 v180, v180, v184
    v_add_f32 v181, v181, v185
    v_lshlrev_b32 v186, 16, v115
    v_and_b32 v187, 0xffff0000, v115
    v_mul_f32 v186, v186, v158
    v_mul_f32 v187, v187, v159
    v_cvt_pk_bf16_f32 v186, v186, v187
    v_and_b32 v187, 0xffff0000, v186
    v_lshlrev_b32 v186, 16, v186
    v_add_f32 v180, v180, v186
    v_add_f32 v181, v181, v187
    v_lshlrev_b32 v184, 16, v116
    v_and_b32 v185, 0xffff0000, v116
    v_mul_f32 v184, v184, v160
    v_mul_f32 v185, v185, v161
    v_cvt_pk_bf16_f32 v184, v184, v185
    v_and_b32 v185, 0xffff0000, v184
    v_lshlrev_b32 v184, 16, v184
    v_add_f32 v180, v180, v184
    v_add_f32 v181, v181, v185
    v_lshlrev_b32 v186, 16, v117
    v_and_b32 v187, 0xffff0000, v117
    v_mul_f32 v186, v186, v162
    v_mul_f32 v187, v187, v163
    v_cvt_pk_bf16_f32 v186, v186, v187
    v_and_b32 v187, 0xffff0000, v186
    v_lshlrev_b32 v186, 16, v186
    v_add_f32 v180, v180, v186
    v_add_f32 v181, v181, v187
    v_lshlrev_b32 v184, 16, v118
    v_and_b32 v185, 0xffff0000, v118
    v_mul_f32 v184, v184, v164
    v_mul_f32 v185, v185, v165
    v_cvt_pk_bf16_f32 v184, v184, v185
    v_and_b32 v185, 0xffff0000, v184
    v_lshlrev_b32 v184, 16, v184
    v_add_f32 v180, v180, v184
    v_add_f32 v181, v181, v185
    v_lshlrev_b32 v186, 16, v119
    v_and_b32 v187, 0xffff0000, v119
    v_mul_f32 v186, v186, v166
    v_mul_f32 v187, v187, v167
    v_cvt_pk_bf16_f32 v186, v186, v187
    v_and_b32 v187, 0xffff0000, v186
    v_lshlrev_b32 v186, 16, v186
    v_add_f32 v180, v180, v186
    v_add_f32 v181, v181, v187
    v_add_f32 v180, v180, v181
    s_nop 1
    v_add_f32_dpp v180, v180, v180 row_ror:8 row_mask:0xf bank_mask:0xf
    s_nop 1
    v_add_f32_dpp v180, v180, v180 row_ror:4 row_mask:0xf bank_mask:0xf
    s_nop 1
    v_add_f32_dpp v180, v180, v180 row_ror:2 row_mask:0xf bank_mask:0xf
    s_nop 1
    v_add_f32_dpp v180, v180, v180 row_ror:1 row_mask:0xf bank_mask:0xf
    v_cvt_pk_bf16_f32 v180, v180, v180
    v_and_b32 v180, 0xffff0000, v180
    v_mul_f32 v181, 0xbfb8aa3b, v180
    v_exp_f32 v181, v181
    s_nop 0
    v_add_f32 v181, 1.0, v181
    v_rcp_f32 v182, v181
    s_nop 0
    v_fma_f32 v183, -v181, v182, 2.0
    v_mul_f32 v182, v182, v183
    v_cvt_pk_bf16_f32 v176, v182, v182
    v_and_b32 v176, 0xffff0000, v176
    v_sub_f32 v183, 1.0, v176
    v_cvt_pk_bf16_f32 v177, v183, v183
    v_and_b32 v177, 0xffff0000, v177
    v_mov_b32 v5, 0
    s_mov_b32 s82, 100000
GN_54:
    buffer_load_dwordx2 v[6:7], v5, s[24:27], 0 offen sc1
    s_waitcnt vmcnt(0)
    v_readfirstlane_b32 s28, v6
    v_readfirstlane_b32 s29, v7
    s_nop 0
    s_cmp_lg_u32 s28, 0
    s_cbranch_scc1 GNOK_55
    s_sub_u32 s82, s82, 1
    s_cbranch_scc1 L_END
    s_branch GN_54
GNOK_55:
    v_lshlrev_b32 v8, 3, v2
    s_lshl_b32 s33, s32, 3
    s_add_u32 s33, s33, 327680
    v_and_b32 v9, 15, v1
    v_cmp_eq_u32 vcc, 0, v9
    s_and_saveexec_b64 s[88:89], vcc
    buffer_store_dwordx2 v[170:171], v8, s[8:11], s33 offen offset:0 sc1
    buffer_store_dwordx2 v[172:173], v8, s[8:11], s33 offen offset:32 sc1
    buffer_store_dwordx2 v[174:175], v8, s[8:11], s33 offen offset:64 sc1
    buffer_store_dwordx2 v[176:177], v8, s[8:11], s33 offen offset:96 sc1
    s_mov_b64 exec, s[88:89]
    s_waitcnt vmcnt(0)
    s_barrier
    s_cmp_lg_u32 s3, 0
    s_cbranch_scc1 GNF_56
    s_lshl_b32 s34, s30, 7
    s_add_u32 s34, s34, 262224
    v_mov_b32 v6, s28
    v_mov_b32 v7, s29
    s_mov_b64 exec, 1
    buffer_store_dwordx2 v[6:7], v5, s[8:11], s34 offen sc1
    s_mov_b64 exec, -1
GNF_56:
L_END:
    s_endpgm
L_CODE_END:

.section .rodata,"a"
.p2align 6
.amdhsa_kernel gated_mix__ssm_conv_s4d__ssm_conv_s5__prompt_kernel
  .amdhsa_next_free_vgpr 256
  .amdhsa_next_free_sgpr 102
  .amdhsa_accum_offset 256
  .amdhsa_group_segment_fixed_size 0
  .amdhsa_kernarg_size 160
  .amdhsa_user_sgpr_count 2
  .amdhsa_user_sgpr_kernarg_segment_ptr 1
  .amdhsa_system_sgpr_workgroup_id_x 1
.end_amdhsa_kernel
```
